```python
import torch

def _softmax(x, axis=-1):
    return torch.softmax(x, dim=axis)

def _gelu(x):
    return torch.nn.functional.gelu(x, approximate='tanh')

def _silu(x):
    return torch.nn.functional.silu(x)

def _sigmoid(x):
    return torch.sigmoid(x)

def _layernorm(x, axis=-1, eps=1e-05):
    m = x.mean(dim=axis, keepdim=True)
    v = x.var(dim=axis, keepdim=True, unbiased=False)
    return (x - m) / torch.sqrt(v + eps)

def _scatter_add(tgt, idx, src, axis=0):
    return tgt.clone().index_add_(axis, idx, src)

def _segment_sum(src, seg, n):
    out = torch.zeros((n,) + src.shape[1:], dtype=src.dtype)
    return out.index_add_(0, seg, src)

def _pad(x, pw):
    flat = tuple((v for pair in reversed(pw) for v in pair))
    return torch.nn.functional.pad(x, flat)
kernel_name = 'gated_mix__linear_kernel_hedgehog__memory_aug_recurrent_mem_tr__prompt'

def setup_inputs():

    _w = lambda a: (lambda t: t.to(torch.bfloat16) if t.is_floating_point() else t)(torch.as_tensor(a))

    def _A_setup():
        B, S, D, H = (1, 2048, 640, 32)
        Dh = D // H
        return {'x': _w((lambda *s: torch.randn(*s, dtype=torch.bfloat16) * 0.05)(B, S, D)), 'wqkv': _w((lambda *s: torch.randn(*s, dtype=torch.bfloat16) * 1.6)(D, 3 * D)), 'w_phi': _w((lambda *s: torch.randn(*s, dtype=torch.bfloat16) * 1.6)(H, Dh, Dh) * Dh ** (-0.5)), 'wo': _w((lambda *s: torch.randn(*s, dtype=torch.bfloat16) * 0.05)(D, D))}
    _A_in = _A_setup()

    def _B_setup():
        B, S, Dm = (1, 2048, 640)
        H, Dh = (32, 128)
        M, seg = (8, 32)
        seg = min(seg, S)
        S = S // seg * seg
        return {'x': _w((lambda *s: torch.randn(*s, dtype=torch.bfloat16) * 0.05)(B, S, Dm)), 'mem0': _w((lambda *s: torch.randn(*s, dtype=torch.bfloat16) * 0.8)(B, M, Dm)), 'Wq': _w((lambda *s: torch.randn(*s, dtype=torch.bfloat16) * 3.2)(Dm, H, Dh) * Dm ** (-0.5)), 'Wk': _w((lambda *s: torch.randn(*s, dtype=torch.bfloat16) * 3.2)(Dm, H, Dh) * Dm ** (-0.5)), 'Wv': _w((lambda *s: torch.randn(*s, dtype=torch.bfloat16) * 0.8)(Dm, H, Dh) * Dm ** (-0.5)), 'Wo': _w((lambda *s: torch.randn(*s, dtype=torch.bfloat16) * 0.8)(H, Dh, Dm) * (H * Dh) ** (-0.5)), 'seg_len': seg}
    _B_in = _B_setup()
    return {'A_x': _A_in['x'], 'A_wqkv': _A_in['wqkv'], 'A_w_phi': _A_in['w_phi'], 'A_wo': _A_in['wo'], 'B_x': _B_in['x'], 'B_mem0': _B_in['mem0'], 'B_Wq': _B_in['Wq'], 'B_Wk': _B_in['Wk'], 'B_Wv': _B_in['Wv'], 'B_Wo': _B_in['Wo'], 'B_seg_len': _B_in['seg_len'], 'gate_w': _w((lambda *s: torch.randn(*s, dtype=torch.bfloat16) * 0.05)(640) * 16.0)}

def reference(A_x, A_wqkv, A_w_phi, A_wo, B_x, B_mem0, B_Wq, B_Wk, B_Wv, B_Wo, B_seg_len, gate_w):

    def _A_ref(x, wqkv, w_phi, wo):
        B, S, D = x.shape
        H = 32
        Dh = D // H
        qkv = (lambda x, *d: x.permute(*d))((x @ wqkv).reshape(B, S, 3, H, Dh), 2, 0, 3, 1, 4)
        q, k, v = (qkv[0], qkv[1], qkv[2])
        pq = torch.einsum('bhsd,hdf->bhsf', q, w_phi)
        pk = torch.einsum('bhsd,hdf->bhsf', k, w_phi)
        phi_q = torch.concatenate([_softmax(pq, axis=-1), _softmax(-pq, axis=-1)], axis=-1)
        phi_k = torch.concatenate([_softmax(pk, axis=-1), _softmax(-pk, axis=-1)], axis=-1)
        kv = torch.einsum('bhsf,bhsd->bhfd', phi_k, v)
        z = torch.einsum('bhsf->bhf', phi_k)
        num = torch.einsum('bhqf,bhfd->bhqd', phi_q, kv)
        den = torch.einsum('bhqf,bhf->bhq', phi_q, z)[..., None] + 1e-06
        o = num / den
        return (lambda x, *d: x.permute(*d))(o, 0, 2, 1, 3).reshape(B, S, D) @ wo

    def _B_ref(x, mem0, Wq, Wk, Wv, Wo, seg_len):
        B, S, Dm = x.shape
        H, Dh = (Wq.shape[1], Wq.shape[2])
        M = mem0.shape[1]
        scale = Dh ** (-0.5)
        n_seg = S // seg_len
        L = M + seg_len
        idx = torch.arange(L)
        mask = (idx[:, None] < M) | (idx[:, None] >= idx[None, :])
        mem = mem0
        outs = []
        for s in range(n_seg):
            xs = x[:, s * seg_len:(s + 1) * seg_len, :].clone()
            h = torch.concatenate([mem, xs], axis=1)
            q = torch.einsum('btd,dhe->bhte', h, Wq)
            k = torch.einsum('btd,dhe->bhte', h, Wk)
            v = torch.einsum('btd,dhe->bhte', h, Wv)
            scores = torch.einsum('bhqe,bhke->bhqk', q, k) * scale
            scores = torch.where(mask[None, None], scores, -1000000000.0)
            p = _softmax(scores, axis=-1)
            o = torch.einsum('bhqk,bhke->bhqe', p, v)
            o = torch.einsum('bhte,hed->btd', o, Wo)
            mem = o[:, :M, :].clone()
            outs.append(o[:, M:, :])
        return torch.concatenate(outs, axis=1)
    x = A_x
    g = _sigmoid((x * gate_w).sum(-1, keepdims=True))
    a = _A_ref(x, A_wqkv, A_w_phi, A_wo)
    b = _B_ref(x, B_mem0, B_Wq, B_Wk, B_Wv, B_Wo, B_seg_len)
    return g * a + (1 - g) * b
```

```asm
; @launch grid=(256,1,1) block=(256,1,1) lds=163840
.amdgcn_target "amdgcn-amd-amdhsa--gfx950"
.text
.globl gated_mix__linear_kernel_hedgehog__memory_aug_recurrent_mem_tr__prompt_kernel
.p2align 8
.type gated_mix__linear_kernel_hedgehog__memory_aug_recurrent_mem_tr__prompt_kernel,@function
gated_mix__linear_kernel_hedgehog__memory_aug_recurrent_mem_tr__prompt_kernel:
    s_cmp_ge_u32 s2, 256
    s_cbranch_scc1 L_end
    s_load_dwordx16 s[16:31], s[0:1], 0
    s_load_dwordx8 s[32:39], s[0:1], 64
    s_load_dwordx4 s[40:43], s[0:1], 96
    s_load_dwordx2 s[44:45], s[0:1], 112
    v_lshrrev_b32 v1, 6, v0
    v_and_b32 v0, 63, v0
    v_readfirstlane_b32 s4, v1
    s_getreg_b32 s3, hwreg(HW_REG_XCC_ID, 0, 4)
    s_mov_b32 s46, 0x40000
    s_waitcnt lgkmcnt(0)
    s_mov_b32 s8, s44
    s_and_b32 s9, s45, 0xffff
    s_mov_b32 s10, 0x10000000
    s_mov_b32 s11, 0x20000
    s_add_u32 s65, s44, 0x91fffff
    s_and_b32 s65, s65, 0xffe00000
    s_sub_u32 s73, s65, s44
    s_cmp_lg_u32 s4, 0
    s_cbranch_scc1 L_tk_wait
    s_lshr_b32 s6, s3, 1
    s_lshl_b32 s6, s6, 6
    s_and_b32 s7, s3, 1
    s_lshl_b32 s7, s7, 2
    s_add_u32 s6, s6, s7
    v_mov_b32 v1, s6
    v_mov_b32 v2, 1
    s_mov_b64 exec, 1
    global_atomic_add v3, v1, v2, s[42:43] sc0 sc1
    s_waitcnt vmcnt(0)
    v_mov_b32 v1, 0
    ds_write_b32 v1, v3
    s_waitcnt lgkmcnt(0)
    s_mov_b64 exec, -1
L_tk_wait:
    s_barrier
    v_mov_b32 v1, 0
    ds_read_b32 v2, v1
    s_waitcnt lgkmcnt(0)
    v_readfirstlane_b32 s6, v2
    s_mov_b32 s5, s3
    s_barrier
    s_cmp_ge_u32 s6, 32
    s_cbranch_scc1 L_end
    s_cmp_ge_u32 s5, 4
    s_cbranch_scc1 L_gemm
    v_lshlrev_b32 v1, 4, v0
    v_and_b32 v20, 15, v0
    v_lshrrev_b32 v21, 4, v0
    v_mov_b32 v5, 0x4444
    v_mov_b32 v22, 0xeeee
    v_cmp_lt_u32 vcc, 7, v20
    s_nop 1
    v_cndmask_b32 v5, v5, v22, vcc
    v_lshrrev_b32 v22, 1, v21
    v_lshlrev_b32 v22, 4, v22
    v_and_b32 v23, 1, v21
    v_lshl_add_u32 v22, v23, 2, v22
    v_bfe_u32 v23, v0, 2, 2
    v_add_u32 v22, v22, v23
    v_lshlrev_b32 v22, 5, v22
    v_and_b32 v23, 3, v0
    v_lshl_add_u32 v22, v23, 3, v22
    v_add_u32 v2, 10240, v22
    v_and_b32 v22, 3, v20
    v_bfe_u32 v23, v20, 3, 1
    v_lshl_add_u32 v22, v23, 2, v22
    v_bfe_u32 v23, v20, 2, 1
    v_lshl_add_u32 v22, v23, 3, v22
    v_lshlrev_b32 v22, 5, v22
    s_lshl_b32 s65, s4, 10
    s_add_u32 s66, s65, 10240
    v_add_u32 v22, s66, v22
    v_and_b32 v23, 1, v21
    v_lshl_add_u32 v24, v23, 3, v22
    v_lshl_add_u32 v25, v23, 4, v22
    v_add_u32 v25, 4096, v25
    v_cmp_lt_u32 s[82:83], 31, v0
    s_nop 1
    v_cndmask_b32 v3, v24, v25, s[82:83]
    v_add_u32 v24, 4, v24
    v_add_u32 v25, 8, v25
    v_cndmask_b32 v143, v24, v25, s[82:83]
    s_lshl_b32 s65, s4, 10
    v_add_u32 v9, s65, v1
    s_mul_i32 s66, s4, 3
    s_lshl_b32 s67, s4, 1
    s_add_u32 s67, s67, 2
    s_cmp_lt_u32 s4, 2
    s_cselect_b32 s66, s66, s67
    s_lshl_b32 s67, s66, 12
    s_add_u32 s67, s67, 110592
    v_add_u32 v4, s67, v1
    s_mul_i32 s67, s5, 163840
    s_lshl_b32 s68, s6, 8
    s_add_u32 s67, s67, s68
    s_lshl_b32 s68, s66, 14
    s_add_u32 s67, s67, s68
    s_add_u32 s55, s67, 71303168
    s_add_u32 s56, s55, 16384
    s_add_u32 s57, s55, 32768
    s_mul_i32 s75, s5, 20
    s_add_u32 s75, s75, s6
    s_lshl_b32 s58, s75, 13
    s_add_u32 s58, s58, 71303168
    s_add_u32 s72, s58, 4096
    v_lshrrev_b32 v22, 1, v21
    v_lshlrev_b32 v22, 13, v22
    v_and_b32 v23, 1, v21
    v_lshl_add_u32 v23, v23, 3, v20
    v_lshl_add_u32 v22, v23, 4, v22
    v_mov_b32 v23, 0x80000000
    v_cndmask_b32 v6, v22, v23, vcc
    v_lshlrev_b32 v22, 4, v20
    v_lshl_add_u32 v22, v21, 9, v22
    v_subrev_u32 v22, 128, v22
    v_cndmask_b32 v7, v23, v22, vcc
    v_lshrrev_b32 v22, 1, v21
    v_lshl_add_u32 v22, v22, 4, v20
    v_lshlrev_b32 v22, 3, v22
    v_and_b32 v23, 1, v21
    v_lshl_add_u32 v8, v23, 2, v22
    v_lshlrev_b32 v22, 3, v0
    v_mov_b32 v23, 0x80000000
    v_cmp_eq_u32 vcc, s4, v21
    s_nop 1
    v_cndmask_b32 v18, v23, v22, vcc
    v_mov_b32 v18, v22
    v_and_b32 v22, 7, v20
    v_lshlrev_b32 v22, 4, v22
    v_lshrrev_b32 v23, 3, v20
    v_lshl_add_u32 v22, v23, 3, v22
    v_lshl_add_u32 v22, v21, 2, v22
    v_mov_b32 v23, 0x80000000
    v_cmp_gt_u32 vcc, 32, v0
    s_nop 1
    v_cndmask_b32 v19, v23, v22, vcc
    s_lshl_b32 s65, s5, 3
    s_sub_u32 s65, s65, 8
    v_add_u32 v22, s65, v20
    v_mov_b32 v23, 63
    v_cmp_lt_u32 vcc, 7, v20
    s_nop 1
    v_cndmask_b32 v22, v23, v22, vcc
    v_lshlrev_b32 v23, 3, v21
    v_mov_b32 v24, 0xff800000
    v_add_u32 v25, 0, v23
    v_cmp_gt_u32 vcc, v25, v22
    s_nop 1
    v_cndmask_b32 v10, 0, v24, vcc
    v_add_u32 v25, 1, v23
    v_cmp_gt_u32 vcc, v25, v22
    s_nop 1
    v_cndmask_b32 v11, 0, v24, vcc
    v_add_u32 v25, 2, v23
    v_cmp_gt_u32 vcc, v25, v22
    s_nop 1
    v_cndmask_b32 v12, 0, v24, vcc
    v_add_u32 v25, 3, v23
    v_cmp_gt_u32 vcc, v25, v22
    s_nop 1
    v_cndmask_b32 v13, 0, v24, vcc
    v_add_u32 v25, 4, v23
    v_cmp_gt_u32 vcc, v25, v22
    s_nop 1
    v_cndmask_b32 v14, 0, v24, vcc
    v_add_u32 v25, 5, v23
    v_cmp_gt_u32 vcc, v25, v22
    s_nop 1
    v_cndmask_b32 v15, 0, v24, vcc
    v_add_u32 v25, 6, v23
    v_cmp_gt_u32 vcc, v25, v22
    s_nop 1
    v_cndmask_b32 v16, 0, v24, vcc
    v_add_u32 v25, 7, v23
    v_cmp_gt_u32 vcc, v25, v22
    s_nop 1
    v_cndmask_b32 v17, 0, v24, vcc
    v_lshrrev_b32 v22, 2, v20
    v_lshlrev_b32 v22, 3, v22
    v_and_b32 v23, 3, v20
    v_add_u32 v22, v22, v23
    v_lshl_add_u32 v22, v21, 5, v22
    v_lshlrev_b32 v140, 4, v22
    v_lshl_add_u32 v22, v21, 5, v20
    v_lshlrev_b32 v141, 4, v22
    v_lshrrev_b32 v22, 1, v0
    v_and_b32 v23, 19, v22
    v_bfe_u32 v24, v22, 2, 1
    v_lshl_add_u32 v23, v24, 3, v23
    v_bfe_u32 v24, v22, 3, 1
    v_lshl_add_u32 v23, v24, 2, v23
    s_lshl_b32 s65, s5, 5
    v_add_u32 v23, s65, v23
    v_lshlrev_b32 v142, 4, v23
    v_mov_b32 v137, 0
    v_mov_b32 v139, 0
    s_mov_b32 s70, 0x3e0293ee
    s_mov_b32 s71, 0x3e0293ee
    s_add_u32 s65, s4, 8
    s_add_u32 s66, s4, 4
    s_cmp_lt_u32 s4, 2
    s_cselect_b32 s64, s65, s66
    v_mov_b32 v24, -1
    v_mov_b32 v25, -1
    v_mov_b32 v26, -1
    v_mov_b32 v27, -1
    s_cmp_eq_u32 s4, 0
    s_cbranch_scc1 L_fill_ag
    s_cmp_eq_u32 s4, 1
    s_cbranch_scc1 L_fill_vex
    s_cmp_eq_u32 s4, 2
    s_cbranch_scc1 L_fill_rs
    s_mov_b32 s65, 0
    s_lshl_b32 s66, s6, 2
    s_add_u32 s66, s66, s5
    s_lshl_b32 s66, s66, 7
    s_add_u32 s66, s66, 72155136
    v_mov_b32 v92, s65
    v_mov_b32 v93, s65
    v_mov_b32 v94, s65
    v_mov_b32 v95, s65
    s_mov_b64 exec, 0xff
    buffer_store_dwordx4 v[92:95], v1, s[8:11], s66 offen sc1
    s_mov_b64 exec, -1
    s_or_b32 s65, s5, s6
    s_cmp_lg_u32 s65, 0
    s_cbranch_scc1 L_fill_done
    v_mov_b32 v20, 0
    v_mov_b32 v21, 0
    s_mov_b64 exec, 1
    s_mov_b32 s76, -1
    s_mov_b32 s77, -1
    s_mov_b32 s67, 5
L_probe_c:
    s_add_u32 s65, s73, 0
    s_memtime s[82:83]
    s_waitcnt lgkmcnt(0)
    buffer_atomic_add v21, v20, s[8:11], s65 offen sc0 sc1
    s_waitcnt vmcnt(0)
    s_memtime s[84:85]
    s_waitcnt lgkmcnt(0)
    s_sub_u32 s66, s84, s82
    s_min_u32 s76, s76, s66
    v_mov_b32 v21, 0
    s_add_u32 s65, s73, 8192
    s_memtime s[82:83]
    s_waitcnt lgkmcnt(0)
    buffer_atomic_add v21, v20, s[8:11], s65 offen sc0 sc1
    s_waitcnt vmcnt(0)
    s_memtime s[84:85]
    s_waitcnt lgkmcnt(0)
    s_sub_u32 s66, s84, s82
    s_min_u32 s77, s77, s66
    v_mov_b32 v21, 0
    s_sub_u32 s67, s67, 1
    s_cmp_lg_u32 s67, 0
    s_cbranch_scc1 L_probe_c
    s_cmp_lt_u32 s77, s76
    s_cselect_b32 s65, 2, 1
    v_mov_b32 v21, s65
    v_mov_b32 v20, 36
    global_store_dword v20, v21, s[42:43] sc1
    s_mov_b64 exec, -1
    s_branch L_fill_done
L_fill_ag:
    s_cmp_ge_u32 s6, 20
    s_cbranch_scc1 L_fill_done
    s_lshl_b32 s65, s75, 7
    s_add_u32 s65, s65, 0x2000
    v_lshrrev_b32 v20, 3, v0
    v_add_u32 v20, 1, v20
    v_mul_u32_u24 v20, 10240, v20
    v_and_b32 v21, 7, v0
    v_lshl_add_u32 v20, v21, 4, v20
    v_add_u32 v20, s65, v20
    v_and_b32 v21, 0xffffe000, v20
    v_add_u32 v21, v21, v20
    buffer_store_dwordx4 v[24:27], v21, s[8:11], s73 offen sc1
    v_add_u32 v22, 0x2000, v21
    buffer_store_dwordx4 v[24:27], v22, s[8:11], s73 offen sc1
    v_add_u32 v20, 81920, v20
    v_and_b32 v21, 0xffffe000, v20
    v_add_u32 v21, v21, v20
    buffer_store_dwordx4 v[24:27], v21, s[8:11], s73 offen sc1
    v_add_u32 v22, 0x2000, v21
    buffer_store_dwordx4 v[24:27], v22, s[8:11], s73 offen sc1
    v_add_u32 v20, 81920, v20
    v_and_b32 v21, 0xffffe000, v20
    v_add_u32 v21, v21, v20
    buffer_store_dwordx4 v[24:27], v21, s[8:11], s73 offen sc1
    v_add_u32 v22, 0x2000, v21
    buffer_store_dwordx4 v[24:27], v22, s[8:11], s73 offen sc1
    v_add_u32 v20, 81920, v20
    v_and_b32 v21, 0xffffe000, v20
    v_add_u32 v21, v21, v20
    buffer_store_dwordx4 v[24:27], v21, s[8:11], s73 offen sc1
    v_add_u32 v22, 0x2000, v21
    buffer_store_dwordx4 v[24:27], v22, s[8:11], s73 offen sc1
    v_add_u32 v20, 81920, v20
    v_and_b32 v21, 0xffffe000, v20
    v_add_u32 v21, v21, v20
    buffer_store_dwordx4 v[24:27], v21, s[8:11], s73 offen sc1
    v_add_u32 v22, 0x2000, v21
    buffer_store_dwordx4 v[24:27], v22, s[8:11], s73 offen sc1
    v_add_u32 v20, 81920, v20
    v_and_b32 v21, 0xffffe000, v20
    v_add_u32 v21, v21, v20
    buffer_store_dwordx4 v[24:27], v21, s[8:11], s73 offen sc1
    v_add_u32 v22, 0x2000, v21
    buffer_store_dwordx4 v[24:27], v22, s[8:11], s73 offen sc1
    v_add_u32 v20, 81920, v20
    v_and_b32 v21, 0xffffe000, v20
    v_add_u32 v21, v21, v20
    buffer_store_dwordx4 v[24:27], v21, s[8:11], s73 offen sc1
    v_add_u32 v22, 0x2000, v21
    buffer_store_dwordx4 v[24:27], v22, s[8:11], s73 offen sc1
    v_add_u32 v20, 81920, v20
    v_and_b32 v21, 0xffffe000, v20
    v_add_u32 v21, v21, v20
    buffer_store_dwordx4 v[24:27], v21, s[8:11], s73 offen sc1
    v_add_u32 v22, 0x2000, v21
    buffer_store_dwordx4 v[24:27], v22, s[8:11], s73 offen sc1
    s_branch L_fill_done
L_fill_vex:
    s_lshl_b32 s65, s6, 2
    s_add_u32 s65, s65, s5
    s_mul_i32 s65, s65, 512
    s_add_u32 s65, s65, 663552
    v_lshrrev_b32 v20, 5, v0
    v_mul_u32_u24 v20, 65536, v20
    v_and_b32 v21, 31, v0
    v_lshl_add_u32 v20, v21, 4, v20
    v_add_u32 v20, s65, v20
    v_and_b32 v21, 0xffffe000, v20
    v_add_u32 v21, v21, v20
    buffer_store_dwordx4 v[24:27], v21, s[8:11], s73 offen sc1
    v_add_u32 v22, 0x2000, v21
    buffer_store_dwordx4 v[24:27], v22, s[8:11], s73 offen sc1
    v_add_u32 v20, 131072, v20
    v_and_b32 v21, 0xffffe000, v20
    v_add_u32 v21, v21, v20
    buffer_store_dwordx4 v[24:27], v21, s[8:11], s73 offen sc1
    v_add_u32 v22, 0x2000, v21
    buffer_store_dwordx4 v[24:27], v22, s[8:11], s73 offen sc1
    s_branch L_fill_done
L_fill_rs:
    s_cmp_ge_u32 s6, 20
    s_cbranch_scc1 L_fill_done
    v_mov_b32 v24, 1
    v_mov_b32 v25, 1
    v_mov_b32 v26, 1
    v_mov_b32 v27, 1
    buffer_store_dwordx4 v[24:27], v1, s[8:11], s58 offen offset:0
    buffer_store_dwordx4 v[24:27], v1, s[8:11], s58 offen offset:1024
    buffer_store_dwordx4 v[24:27], v1, s[8:11], s58 offen offset:2048
    buffer_store_dwordx4 v[24:27], v1, s[8:11], s58 offen offset:3072
    buffer_store_dwordx4 v[24:27], v1, s[8:11], s72 offen offset:0
    buffer_store_dwordx4 v[24:27], v1, s[8:11], s72 offen offset:1024
    buffer_store_dwordx4 v[24:27], v1, s[8:11], s72 offen offset:2048
    buffer_store_dwordx4 v[24:27], v1, s[8:11], s72 offen offset:3072
    s_mul_i32 s65, s5, 1280
    s_mul_i32 s66, s6, 64
    s_add_u32 s65, s65, s66
    s_add_u32 s65, s65, s73
    s_add_u32 s65, s65, 1024
    s_add_u32 s66, s65, 0x2000
    v_mov_b32 v24, 0
    s_mov_b64 exec, 1
    buffer_store_dword v24, v24, s[8:11], s65 offen
    buffer_store_dword v24, v24, s[8:11], s66 offen
    s_mov_b64 exec, -1
L_fill_done:
    s_cmp_lt_u32 s4, 2
    s_cselect_b32 s12, s28, s30
    s_cselect_b32 s13, s29, s31
    s_and_b32 s13, s13, 0xffff
    s_mov_b32 s14, 0x500000
    s_mov_b32 s15, 0x20000
    v_lshrrev_b32 v20, 4, v0
    v_lshlrev_b32 v20, 13, v20
    v_and_b32 v21, 15, v0
    v_lshl_add_u32 v20, v21, 4, v20
    s_lshl_b32 s65, s6, 8
    v_add_u32 v24, s65, v20
    s_and_b32 s76, s4, 1
    s_lshl_b32 s76, s76, 18
    s_lshl_b32 s77, s4, 13
    v_lshrrev_b32 v20, 5, v0
    v_lshlrev_b32 v20, 4, v20
    v_bfe_u32 v21, v0, 4, 1
    v_lshl_add_u32 v20, v21, 2, v20
    v_bfe_u32 v21, v0, 2, 2
    v_add_u32 v20, v20, v21
    v_mov_b32 v23, v20
    v_lshlrev_b32 v20, 8, v20
    v_and_b32 v21, 3, v0
    v_lshl_add_u32 v20, v21, 3, v20
    s_lshl_b32 s65, s4, 6
    v_add_u32 v25, s65, v20
    v_add_u32 v26, 0x10000, v25
    v_add_u32 v27, 0x20000, v25
    s_add_u32 s65, s76, 0
    s_add_u32 s66, s77, 0
    s_mov_b32 m0, s66
    s_nop 0
    buffer_load_dwordx4 v24, s[12:15], s65 offen lds
    s_add_u32 s65, s76, 32768
    s_add_u32 s66, s77, 1024
    s_mov_b32 m0, s66
    s_nop 0
    buffer_load_dwordx4 v24, s[12:15], s65 offen lds
    s_add_u32 s65, s76, 65536
    s_add_u32 s66, s77, 2048
    s_mov_b32 m0, s66
    s_nop 0
    buffer_load_dwordx4 v24, s[12:15], s65 offen lds
    s_add_u32 s65, s76, 98304
    s_add_u32 s66, s77, 3072
    s_mov_b32 m0, s66
    s_nop 0
    buffer_load_dwordx4 v24, s[12:15], s65 offen lds
    s_add_u32 s65, s76, 131072
    s_add_u32 s66, s77, 4096
    s_mov_b32 m0, s66
    s_nop 0
    buffer_load_dwordx4 v24, s[12:15], s65 offen lds
    s_add_u32 s65, s76, 163840
    s_add_u32 s66, s77, 5120
    s_mov_b32 m0, s66
    s_nop 0
    buffer_load_dwordx4 v24, s[12:15], s65 offen lds
    s_add_u32 s65, s76, 196608
    s_add_u32 s66, s77, 6144
    s_mov_b32 m0, s66
    s_nop 0
    buffer_load_dwordx4 v24, s[12:15], s65 offen lds
    s_add_u32 s65, s76, 229376
    s_add_u32 s66, s77, 7168
    s_mov_b32 m0, s66
    s_nop 0
    buffer_load_dwordx4 v24, s[12:15], s65 offen lds
    s_add_u32 s65, s76, 524288
    s_add_u32 s66, s77, 32768
    s_mov_b32 m0, s66
    s_nop 0
    buffer_load_dwordx4 v24, s[12:15], s65 offen lds
    s_add_u32 s65, s76, 557056
    s_add_u32 s66, s77, 33792
    s_mov_b32 m0, s66
    s_nop 0
    buffer_load_dwordx4 v24, s[12:15], s65 offen lds
    s_add_u32 s65, s76, 589824
    s_add_u32 s66, s77, 34816
    s_mov_b32 m0, s66
    s_nop 0
    buffer_load_dwordx4 v24, s[12:15], s65 offen lds
    s_add_u32 s65, s76, 622592
    s_add_u32 s66, s77, 35840
    s_mov_b32 m0, s66
    s_nop 0
    buffer_load_dwordx4 v24, s[12:15], s65 offen lds
    s_add_u32 s65, s76, 655360
    s_add_u32 s66, s77, 36864
    s_mov_b32 m0, s66
    s_nop 0
    buffer_load_dwordx4 v24, s[12:15], s65 offen lds
    s_add_u32 s65, s76, 688128
    s_add_u32 s66, s77, 37888
    s_mov_b32 m0, s66
    s_nop 0
    buffer_load_dwordx4 v24, s[12:15], s65 offen lds
    s_add_u32 s65, s76, 720896
    s_add_u32 s66, s77, 38912
    s_mov_b32 m0, s66
    s_nop 0
    buffer_load_dwordx4 v24, s[12:15], s65 offen lds
    s_add_u32 s65, s76, 753664
    s_add_u32 s66, s77, 39936
    s_mov_b32 m0, s66
    s_nop 0
    buffer_load_dwordx4 v24, s[12:15], s65 offen lds
    s_add_u32 s65, s76, 1048576
    s_add_u32 s66, s77, 65536
    s_mov_b32 m0, s66
    s_nop 0
    buffer_load_dwordx4 v24, s[12:15], s65 offen lds
    s_add_u32 s65, s76, 1081344
    s_add_u32 s66, s77, 66560
    s_mov_b32 m0, s66
    s_nop 0
    buffer_load_dwordx4 v24, s[12:15], s65 offen lds
    s_add_u32 s65, s76, 1114112
    s_add_u32 s66, s77, 67584
    s_mov_b32 m0, s66
    s_nop 0
    buffer_load_dwordx4 v24, s[12:15], s65 offen lds
    s_add_u32 s65, s76, 1146880
    s_add_u32 s66, s77, 68608
    s_mov_b32 m0, s66
    s_nop 0
    buffer_load_dwordx4 v24, s[12:15], s65 offen lds
    s_add_u32 s65, s76, 1179648
    s_add_u32 s66, s77, 69632
    s_mov_b32 m0, s66
    s_nop 0
    buffer_load_dwordx4 v24, s[12:15], s65 offen lds
    s_add_u32 s65, s76, 1212416
    s_add_u32 s66, s77, 70656
    s_mov_b32 m0, s66
    s_nop 0
    buffer_load_dwordx4 v24, s[12:15], s65 offen lds
    s_add_u32 s65, s76, 1245184
    s_add_u32 s66, s77, 71680
    s_mov_b32 m0, s66
    s_nop 0
    buffer_load_dwordx4 v24, s[12:15], s65 offen lds
    s_add_u32 s65, s76, 1277952
    s_add_u32 s66, s77, 72704
    s_mov_b32 m0, s66
    s_nop 0
    buffer_load_dwordx4 v24, s[12:15], s65 offen lds
    s_add_u32 s65, s76, 1572864
    s_add_u32 s66, s77, 98304
    s_mov_b32 m0, s66
    s_nop 0
    buffer_load_dwordx4 v24, s[12:15], s65 offen lds
    s_add_u32 s65, s76, 1605632
    s_add_u32 s66, s77, 99328
    s_mov_b32 m0, s66
    s_nop 0
    buffer_load_dwordx4 v24, s[12:15], s65 offen lds
    s_add_u32 s65, s76, 1638400
    s_add_u32 s66, s77, 100352
    s_mov_b32 m0, s66
    s_nop 0
    buffer_load_dwordx4 v24, s[12:15], s65 offen lds
    s_add_u32 s65, s76, 1671168
    s_add_u32 s66, s77, 101376
    s_mov_b32 m0, s66
    s_nop 0
    buffer_load_dwordx4 v24, s[12:15], s65 offen lds
    s_add_u32 s65, s76, 1703936
    s_add_u32 s66, s77, 102400
    s_mov_b32 m0, s66
    s_nop 0
    buffer_load_dwordx4 v24, s[12:15], s65 offen lds
    s_add_u32 s65, s76, 1736704
    s_add_u32 s66, s77, 103424
    s_mov_b32 m0, s66
    s_nop 0
    buffer_load_dwordx4 v24, s[12:15], s65 offen lds
    s_add_u32 s65, s76, 1769472
    s_add_u32 s66, s77, 104448
    s_mov_b32 m0, s66
    s_nop 0
    buffer_load_dwordx4 v24, s[12:15], s65 offen lds
    s_add_u32 s65, s76, 1802240
    s_add_u32 s66, s77, 105472
    s_mov_b32 m0, s66
    s_nop 0
    buffer_load_dwordx4 v24, s[12:15], s65 offen lds
    s_waitcnt vmcnt(24)
    s_barrier
    s_cmp_lg_u32 s4, 0
    s_cbranch_scc1 L_noarr
    v_mov_b32 v20, 32
    v_mov_b32 v21, 1
    s_mov_b64 exec, 1
    global_atomic_add v20, v21, s[42:43] sc1
    s_mov_b64 exec, -1
L_noarr:
    s_add_u32 s65, s76, 2097152
    s_add_u32 s66, s77, 131072
    s_mov_b32 m0, s66
    s_nop 0
    buffer_load_dwordx4 v24, s[12:15], s65 offen lds
    s_add_u32 s65, s76, 2129920
    s_add_u32 s66, s77, 132096
    s_mov_b32 m0, s66
    s_nop 0
    buffer_load_dwordx4 v24, s[12:15], s65 offen lds
    s_add_u32 s65, s76, 2162688
    s_add_u32 s66, s77, 133120
    s_mov_b32 m0, s66
    s_nop 0
    buffer_load_dwordx4 v24, s[12:15], s65 offen lds
    s_add_u32 s65, s76, 2195456
    s_add_u32 s66, s77, 134144
    s_mov_b32 m0, s66
    s_nop 0
    buffer_load_dwordx4 v24, s[12:15], s65 offen lds
    s_add_u32 s65, s76, 2228224
    s_add_u32 s66, s77, 135168
    s_mov_b32 m0, s66
    s_nop 0
    buffer_load_dwordx4 v24, s[12:15], s65 offen lds
    s_add_u32 s65, s76, 2260992
    s_add_u32 s66, s77, 136192
    s_mov_b32 m0, s66
    s_nop 0
    buffer_load_dwordx4 v24, s[12:15], s65 offen lds
    s_add_u32 s65, s76, 2293760
    s_add_u32 s66, s77, 137216
    s_mov_b32 m0, s66
    s_nop 0
    buffer_load_dwordx4 v24, s[12:15], s65 offen lds
    s_add_u32 s65, s76, 2326528
    s_add_u32 s66, s77, 138240
    s_mov_b32 m0, s66
    s_nop 0
    buffer_load_dwordx4 v24, s[12:15], s65 offen lds
    ds_read_b64_tr_b16 v[32:33], v25 offset:0
    ds_read_b64_tr_b16 v[34:35], v25 offset:2048
    ds_read_b64_tr_b16 v[36:37], v25 offset:8192
    ds_read_b64_tr_b16 v[38:39], v25 offset:10240
    s_waitcnt lgkmcnt(0)
    v_mov_b32 v192, v32
    v_mov_b32 v193, v34
    v_mov_b32 v194, v33
    v_mov_b32 v195, v35
    v_mov_b32 v196, v36
    v_mov_b32 v197, v38
    v_mov_b32 v198, v37
    v_mov_b32 v199, v39
    ds_read_b64_tr_b16 v[32:33], v25 offset:32
    ds_read_b64_tr_b16 v[34:35], v25 offset:2080
    ds_read_b64_tr_b16 v[36:37], v25 offset:8224
    ds_read_b64_tr_b16 v[38:39], v25 offset:10272
    s_waitcnt lgkmcnt(0)
    v_accvgpr_write_b32 a16, v32
    v_accvgpr_write_b32 a17, v34
    v_accvgpr_write_b32 a18, v33
    v_accvgpr_write_b32 a19, v35
    v_accvgpr_write_b32 a20, v36
    v_accvgpr_write_b32 a21, v38
    v_accvgpr_write_b32 a22, v37
    v_accvgpr_write_b32 a23, v39
    ds_read_b64_tr_b16 v[32:33], v25 offset:16384
    ds_read_b64_tr_b16 v[34:35], v25 offset:18432
    ds_read_b64_tr_b16 v[36:37], v25 offset:24576
    ds_read_b64_tr_b16 v[38:39], v25 offset:26624
    s_waitcnt lgkmcnt(0)
    v_accvgpr_write_b32 a96, v32
    v_accvgpr_write_b32 a97, v34
    v_accvgpr_write_b32 a98, v33
    v_accvgpr_write_b32 a99, v35
    v_accvgpr_write_b32 a100, v36
    v_accvgpr_write_b32 a101, v38
    v_accvgpr_write_b32 a102, v37
    v_accvgpr_write_b32 a103, v39
    ds_read_b64_tr_b16 v[32:33], v25 offset:16416
    ds_read_b64_tr_b16 v[34:35], v25 offset:18464
    ds_read_b64_tr_b16 v[36:37], v25 offset:24608
    ds_read_b64_tr_b16 v[38:39], v25 offset:26656
    s_waitcnt lgkmcnt(0)
    v_accvgpr_write_b32 a176, v32
    v_accvgpr_write_b32 a177, v34
    v_accvgpr_write_b32 a178, v33
    v_accvgpr_write_b32 a179, v35
    v_accvgpr_write_b32 a180, v36
    v_accvgpr_write_b32 a181, v38
    v_accvgpr_write_b32 a182, v37
    v_accvgpr_write_b32 a183, v39
    s_waitcnt vmcnt(24)
    s_barrier
    s_add_u32 s65, s76, 2621440
    s_add_u32 s66, s77, 0
    s_mov_b32 m0, s66
    s_nop 0
    buffer_load_dwordx4 v24, s[12:15], s65 offen lds
    s_add_u32 s65, s76, 2654208
    s_add_u32 s66, s77, 1024
    s_mov_b32 m0, s66
    s_nop 0
    buffer_load_dwordx4 v24, s[12:15], s65 offen lds
    s_add_u32 s65, s76, 2686976
    s_add_u32 s66, s77, 2048
    s_mov_b32 m0, s66
    s_nop 0
    buffer_load_dwordx4 v24, s[12:15], s65 offen lds
    s_add_u32 s65, s76, 2719744
    s_add_u32 s66, s77, 3072
    s_mov_b32 m0, s66
    s_nop 0
    buffer_load_dwordx4 v24, s[12:15], s65 offen lds
    s_add_u32 s65, s76, 2752512
    s_add_u32 s66, s77, 4096
    s_mov_b32 m0, s66
    s_nop 0
    buffer_load_dwordx4 v24, s[12:15], s65 offen lds
    s_add_u32 s65, s76, 2785280
    s_add_u32 s66, s77, 5120
    s_mov_b32 m0, s66
    s_nop 0
    buffer_load_dwordx4 v24, s[12:15], s65 offen lds
    s_add_u32 s65, s76, 2818048
    s_add_u32 s66, s77, 6144
    s_mov_b32 m0, s66
    s_nop 0
    buffer_load_dwordx4 v24, s[12:15], s65 offen lds
    s_add_u32 s65, s76, 2850816
    s_add_u32 s66, s77, 7168
    s_mov_b32 m0, s66
    s_nop 0
    buffer_load_dwordx4 v24, s[12:15], s65 offen lds
    ds_read_b64_tr_b16 v[32:33], v25 offset:32768
    ds_read_b64_tr_b16 v[34:35], v25 offset:34816
    ds_read_b64_tr_b16 v[36:37], v25 offset:40960
    ds_read_b64_tr_b16 v[38:39], v25 offset:43008
    s_waitcnt lgkmcnt(0)
    v_mov_b32 v200, v32
    v_mov_b32 v201, v34
    v_mov_b32 v202, v33
    v_mov_b32 v203, v35
    v_mov_b32 v204, v36
    v_mov_b32 v205, v38
    v_mov_b32 v206, v37
    v_mov_b32 v207, v39
    ds_read_b64_tr_b16 v[32:33], v25 offset:32800
    ds_read_b64_tr_b16 v[34:35], v25 offset:34848
    ds_read_b64_tr_b16 v[36:37], v25 offset:40992
    ds_read_b64_tr_b16 v[38:39], v25 offset:43040
    s_waitcnt lgkmcnt(0)
    v_accvgpr_write_b32 a24, v32
    v_accvgpr_write_b32 a25, v34
    v_accvgpr_write_b32 a26, v33
    v_accvgpr_write_b32 a27, v35
    v_accvgpr_write_b32 a28, v36
    v_accvgpr_write_b32 a29, v38
    v_accvgpr_write_b32 a30, v37
    v_accvgpr_write_b32 a31, v39
    ds_read_b64_tr_b16 v[32:33], v25 offset:49152
    ds_read_b64_tr_b16 v[34:35], v25 offset:51200
    ds_read_b64_tr_b16 v[36:37], v25 offset:57344
    ds_read_b64_tr_b16 v[38:39], v25 offset:59392
    s_waitcnt lgkmcnt(0)
    v_accvgpr_write_b32 a104, v32
    v_accvgpr_write_b32 a105, v34
    v_accvgpr_write_b32 a106, v33
    v_accvgpr_write_b32 a107, v35
    v_accvgpr_write_b32 a108, v36
    v_accvgpr_write_b32 a109, v38
    v_accvgpr_write_b32 a110, v37
    v_accvgpr_write_b32 a111, v39
    ds_read_b64_tr_b16 v[32:33], v25 offset:49184
    ds_read_b64_tr_b16 v[34:35], v25 offset:51232
    ds_read_b64_tr_b16 v[36:37], v25 offset:57376
    ds_read_b64_tr_b16 v[38:39], v25 offset:59424
    s_waitcnt lgkmcnt(0)
    v_accvgpr_write_b32 a184, v32
    v_accvgpr_write_b32 a185, v34
    v_accvgpr_write_b32 a186, v33
    v_accvgpr_write_b32 a187, v35
    v_accvgpr_write_b32 a188, v36
    v_accvgpr_write_b32 a189, v38
    v_accvgpr_write_b32 a190, v37
    v_accvgpr_write_b32 a191, v39
    s_waitcnt vmcnt(24)
    s_barrier
    s_add_u32 s65, s76, 3145728
    s_add_u32 s66, s77, 32768
    s_mov_b32 m0, s66
    s_nop 0
    buffer_load_dwordx4 v24, s[12:15], s65 offen lds
    s_add_u32 s65, s76, 3178496
    s_add_u32 s66, s77, 33792
    s_mov_b32 m0, s66
    s_nop 0
    buffer_load_dwordx4 v24, s[12:15], s65 offen lds
    s_add_u32 s65, s76, 3211264
    s_add_u32 s66, s77, 34816
    s_mov_b32 m0, s66
    s_nop 0
    buffer_load_dwordx4 v24, s[12:15], s65 offen lds
    s_add_u32 s65, s76, 3244032
    s_add_u32 s66, s77, 35840
    s_mov_b32 m0, s66
    s_nop 0
    buffer_load_dwordx4 v24, s[12:15], s65 offen lds
    s_add_u32 s65, s76, 3276800
    s_add_u32 s66, s77, 36864
    s_mov_b32 m0, s66
    s_nop 0
    buffer_load_dwordx4 v24, s[12:15], s65 offen lds
    s_add_u32 s65, s76, 3309568
    s_add_u32 s66, s77, 37888
    s_mov_b32 m0, s66
    s_nop 0
    buffer_load_dwordx4 v24, s[12:15], s65 offen lds
    s_add_u32 s65, s76, 3342336
    s_add_u32 s66, s77, 38912
    s_mov_b32 m0, s66
    s_nop 0
    buffer_load_dwordx4 v24, s[12:15], s65 offen lds
    s_add_u32 s65, s76, 3375104
    s_add_u32 s66, s77, 39936
    s_mov_b32 m0, s66
    s_nop 0
    buffer_load_dwordx4 v24, s[12:15], s65 offen lds
    ds_read_b64_tr_b16 v[32:33], v26 offset:0
    ds_read_b64_tr_b16 v[34:35], v26 offset:2048
    ds_read_b64_tr_b16 v[36:37], v26 offset:8192
    ds_read_b64_tr_b16 v[38:39], v26 offset:10240
    s_waitcnt lgkmcnt(0)
    v_mov_b32 v208, v32
    v_mov_b32 v209, v34
    v_mov_b32 v210, v33
    v_mov_b32 v211, v35
    v_mov_b32 v212, v36
    v_mov_b32 v213, v38
    v_mov_b32 v214, v37
    v_mov_b32 v215, v39
    ds_read_b64_tr_b16 v[32:33], v26 offset:32
    ds_read_b64_tr_b16 v[34:35], v26 offset:2080
    ds_read_b64_tr_b16 v[36:37], v26 offset:8224
    ds_read_b64_tr_b16 v[38:39], v26 offset:10272
    s_waitcnt lgkmcnt(0)
    v_accvgpr_write_b32 a32, v32
    v_accvgpr_write_b32 a33, v34
    v_accvgpr_write_b32 a34, v33
    v_accvgpr_write_b32 a35, v35
    v_accvgpr_write_b32 a36, v36
    v_accvgpr_write_b32 a37, v38
    v_accvgpr_write_b32 a38, v37
    v_accvgpr_write_b32 a39, v39
    ds_read_b64_tr_b16 v[32:33], v26 offset:16384
    ds_read_b64_tr_b16 v[34:35], v26 offset:18432
    ds_read_b64_tr_b16 v[36:37], v26 offset:24576
    ds_read_b64_tr_b16 v[38:39], v26 offset:26624
    s_waitcnt lgkmcnt(0)
    v_accvgpr_write_b32 a112, v32
    v_accvgpr_write_b32 a113, v34
    v_accvgpr_write_b32 a114, v33
    v_accvgpr_write_b32 a115, v35
    v_accvgpr_write_b32 a116, v36
    v_accvgpr_write_b32 a117, v38
    v_accvgpr_write_b32 a118, v37
    v_accvgpr_write_b32 a119, v39
    ds_read_b64_tr_b16 v[32:33], v26 offset:16416
    ds_read_b64_tr_b16 v[34:35], v26 offset:18464
    ds_read_b64_tr_b16 v[36:37], v26 offset:24608
    ds_read_b64_tr_b16 v[38:39], v26 offset:26656
    s_waitcnt lgkmcnt(0)
    v_accvgpr_write_b32 a192, v32
    v_accvgpr_write_b32 a193, v34
    v_accvgpr_write_b32 a194, v33
    v_accvgpr_write_b32 a195, v35
    v_accvgpr_write_b32 a196, v36
    v_accvgpr_write_b32 a197, v38
    v_accvgpr_write_b32 a198, v37
    v_accvgpr_write_b32 a199, v39
    s_waitcnt vmcnt(24)
    s_barrier
    s_add_u32 s65, s76, 3670016
    s_add_u32 s66, s77, 65536
    s_mov_b32 m0, s66
    s_nop 0
    buffer_load_dwordx4 v24, s[12:15], s65 offen lds
    s_add_u32 s65, s76, 3702784
    s_add_u32 s66, s77, 66560
    s_mov_b32 m0, s66
    s_nop 0
    buffer_load_dwordx4 v24, s[12:15], s65 offen lds
    s_add_u32 s65, s76, 3735552
    s_add_u32 s66, s77, 67584
    s_mov_b32 m0, s66
    s_nop 0
    buffer_load_dwordx4 v24, s[12:15], s65 offen lds
    s_add_u32 s65, s76, 3768320
    s_add_u32 s66, s77, 68608
    s_mov_b32 m0, s66
    s_nop 0
    buffer_load_dwordx4 v24, s[12:15], s65 offen lds
    s_add_u32 s65, s76, 3801088
    s_add_u32 s66, s77, 69632
    s_mov_b32 m0, s66
    s_nop 0
    buffer_load_dwordx4 v24, s[12:15], s65 offen lds
    s_add_u32 s65, s76, 3833856
    s_add_u32 s66, s77, 70656
    s_mov_b32 m0, s66
    s_nop 0
    buffer_load_dwordx4 v24, s[12:15], s65 offen lds
    s_add_u32 s65, s76, 3866624
    s_add_u32 s66, s77, 71680
    s_mov_b32 m0, s66
    s_nop 0
    buffer_load_dwordx4 v24, s[12:15], s65 offen lds
    s_add_u32 s65, s76, 3899392
    s_add_u32 s66, s77, 72704
    s_mov_b32 m0, s66
    s_nop 0
    buffer_load_dwordx4 v24, s[12:15], s65 offen lds
    ds_read_b64_tr_b16 v[32:33], v26 offset:32768
    ds_read_b64_tr_b16 v[34:35], v26 offset:34816
    ds_read_b64_tr_b16 v[36:37], v26 offset:40960
    ds_read_b64_tr_b16 v[38:39], v26 offset:43008
    s_waitcnt lgkmcnt(0)
    v_mov_b32 v216, v32
    v_mov_b32 v217, v34
    v_mov_b32 v218, v33
    v_mov_b32 v219, v35
    v_mov_b32 v220, v36
    v_mov_b32 v221, v38
    v_mov_b32 v222, v37
    v_mov_b32 v223, v39
    ds_read_b64_tr_b16 v[32:33], v26 offset:32800
    ds_read_b64_tr_b16 v[34:35], v26 offset:34848
    ds_read_b64_tr_b16 v[36:37], v26 offset:40992
    ds_read_b64_tr_b16 v[38:39], v26 offset:43040
    s_waitcnt lgkmcnt(0)
    v_accvgpr_write_b32 a40, v32
    v_accvgpr_write_b32 a41, v34
    v_accvgpr_write_b32 a42, v33
    v_accvgpr_write_b32 a43, v35
    v_accvgpr_write_b32 a44, v36
    v_accvgpr_write_b32 a45, v38
    v_accvgpr_write_b32 a46, v37
    v_accvgpr_write_b32 a47, v39
    ds_read_b64_tr_b16 v[32:33], v26 offset:49152
    ds_read_b64_tr_b16 v[34:35], v26 offset:51200
    ds_read_b64_tr_b16 v[36:37], v26 offset:57344
    ds_read_b64_tr_b16 v[38:39], v26 offset:59392
    s_waitcnt lgkmcnt(0)
    v_accvgpr_write_b32 a120, v32
    v_accvgpr_write_b32 a121, v34
    v_accvgpr_write_b32 a122, v33
    v_accvgpr_write_b32 a123, v35
    v_accvgpr_write_b32 a124, v36
    v_accvgpr_write_b32 a125, v38
    v_accvgpr_write_b32 a126, v37
    v_accvgpr_write_b32 a127, v39
    ds_read_b64_tr_b16 v[32:33], v26 offset:49184
    ds_read_b64_tr_b16 v[34:35], v26 offset:51232
    ds_read_b64_tr_b16 v[36:37], v26 offset:57376
    ds_read_b64_tr_b16 v[38:39], v26 offset:59424
    s_waitcnt lgkmcnt(0)
    v_accvgpr_write_b32 a200, v32
    v_accvgpr_write_b32 a201, v34
    v_accvgpr_write_b32 a202, v33
    v_accvgpr_write_b32 a203, v35
    v_accvgpr_write_b32 a204, v36
    v_accvgpr_write_b32 a205, v38
    v_accvgpr_write_b32 a206, v37
    v_accvgpr_write_b32 a207, v39
    s_waitcnt vmcnt(24)
    s_barrier
    s_add_u32 s65, s76, 4194304
    s_add_u32 s66, s77, 98304
    s_mov_b32 m0, s66
    s_nop 0
    buffer_load_dwordx4 v24, s[12:15], s65 offen lds
    s_add_u32 s65, s76, 4227072
    s_add_u32 s66, s77, 99328
    s_mov_b32 m0, s66
    s_nop 0
    buffer_load_dwordx4 v24, s[12:15], s65 offen lds
    s_add_u32 s65, s76, 4259840
    s_add_u32 s66, s77, 100352
    s_mov_b32 m0, s66
    s_nop 0
    buffer_load_dwordx4 v24, s[12:15], s65 offen lds
    s_add_u32 s65, s76, 4292608
    s_add_u32 s66, s77, 101376
    s_mov_b32 m0, s66
    s_nop 0
    buffer_load_dwordx4 v24, s[12:15], s65 offen lds
    s_add_u32 s65, s76, 4325376
    s_add_u32 s66, s77, 102400
    s_mov_b32 m0, s66
    s_nop 0
    buffer_load_dwordx4 v24, s[12:15], s65 offen lds
    s_add_u32 s65, s76, 4358144
    s_add_u32 s66, s77, 103424
    s_mov_b32 m0, s66
    s_nop 0
    buffer_load_dwordx4 v24, s[12:15], s65 offen lds
    s_add_u32 s65, s76, 4390912
    s_add_u32 s66, s77, 104448
    s_mov_b32 m0, s66
    s_nop 0
    buffer_load_dwordx4 v24, s[12:15], s65 offen lds
    s_add_u32 s65, s76, 4423680
    s_add_u32 s66, s77, 105472
    s_mov_b32 m0, s66
    s_nop 0
    buffer_load_dwordx4 v24, s[12:15], s65 offen lds
    ds_read_b64_tr_b16 v[32:33], v27 offset:0
    ds_read_b64_tr_b16 v[34:35], v27 offset:2048
    ds_read_b64_tr_b16 v[36:37], v27 offset:8192
    ds_read_b64_tr_b16 v[38:39], v27 offset:10240
    s_waitcnt lgkmcnt(0)
    v_mov_b32 v224, v32
    v_mov_b32 v225, v34
    v_mov_b32 v226, v33
    v_mov_b32 v227, v35
    v_mov_b32 v228, v36
    v_mov_b32 v229, v38
    v_mov_b32 v230, v37
    v_mov_b32 v231, v39
    ds_read_b64_tr_b16 v[32:33], v27 offset:32
    ds_read_b64_tr_b16 v[34:35], v27 offset:2080
    ds_read_b64_tr_b16 v[36:37], v27 offset:8224
    ds_read_b64_tr_b16 v[38:39], v27 offset:10272
    s_waitcnt lgkmcnt(0)
    v_accvgpr_write_b32 a48, v32
    v_accvgpr_write_b32 a49, v34
    v_accvgpr_write_b32 a50, v33
    v_accvgpr_write_b32 a51, v35
    v_accvgpr_write_b32 a52, v36
    v_accvgpr_write_b32 a53, v38
    v_accvgpr_write_b32 a54, v37
    v_accvgpr_write_b32 a55, v39
    ds_read_b64_tr_b16 v[32:33], v27 offset:16384
    ds_read_b64_tr_b16 v[34:35], v27 offset:18432
    ds_read_b64_tr_b16 v[36:37], v27 offset:24576
    ds_read_b64_tr_b16 v[38:39], v27 offset:26624
    s_waitcnt lgkmcnt(0)
    v_accvgpr_write_b32 a128, v32
    v_accvgpr_write_b32 a129, v34
    v_accvgpr_write_b32 a130, v33
    v_accvgpr_write_b32 a131, v35
    v_accvgpr_write_b32 a132, v36
    v_accvgpr_write_b32 a133, v38
    v_accvgpr_write_b32 a134, v37
    v_accvgpr_write_b32 a135, v39
    ds_read_b64_tr_b16 v[32:33], v27 offset:16416
    ds_read_b64_tr_b16 v[34:35], v27 offset:18464
    ds_read_b64_tr_b16 v[36:37], v27 offset:24608
    ds_read_b64_tr_b16 v[38:39], v27 offset:26656
    s_waitcnt lgkmcnt(0)
    v_accvgpr_write_b32 a208, v32
    v_accvgpr_write_b32 a209, v34
    v_accvgpr_write_b32 a210, v33
    v_accvgpr_write_b32 a211, v35
    v_accvgpr_write_b32 a212, v36
    v_accvgpr_write_b32 a213, v38
    v_accvgpr_write_b32 a214, v37
    v_accvgpr_write_b32 a215, v39
    s_waitcnt vmcnt(24)
    s_barrier
    s_add_u32 s65, s76, 4718592
    s_add_u32 s66, s77, 131072
    s_mov_b32 m0, s66
    s_nop 0
    buffer_load_dwordx4 v24, s[12:15], s65 offen lds
    s_add_u32 s65, s76, 4751360
    s_add_u32 s66, s77, 132096
    s_mov_b32 m0, s66
    s_nop 0
    buffer_load_dwordx4 v24, s[12:15], s65 offen lds
    s_add_u32 s65, s76, 4784128
    s_add_u32 s66, s77, 133120
    s_mov_b32 m0, s66
    s_nop 0
    buffer_load_dwordx4 v24, s[12:15], s65 offen lds
    s_add_u32 s65, s76, 4816896
    s_add_u32 s66, s77, 134144
    s_mov_b32 m0, s66
    s_nop 0
    buffer_load_dwordx4 v24, s[12:15], s65 offen lds
    s_add_u32 s65, s76, 4849664
    s_add_u32 s66, s77, 135168
    s_mov_b32 m0, s66
    s_nop 0
    buffer_load_dwordx4 v24, s[12:15], s65 offen lds
    s_add_u32 s65, s76, 4882432
    s_add_u32 s66, s77, 136192
    s_mov_b32 m0, s66
    s_nop 0
    buffer_load_dwordx4 v24, s[12:15], s65 offen lds
    s_add_u32 s65, s76, 4915200
    s_add_u32 s66, s77, 137216
    s_mov_b32 m0, s66
    s_nop 0
    buffer_load_dwordx4 v24, s[12:15], s65 offen lds
    s_add_u32 s65, s76, 4947968
    s_add_u32 s66, s77, 138240
    s_mov_b32 m0, s66
    s_nop 0
    buffer_load_dwordx4 v24, s[12:15], s65 offen lds
    ds_read_b64_tr_b16 v[32:33], v25 offset:0
    ds_read_b64_tr_b16 v[34:35], v25 offset:2048
    ds_read_b64_tr_b16 v[36:37], v25 offset:8192
    ds_read_b64_tr_b16 v[38:39], v25 offset:10240
    s_waitcnt lgkmcnt(0)
    v_mov_b32 v232, v32
    v_mov_b32 v233, v34
    v_mov_b32 v234, v33
    v_mov_b32 v235, v35
    v_mov_b32 v236, v36
    v_mov_b32 v237, v38
    v_mov_b32 v238, v37
    v_mov_b32 v239, v39
    ds_read_b64_tr_b16 v[32:33], v25 offset:32
    ds_read_b64_tr_b16 v[34:35], v25 offset:2080
    ds_read_b64_tr_b16 v[36:37], v25 offset:8224
    ds_read_b64_tr_b16 v[38:39], v25 offset:10272
    s_waitcnt lgkmcnt(0)
    v_accvgpr_write_b32 a56, v32
    v_accvgpr_write_b32 a57, v34
    v_accvgpr_write_b32 a58, v33
    v_accvgpr_write_b32 a59, v35
    v_accvgpr_write_b32 a60, v36
    v_accvgpr_write_b32 a61, v38
    v_accvgpr_write_b32 a62, v37
    v_accvgpr_write_b32 a63, v39
    ds_read_b64_tr_b16 v[32:33], v25 offset:16384
    ds_read_b64_tr_b16 v[34:35], v25 offset:18432
    ds_read_b64_tr_b16 v[36:37], v25 offset:24576
    ds_read_b64_tr_b16 v[38:39], v25 offset:26624
    s_waitcnt lgkmcnt(0)
    v_accvgpr_write_b32 a136, v32
    v_accvgpr_write_b32 a137, v34
    v_accvgpr_write_b32 a138, v33
    v_accvgpr_write_b32 a139, v35
    v_accvgpr_write_b32 a140, v36
    v_accvgpr_write_b32 a141, v38
    v_accvgpr_write_b32 a142, v37
    v_accvgpr_write_b32 a143, v39
    ds_read_b64_tr_b16 v[32:33], v25 offset:16416
    ds_read_b64_tr_b16 v[34:35], v25 offset:18464
    ds_read_b64_tr_b16 v[36:37], v25 offset:24608
    ds_read_b64_tr_b16 v[38:39], v25 offset:26656
    s_waitcnt lgkmcnt(0)
    v_accvgpr_write_b32 a216, v32
    v_accvgpr_write_b32 a217, v34
    v_accvgpr_write_b32 a218, v33
    v_accvgpr_write_b32 a219, v35
    v_accvgpr_write_b32 a220, v36
    v_accvgpr_write_b32 a221, v38
    v_accvgpr_write_b32 a222, v37
    v_accvgpr_write_b32 a223, v39
    s_waitcnt vmcnt(24)
    s_barrier
    ds_read_b64_tr_b16 v[32:33], v25 offset:32768
    ds_read_b64_tr_b16 v[34:35], v25 offset:34816
    ds_read_b64_tr_b16 v[36:37], v25 offset:40960
    ds_read_b64_tr_b16 v[38:39], v25 offset:43008
    s_waitcnt lgkmcnt(0)
    v_mov_b32 v240, v32
    v_mov_b32 v241, v34
    v_mov_b32 v242, v33
    v_mov_b32 v243, v35
    v_mov_b32 v244, v36
    v_mov_b32 v245, v38
    v_mov_b32 v246, v37
    v_mov_b32 v247, v39
    ds_read_b64_tr_b16 v[32:33], v25 offset:32800
    ds_read_b64_tr_b16 v[34:35], v25 offset:34848
    ds_read_b64_tr_b16 v[36:37], v25 offset:40992
    ds_read_b64_tr_b16 v[38:39], v25 offset:43040
    s_waitcnt lgkmcnt(0)
    v_accvgpr_write_b32 a64, v32
    v_accvgpr_write_b32 a65, v34
    v_accvgpr_write_b32 a66, v33
    v_accvgpr_write_b32 a67, v35
    v_accvgpr_write_b32 a68, v36
    v_accvgpr_write_b32 a69, v38
    v_accvgpr_write_b32 a70, v37
    v_accvgpr_write_b32 a71, v39
    ds_read_b64_tr_b16 v[32:33], v25 offset:49152
    ds_read_b64_tr_b16 v[34:35], v25 offset:51200
    ds_read_b64_tr_b16 v[36:37], v25 offset:57344
    ds_read_b64_tr_b16 v[38:39], v25 offset:59392
    s_waitcnt lgkmcnt(0)
    v_accvgpr_write_b32 a144, v32
    v_accvgpr_write_b32 a145, v34
    v_accvgpr_write_b32 a146, v33
    v_accvgpr_write_b32 a147, v35
    v_accvgpr_write_b32 a148, v36
    v_accvgpr_write_b32 a149, v38
    v_accvgpr_write_b32 a150, v37
    v_accvgpr_write_b32 a151, v39
    ds_read_b64_tr_b16 v[32:33], v25 offset:49184
    ds_read_b64_tr_b16 v[34:35], v25 offset:51232
    ds_read_b64_tr_b16 v[36:37], v25 offset:57376
    ds_read_b64_tr_b16 v[38:39], v25 offset:59424
    s_waitcnt lgkmcnt(0)
    v_accvgpr_write_b32 a224, v32
    v_accvgpr_write_b32 a225, v34
    v_accvgpr_write_b32 a226, v33
    v_accvgpr_write_b32 a227, v35
    v_accvgpr_write_b32 a228, v36
    v_accvgpr_write_b32 a229, v38
    v_accvgpr_write_b32 a230, v37
    v_accvgpr_write_b32 a231, v39
    s_waitcnt vmcnt(16)
    s_barrier
    s_mov_b32 s12, s32
    s_and_b32 s13, s33, 0xffff
    s_mov_b32 s14, 0x500000
    s_mov_b32 s15, 0x20000
    v_lshrrev_b32 v20, 2, v0
    v_lshlrev_b32 v20, 13, v20
    v_and_b32 v21, 3, v0
    v_lshl_add_u32 v20, v21, 4, v20
    s_lshl_b32 s65, s6, 8
    s_lshl_b32 s66, s5, 6
    s_add_u32 s65, s65, s66
    v_add_u32 v24, s65, v20
    s_mul_i32 s76, s4, 1310720
    s_mul_i32 s77, s4, 10240
    s_add_u32 s65, s76, 0
    s_add_u32 s66, s77, 0
    s_mov_b32 m0, s66
    s_nop 0
    buffer_load_dwordx4 v24, s[12:15], s65 offen lds
    s_add_u32 s65, s76, 131072
    s_add_u32 s66, s77, 1024
    s_mov_b32 m0, s66
    s_nop 0
    buffer_load_dwordx4 v24, s[12:15], s65 offen lds
    s_add_u32 s65, s76, 262144
    s_add_u32 s66, s77, 2048
    s_mov_b32 m0, s66
    s_nop 0
    buffer_load_dwordx4 v24, s[12:15], s65 offen lds
    s_add_u32 s65, s76, 393216
    s_add_u32 s66, s77, 3072
    s_mov_b32 m0, s66
    s_nop 0
    buffer_load_dwordx4 v24, s[12:15], s65 offen lds
    s_add_u32 s65, s76, 524288
    s_add_u32 s66, s77, 4096
    s_mov_b32 m0, s66
    s_nop 0
    buffer_load_dwordx4 v24, s[12:15], s65 offen lds
    s_add_u32 s65, s76, 655360
    s_add_u32 s66, s77, 5120
    s_mov_b32 m0, s66
    s_nop 0
    buffer_load_dwordx4 v24, s[12:15], s65 offen lds
    s_add_u32 s65, s76, 786432
    s_add_u32 s66, s77, 6144
    s_mov_b32 m0, s66
    s_nop 0
    buffer_load_dwordx4 v24, s[12:15], s65 offen lds
    s_add_u32 s65, s76, 917504
    s_add_u32 s66, s77, 7168
    s_mov_b32 m0, s66
    s_nop 0
    buffer_load_dwordx4 v24, s[12:15], s65 offen lds
    s_add_u32 s65, s76, 1048576
    s_add_u32 s66, s77, 8192
    s_mov_b32 m0, s66
    s_nop 0
    buffer_load_dwordx4 v24, s[12:15], s65 offen lds
    s_add_u32 s65, s76, 1179648
    s_add_u32 s66, s77, 9216
    s_mov_b32 m0, s66
    s_nop 0
    buffer_load_dwordx4 v24, s[12:15], s65 offen lds
    ds_read_b64_tr_b16 v[32:33], v26 offset:0
    ds_read_b64_tr_b16 v[34:35], v26 offset:2048
    ds_read_b64_tr_b16 v[36:37], v26 offset:8192
    ds_read_b64_tr_b16 v[38:39], v26 offset:10240
    s_waitcnt lgkmcnt(0)
    v_mov_b32 v248, v32
    v_mov_b32 v249, v34
    v_mov_b32 v250, v33
    v_mov_b32 v251, v35
    v_mov_b32 v252, v36
    v_mov_b32 v253, v38
    v_mov_b32 v254, v37
    v_mov_b32 v255, v39
    ds_read_b64_tr_b16 v[32:33], v26 offset:32
    ds_read_b64_tr_b16 v[34:35], v26 offset:2080
    ds_read_b64_tr_b16 v[36:37], v26 offset:8224
    ds_read_b64_tr_b16 v[38:39], v26 offset:10272
    s_waitcnt lgkmcnt(0)
    v_accvgpr_write_b32 a72, v32
    v_accvgpr_write_b32 a73, v34
    v_accvgpr_write_b32 a74, v33
    v_accvgpr_write_b32 a75, v35
    v_accvgpr_write_b32 a76, v36
    v_accvgpr_write_b32 a77, v38
    v_accvgpr_write_b32 a78, v37
    v_accvgpr_write_b32 a79, v39
    ds_read_b64_tr_b16 v[32:33], v26 offset:16384
    ds_read_b64_tr_b16 v[34:35], v26 offset:18432
    ds_read_b64_tr_b16 v[36:37], v26 offset:24576
    ds_read_b64_tr_b16 v[38:39], v26 offset:26624
    s_waitcnt lgkmcnt(0)
    v_accvgpr_write_b32 a152, v32
    v_accvgpr_write_b32 a153, v34
    v_accvgpr_write_b32 a154, v33
    v_accvgpr_write_b32 a155, v35
    v_accvgpr_write_b32 a156, v36
    v_accvgpr_write_b32 a157, v38
    v_accvgpr_write_b32 a158, v37
    v_accvgpr_write_b32 a159, v39
    ds_read_b64_tr_b16 v[32:33], v26 offset:16416
    ds_read_b64_tr_b16 v[34:35], v26 offset:18464
    ds_read_b64_tr_b16 v[36:37], v26 offset:24608
    ds_read_b64_tr_b16 v[38:39], v26 offset:26656
    s_waitcnt lgkmcnt(0)
    v_accvgpr_write_b32 a232, v32
    v_accvgpr_write_b32 a233, v34
    v_accvgpr_write_b32 a234, v33
    v_accvgpr_write_b32 a235, v35
    v_accvgpr_write_b32 a236, v36
    v_accvgpr_write_b32 a237, v38
    v_accvgpr_write_b32 a238, v37
    v_accvgpr_write_b32 a239, v39
    s_waitcnt vmcnt(18)
    s_barrier
    ds_read_b64_tr_b16 v[32:33], v26 offset:32768
    ds_read_b64_tr_b16 v[34:35], v26 offset:34816
    ds_read_b64_tr_b16 v[36:37], v26 offset:40960
    ds_read_b64_tr_b16 v[38:39], v26 offset:43008
    s_waitcnt lgkmcnt(0)
    v_accvgpr_write_b32 a0, v32
    v_accvgpr_write_b32 a1, v34
    v_accvgpr_write_b32 a2, v33
    v_accvgpr_write_b32 a3, v35
    v_accvgpr_write_b32 a4, v36
    v_accvgpr_write_b32 a5, v38
    v_accvgpr_write_b32 a6, v37
    v_accvgpr_write_b32 a7, v39
    ds_read_b64_tr_b16 v[32:33], v26 offset:32800
    ds_read_b64_tr_b16 v[34:35], v26 offset:34848
    ds_read_b64_tr_b16 v[36:37], v26 offset:40992
    ds_read_b64_tr_b16 v[38:39], v26 offset:43040
    s_waitcnt lgkmcnt(0)
    v_accvgpr_write_b32 a80, v32
    v_accvgpr_write_b32 a81, v34
    v_accvgpr_write_b32 a82, v33
    v_accvgpr_write_b32 a83, v35
    v_accvgpr_write_b32 a84, v36
    v_accvgpr_write_b32 a85, v38
    v_accvgpr_write_b32 a86, v37
    v_accvgpr_write_b32 a87, v39
    ds_read_b64_tr_b16 v[32:33], v26 offset:49152
    ds_read_b64_tr_b16 v[34:35], v26 offset:51200
    ds_read_b64_tr_b16 v[36:37], v26 offset:57344
    ds_read_b64_tr_b16 v[38:39], v26 offset:59392
    s_waitcnt lgkmcnt(0)
    v_accvgpr_write_b32 a160, v32
    v_accvgpr_write_b32 a161, v34
    v_accvgpr_write_b32 a162, v33
    v_accvgpr_write_b32 a163, v35
    v_accvgpr_write_b32 a164, v36
    v_accvgpr_write_b32 a165, v38
    v_accvgpr_write_b32 a166, v37
    v_accvgpr_write_b32 a167, v39
    ds_read_b64_tr_b16 v[32:33], v26 offset:49184
    ds_read_b64_tr_b16 v[34:35], v26 offset:51232
    ds_read_b64_tr_b16 v[36:37], v26 offset:57376
    ds_read_b64_tr_b16 v[38:39], v26 offset:59424
    s_waitcnt lgkmcnt(0)
    v_accvgpr_write_b32 a240, v32
    v_accvgpr_write_b32 a241, v34
    v_accvgpr_write_b32 a242, v33
    v_accvgpr_write_b32 a243, v35
    v_accvgpr_write_b32 a244, v36
    v_accvgpr_write_b32 a245, v38
    v_accvgpr_write_b32 a246, v37
    v_accvgpr_write_b32 a247, v39
    s_waitcnt vmcnt(10)
    s_barrier
    s_mov_b32 s12, s34
    s_and_b32 s13, s35, 0xffff
    s_mov_b32 s14, 0x500000
    s_mov_b32 s15, 0x20000
    v_add_u32 v20, 0, v0
    v_mul_u32_u24 v21, 3277, v20
    v_lshrrev_b32 v21, 16, v21
    v_mul_u32_u24 v22, 20, v21
    v_sub_u32 v22, v20, v22
    v_mul_u32_u24 v21, 1280, v21
    v_lshl_add_u32 v40, v22, 4, v21
    v_add_u32 v20, 64, v0
    v_mul_u32_u24 v21, 3277, v20
    v_lshrrev_b32 v21, 16, v21
    v_mul_u32_u24 v22, 20, v21
    v_sub_u32 v22, v20, v22
    v_mul_u32_u24 v21, 1280, v21
    v_lshl_add_u32 v41, v22, 4, v21
    v_add_u32 v20, 128, v0
    v_mul_u32_u24 v21, 3277, v20
    v_lshrrev_b32 v21, 16, v21
    v_mul_u32_u24 v22, 20, v21
    v_sub_u32 v22, v20, v22
    v_mul_u32_u24 v21, 1280, v21
    v_lshl_add_u32 v42, v22, 4, v21
    v_add_u32 v20, 192, v0
    v_mul_u32_u24 v21, 3277, v20
    v_lshrrev_b32 v21, 16, v21
    v_mul_u32_u24 v22, 20, v21
    v_sub_u32 v22, v20, v22
    v_mul_u32_u24 v21, 1280, v21
    v_lshl_add_u32 v43, v22, 4, v21
    v_add_u32 v20, 256, v0
    v_mul_u32_u24 v21, 3277, v20
    v_lshrrev_b32 v21, 16, v21
    v_mul_u32_u24 v22, 20, v21
    v_sub_u32 v22, v20, v22
    v_mul_u32_u24 v21, 1280, v21
    v_lshl_add_u32 v44, v22, 4, v21
    s_lshl_b32 s76, s6, 7
    s_lshl_b32 s65, s4, 5
    s_add_u32 s76, s76, s65
    s_mul_i32 s76, s76, 1280
    s_mul_i32 s65, s5, 320
    s_add_u32 s76, s76, s65
    s_mul_i32 s77, s4, 10240
    s_add_u32 s77, s77, 0x10000
    s_add_u32 s65, s76, 0
    s_add_u32 s66, s77, 0
    s_mov_b32 m0, s66
    s_nop 0
    buffer_load_dwordx4 v40, s[12:15], s65 offen lds
    s_add_u32 s65, s76, 0
    s_add_u32 s66, s77, 1024
    s_mov_b32 m0, s66
    s_nop 0
    buffer_load_dwordx4 v41, s[12:15], s65 offen lds
    s_add_u32 s65, s76, 0
    s_add_u32 s66, s77, 2048
    s_mov_b32 m0, s66
    s_nop 0
    buffer_load_dwordx4 v42, s[12:15], s65 offen lds
    s_add_u32 s65, s76, 0
    s_add_u32 s66, s77, 3072
    s_mov_b32 m0, s66
    s_nop 0
    buffer_load_dwordx4 v43, s[12:15], s65 offen lds
    s_add_u32 s65, s76, 0
    s_add_u32 s66, s77, 4096
    s_mov_b32 m0, s66
    s_nop 0
    buffer_load_dwordx4 v44, s[12:15], s65 offen lds
    s_add_u32 s65, s76, 20480
    s_add_u32 s66, s77, 5120
    s_mov_b32 m0, s66
    s_nop 0
    buffer_load_dwordx4 v40, s[12:15], s65 offen lds
    s_add_u32 s65, s76, 20480
    s_add_u32 s66, s77, 6144
    s_mov_b32 m0, s66
    s_nop 0
    buffer_load_dwordx4 v41, s[12:15], s65 offen lds
    s_add_u32 s65, s76, 20480
    s_add_u32 s66, s77, 7168
    s_mov_b32 m0, s66
    s_nop 0
    buffer_load_dwordx4 v42, s[12:15], s65 offen lds
    s_add_u32 s65, s76, 20480
    s_add_u32 s66, s77, 8192
    s_mov_b32 m0, s66
    s_nop 0
    buffer_load_dwordx4 v43, s[12:15], s65 offen lds
    s_add_u32 s65, s76, 20480
    s_add_u32 s66, s77, 9216
    s_mov_b32 m0, s66
    s_nop 0
    buffer_load_dwordx4 v44, s[12:15], s65 offen lds
    ds_read_b64_tr_b16 v[32:33], v27 offset:0
    ds_read_b64_tr_b16 v[34:35], v27 offset:2048
    ds_read_b64_tr_b16 v[36:37], v27 offset:8192
    ds_read_b64_tr_b16 v[38:39], v27 offset:10240
    s_waitcnt lgkmcnt(0)
    v_accvgpr_write_b32 a8, v32
    v_accvgpr_write_b32 a9, v34
    v_accvgpr_write_b32 a10, v33
    v_accvgpr_write_b32 a11, v35
    v_accvgpr_write_b32 a12, v36
    v_accvgpr_write_b32 a13, v38
    v_accvgpr_write_b32 a14, v37
    v_accvgpr_write_b32 a15, v39
    ds_read_b64_tr_b16 v[32:33], v27 offset:32
    ds_read_b64_tr_b16 v[34:35], v27 offset:2080
    ds_read_b64_tr_b16 v[36:37], v27 offset:8224
    ds_read_b64_tr_b16 v[38:39], v27 offset:10272
    s_waitcnt lgkmcnt(0)
    v_accvgpr_write_b32 a88, v32
    v_accvgpr_write_b32 a89, v34
    v_accvgpr_write_b32 a90, v33
    v_accvgpr_write_b32 a91, v35
    v_accvgpr_write_b32 a92, v36
    v_accvgpr_write_b32 a93, v38
    v_accvgpr_write_b32 a94, v37
    v_accvgpr_write_b32 a95, v39
    ds_read_b64_tr_b16 v[32:33], v27 offset:16384
    ds_read_b64_tr_b16 v[34:35], v27 offset:18432
    ds_read_b64_tr_b16 v[36:37], v27 offset:24576
    ds_read_b64_tr_b16 v[38:39], v27 offset:26624
    s_waitcnt lgkmcnt(0)
    v_accvgpr_write_b32 a168, v32
    v_accvgpr_write_b32 a169, v34
    v_accvgpr_write_b32 a170, v33
    v_accvgpr_write_b32 a171, v35
    v_accvgpr_write_b32 a172, v36
    v_accvgpr_write_b32 a173, v38
    v_accvgpr_write_b32 a174, v37
    v_accvgpr_write_b32 a175, v39
    ds_read_b64_tr_b16 v[32:33], v27 offset:16416
    ds_read_b64_tr_b16 v[34:35], v27 offset:18464
    ds_read_b64_tr_b16 v[36:37], v27 offset:24608
    ds_read_b64_tr_b16 v[38:39], v27 offset:26656
    s_waitcnt lgkmcnt(0)
    v_accvgpr_write_b32 a248, v32
    v_accvgpr_write_b32 a249, v34
    v_accvgpr_write_b32 a250, v33
    v_accvgpr_write_b32 a251, v35
    v_accvgpr_write_b32 a252, v36
    v_accvgpr_write_b32 a253, v38
    v_accvgpr_write_b32 a254, v37
    v_accvgpr_write_b32 a255, v39
    v_mov_b32 v137, 0
    v_mov_b32 v139, 0
    s_waitcnt vmcnt(0) lgkmcnt(0)
    s_barrier
    v_lshlrev_b32 v20, 6, v23
    v_and_b32 v21, 3, v0
    v_lshl_add_u32 v20, v21, 3, v20
    s_lshl_b32 s65, s4, 12
    v_add_u32 v22, s65, v20
    ds_read_b64_tr_b16 v[32:33], v22 offset:0
    ds_read_b64_tr_b16 v[34:35], v22 offset:512
    ds_read_b64_tr_b16 v[36:37], v22 offset:2048
    ds_read_b64_tr_b16 v[38:39], v22 offset:2560
    s_waitcnt lgkmcnt(0)
    v_mov_b32 v144, v32
    v_mov_b32 v145, v34
    v_mov_b32 v146, v33
    v_mov_b32 v147, v35
    v_mov_b32 v148, v36
    v_mov_b32 v149, v38
    v_mov_b32 v150, v37
    v_mov_b32 v151, v39
    ds_read_b64_tr_b16 v[32:33], v22 offset:32
    ds_read_b64_tr_b16 v[34:35], v22 offset:544
    ds_read_b64_tr_b16 v[36:37], v22 offset:2080
    ds_read_b64_tr_b16 v[38:39], v22 offset:2592
    s_waitcnt lgkmcnt(0)
    v_mov_b32 v152, v32
    v_mov_b32 v153, v34
    v_mov_b32 v154, v33
    v_mov_b32 v155, v35
    v_mov_b32 v156, v36
    v_mov_b32 v157, v38
    v_mov_b32 v158, v37
    v_mov_b32 v159, v39
    s_add_u32 s65, s4, 4
    s_lshl_b32 s65, s65, 12
    v_add_u32 v22, s65, v20
    ds_read_b64_tr_b16 v[32:33], v22 offset:0
    ds_read_b64_tr_b16 v[34:35], v22 offset:512
    ds_read_b64_tr_b16 v[36:37], v22 offset:2048
    ds_read_b64_tr_b16 v[38:39], v22 offset:2560
    s_waitcnt lgkmcnt(0)
    v_mov_b32 v160, v32
    v_mov_b32 v161, v34
    v_mov_b32 v162, v33
    v_mov_b32 v163, v35
    v_mov_b32 v164, v36
    v_mov_b32 v165, v38
    v_mov_b32 v166, v37
    v_mov_b32 v167, v39
    ds_read_b64_tr_b16 v[32:33], v22 offset:32
    ds_read_b64_tr_b16 v[34:35], v22 offset:544
    ds_read_b64_tr_b16 v[36:37], v22 offset:2080
    ds_read_b64_tr_b16 v[38:39], v22 offset:2592
    s_waitcnt lgkmcnt(0)
    v_mov_b32 v168, v32
    v_mov_b32 v169, v34
    v_mov_b32 v170, v33
    v_mov_b32 v171, v35
    v_mov_b32 v172, v36
    v_mov_b32 v173, v38
    v_mov_b32 v174, v37
    v_mov_b32 v175, v39
    s_lshl_b32 s65, s64, 12
    v_add_u32 v22, s65, v20
    ds_read_b64_tr_b16 v[32:33], v22 offset:0
    ds_read_b64_tr_b16 v[34:35], v22 offset:512
    ds_read_b64_tr_b16 v[36:37], v22 offset:2048
    ds_read_b64_tr_b16 v[38:39], v22 offset:2560
    s_waitcnt lgkmcnt(0)
    v_mov_b32 v176, v32
    v_mov_b32 v177, v34
    v_mov_b32 v178, v33
    v_mov_b32 v179, v35
    v_mov_b32 v180, v36
    v_mov_b32 v181, v38
    v_mov_b32 v182, v37
    v_mov_b32 v183, v39
    ds_read_b64_tr_b16 v[32:33], v22 offset:32
    ds_read_b64_tr_b16 v[34:35], v22 offset:544
    ds_read_b64_tr_b16 v[36:37], v22 offset:2080
    ds_read_b64_tr_b16 v[38:39], v22 offset:2592
    s_waitcnt lgkmcnt(0)
    v_mov_b32 v184, v32
    v_mov_b32 v185, v34
    v_mov_b32 v186, v33
    v_mov_b32 v187, v35
    v_mov_b32 v188, v36
    v_mov_b32 v189, v38
    v_mov_b32 v190, v37
    v_mov_b32 v191, v39
    s_cmp_lt_u32 s4, 2
    s_cbranch_scc1 L_wv_ok
    v_mov_b32 v176, 0
    v_mov_b32 v177, 0
    v_mov_b32 v178, 0
    v_mov_b32 v179, 0
    v_mov_b32 v180, 0
    v_mov_b32 v181, 0
    v_mov_b32 v182, 0
    v_mov_b32 v183, 0
    v_mov_b32 v184, 0
    v_mov_b32 v185, 0
    v_mov_b32 v186, 0
    v_mov_b32 v187, 0
    v_mov_b32 v188, 0
    v_mov_b32 v189, 0
    v_mov_b32 v190, 0
    v_mov_b32 v191, 0
L_wv_ok:
    v_lshrrev_b32 v20, 4, v0
    v_lshlrev_b32 v20, 2, v20
    v_bfe_u32 v21, v0, 2, 2
    v_add_u32 v20, v20, v21
    v_mul_u32_u24 v20, 320, v20
    v_and_b32 v21, 3, v0
    v_lshl_add_u32 v20, v21, 3, v20
    s_mul_i32 s66, s4, 3
    s_lshl_b32 s67, s4, 1
    s_add_u32 s67, s67, 2
    s_cmp_lt_u32 s4, 2
    s_cselect_b32 s66, s66, s67
    s_lshl_b32 s66, s66, 5
    s_add_u32 s66, s66, 65536
    v_add_u32 v20, s66, v20
    ds_read_b64_tr_b16 v[48:49], v20 offset:0
    ds_read_b64_tr_b16 v[50:51], v20 offset:5120
    ds_read_b64_tr_b16 v[52:53], v20 offset:10240
    ds_read_b64_tr_b16 v[54:55], v20 offset:15360
    ds_read_b64_tr_b16 v[56:57], v20 offset:20480
    ds_read_b64_tr_b16 v[58:59], v20 offset:25600
    ds_read_b64_tr_b16 v[60:61], v20 offset:30720
    ds_read_b64_tr_b16 v[62:63], v20 offset:35840
    s_waitcnt lgkmcnt(0)
    ds_read_b64_tr_b16 v[64:65], v20 offset:32
    ds_read_b64_tr_b16 v[66:67], v20 offset:5152
    ds_read_b64_tr_b16 v[68:69], v20 offset:10272
    ds_read_b64_tr_b16 v[70:71], v20 offset:15392
    ds_read_b64_tr_b16 v[72:73], v20 offset:20512
    ds_read_b64_tr_b16 v[74:75], v20 offset:25632
    ds_read_b64_tr_b16 v[76:77], v20 offset:30752
    ds_read_b64_tr_b16 v[78:79], v20 offset:35872
    s_waitcnt lgkmcnt(0)
    ds_read_b64_tr_b16 v[80:81], v20 offset:64
    ds_read_b64_tr_b16 v[82:83], v20 offset:5184
    ds_read_b64_tr_b16 v[84:85], v20 offset:10304
    ds_read_b64_tr_b16 v[86:87], v20 offset:15424
    ds_read_b64_tr_b16 v[88:89], v20 offset:20544
    ds_read_b64_tr_b16 v[90:91], v20 offset:25664
    ds_read_b64_tr_b16 v[92:93], v20 offset:30784
    ds_read_b64_tr_b16 v[94:95], v20 offset:35904
    s_waitcnt lgkmcnt(0)
    s_barrier
    ds_write_b128 v4, v[48:51] offset:0
    ds_write_b128 v4, v[52:55] offset:1024
    ds_write_b128 v4, v[56:59] offset:2048
    ds_write_b128 v4, v[60:63] offset:3072
    ds_write_b128 v4, v[64:67] offset:4096
    ds_write_b128 v4, v[68:71] offset:5120
    ds_write_b128 v4, v[72:75] offset:6144
    ds_write_b128 v4, v[76:79] offset:7168
    s_cmp_ge_u32 s4, 2
    s_cbranch_scc1 L_wo_done
    ds_write_b128 v4, v[80:83] offset:8192
    ds_write_b128 v4, v[84:87] offset:9216
    ds_write_b128 v4, v[88:91] offset:10240
    ds_write_b128 v4, v[92:95] offset:11264
L_wo_done:
    s_waitcnt lgkmcnt(0)
    s_barrier
L_cbar:
    v_mov_b32 v20, 32
    global_load_dwordx2 v[22:23], v20, s[42:43] sc1
    s_waitcnt vmcnt(0)
    v_readfirstlane_b32 s65, v22
    v_readfirstlane_b32 s66, v23
    global_load_dword v24, v20, s[42:43] offset:64 sc1
    s_waitcnt vmcnt(0)
    v_readfirstlane_b32 s67, v24
    s_cmp_ge_u32 s67, 128
    s_cselect_b32 s65, s65, 0
    s_cmp_ge_u32 s65, 128
    s_cbranch_scc1 L_cbar_ok
    s_cmp_eq_u32 s46, 0
    s_cbranch_scc1 L_cbar_ok
    s_sub_u32 s46, s46, 1
    s_branch L_cbar
L_cbar_ok:
    s_cmp_eq_u32 s66, 2
    s_cselect_b32 s65, 0x2000, 0
    s_add_u32 s47, s73, s65
    s_mov_b32 s63, 0
    s_mov_b32 s7, 0
    s_mov_b32 s79, 0
    s_mul_i32 s59, s6, 1572864
    s_cmp_gt_u32 s63, s79
    s_cbranch_scc1 L_pw_ok_pro
    s_lshl_b32 s78, s6, 9
    s_add_u32 s78, s78, 72220672
L_pw_pro:
    v_mov_b32 v20, 0
    buffer_load_dword v24, v20, s[8:11], s78 offen sc1
    buffer_load_dword v25, v20, s[8:11], s78 offen offset:128 sc1
    buffer_load_dword v26, v20, s[8:11], s78 offen offset:256 sc1
    s_waitcnt vmcnt(0)
    v_min3_u32 v24, v24, v25, v26
    s_nop 0
    v_readfirstlane_b32 s63, v24
    s_cmp_gt_u32 s63, s79
    s_cbranch_scc1 L_pw_ok_pro
    s_cmp_eq_u32 s46, 0
    s_cbranch_scc1 L_pw_ok_pro
    s_sub_u32 s46, s46, 1
    s_branch L_pw_pro
L_pw_ok_pro:
    v_mov_b32 v92, 0
    v_mov_b32 v93, 0
    v_mov_b32 v94, 0
    v_mov_b32 v95, 0
    ds_write_b128 v1, v[92:95] offset:24576
    ds_write_b128 v1, v[92:95] offset:0x4800
    s_waitcnt lgkmcnt(0)
    s_mov_b32 s74, 0
    s_mov_b32 s100, 0
    s_mov_b32 s101, 0
    s_mov_b32 s99, 0x7ff00000
    v_mov_b32 v0, v1
    s_cmp_eq_u32 s4, 1
    s_cbranch_scc1 L_start_1
    s_cmp_eq_u32 s4, 2
    s_cbranch_scc1 L_start_2
    s_cmp_eq_u32 s4, 3
    s_cbranch_scc1 L_start_3
L_start_0:
    s_add_u32 s65, s59, 8192
    s_add_u32 m0, s74, 28672
    s_nop 0
    buffer_load_dwordx4 v140, s[8:11], s65 offen sc1 lds
    s_add_u32 s65, s59, 10240
    s_add_u32 m0, s74, 29696
    s_nop 0
    buffer_load_dwordx4 v140, s[8:11], s65 offen sc1 lds
    s_add_u32 s65, s59, 12288
    s_add_u32 m0, s74, 30720
    s_nop 0
    buffer_load_dwordx4 v140, s[8:11], s65 offen sc1 lds
    s_add_u32 s65, s59, 14336
    s_add_u32 m0, s74, 31744
    s_nop 0
    buffer_load_dwordx4 v140, s[8:11], s65 offen sc1 lds
    s_add_u32 s65, s59, 8256
    s_add_u32 m0, s74, 32768
    s_nop 0
    buffer_load_dwordx4 v140, s[8:11], s65 offen sc1 lds
    s_waitcnt vmcnt(0)
    s_barrier
L_step_0:
    s_mul_i32 s65, s7, 10240
    s_add_u32 s65, s65, 0x2000
    s_lshl_b32 s66, s4, 10
    s_add_u32 s66, s66, s65
    s_and_b32 s68, s66, 0xffffe000
    s_add_u32 s48, s66, s68
    s_add_u32 s48, s48, s47
    s_add_u32 s66, s66, 4096
    s_and_b32 s68, s66, 0xffffe000
    s_add_u32 s49, s66, s68
    s_add_u32 s49, s49, s47
    s_lshl_b32 s66, s64, 10
    s_add_u32 s66, s66, s65
    s_and_b32 s68, s66, 0xffffe000
    s_add_u32 s50, s66, s68
    s_add_u32 s50, s50, s47
    s_lshl_b32 s66, s75, 7
    s_add_u32 s66, s66, s65
    s_add_u32 s66, s66, 10240
    s_and_b32 s68, s66, 0xffffe000
    s_add_u32 s51, s66, s68
    s_add_u32 s51, s51, s47
    s_and_b32 s65, s7, 3
    s_lshl_b32 s65, s65, 5
    s_add_u32 s65, s65, s6
    s_lshl_b32 s65, s65, 11
    s_add_u32 s65, s65, 663552
    s_lshl_b32 s66, s5, 9
    s_add_u32 s66, s66, s65
    s_and_b32 s68, s66, 0xffffe000
    s_add_u32 s52, s66, s68
    s_add_u32 s52, s52, s47
    s_lshl_b32 s66, s4, 9
    s_add_u32 s66, s66, s65
    s_and_b32 s68, s66, 0xffffe000
    s_add_u32 s53, s66, s68
    s_add_u32 s53, s53, s47
    s_add_u32 s65, s7, 2
    s_and_b32 s65, s65, 3
    s_lshl_b32 s65, s65, 5
    s_add_u32 s65, s65, s6
    s_lshl_b32 s65, s65, 11
    s_add_u32 s65, s65, 663552
    s_lshl_b32 s66, s5, 9
    s_add_u32 s66, s66, s65
    s_and_b32 s68, s66, 0xffffe000
    s_add_u32 s54, s66, s68
    s_add_u32 s54, s54, s47
    s_and_b32 s65, s7, 1
    s_sub_u32 s61, 2, s65
    s_add_u32 s62, s65, 1
    s_lshl_b32 s65, s6, 6
    s_add_u32 s65, s65, s7
    s_lshl_b32 s66, s65, 13
    s_lshl_b32 s67, s5, 7
    s_add_u32 s66, s66, s67
    s_add_u32 s60, s66, 50331648
    s_add_u32 s65, s65, 1
    s_mul_i32 s59, s65, 24576
    s_add_u32 s98, s7, 1
    ds_read_b128 v[96:99], v0 offset:28672
    ds_read_b128 v[100:103], v0 offset:29696
    ds_read_b128 v[104:107], v0 offset:30720
    ds_read_b128 v[108:111], v0 offset:31744
    ds_read_b128 v[112:115], v0 offset:32768
    ds_read_b128 v[116:119], v0 offset:33792
    ds_read_b128 v[120:123], v0 offset:34816
    ds_read_b128 v[124:127], v0 offset:35840
    ds_read_b128 v[128:131], v0 offset:36864
    ds_read_b128 v[132:135], v0 offset:37888
    v_mov_b32 v72, 0
    v_mov_b32 v73, 0
    v_mov_b32 v74, 0
    v_mov_b32 v75, 0
    v_mov_b32 v76, 0
    v_mov_b32 v77, 0
    v_mov_b32 v78, 0
    v_mov_b32 v79, 0
    v_mov_b32 v80, 0
    v_mov_b32 v81, 0
    v_mov_b32 v82, 0
    v_mov_b32 v83, 0
    v_mov_b32 v84, 0
    v_mov_b32 v85, 0
    v_mov_b32 v86, 0
    v_mov_b32 v87, 0
    v_mov_b32 v88, 0
    v_mov_b32 v89, 0
    v_mov_b32 v90, 0
    v_mov_b32 v91, 0
    v_mov_b32 v92, 0
    v_mov_b32 v93, 0
    v_mov_b32 v94, 0
    v_mov_b32 v95, 0
    s_add_u32 s79, s7, 1
    s_and_b32 s74, s79, 1
    s_lshl_b32 s74, s74, 16
    s_min_u32 s79, s79, 63
    s_cmp_gt_u32 s63, s79
    s_cbranch_scc1 L_pw_ok_st_0
    s_lshl_b32 s78, s6, 9
    s_add_u32 s78, s78, 72220672
L_pw_st_0:
    v_mov_b32 v20, 0
    buffer_load_dword v24, v20, s[8:11], s78 offen sc1
    buffer_load_dword v25, v20, s[8:11], s78 offen offset:128 sc1
    buffer_load_dword v26, v20, s[8:11], s78 offen offset:256 sc1
    s_waitcnt vmcnt(0)
    v_min3_u32 v24, v24, v25, v26
    s_nop 0
    v_readfirstlane_b32 s63, v24
    s_cmp_gt_u32 s63, s79
    s_cbranch_scc1 L_pw_ok_st_0
    s_cmp_eq_u32 s46, 0
    s_cbranch_scc1 L_pw_ok_st_0
    s_sub_u32 s46, s46, 1
    s_branch L_pw_st_0
L_pw_ok_st_0:
    s_cmp_eq_u32 s7, 0
    s_cbranch_scc1 L_first_0
    s_mul_i32 s65, s5, 1280
    s_add_u32 s65, s65, s47
    s_add_u32 s65, s65, 1024
    v_lshrrev_b32 v36, 4, v1
    v_min_u32 v36, 19, v36
    v_mul_u32_u24 v36, 64, v36
L_lfpoll_0:
    buffer_load_dword v37, v36, s[8:11], s65 offen sc1
    s_nop 2
    v_mov_b32 v139, v139
    s_nop 2
    v_mov_b32 v139, v139
    s_nop 2
    v_mov_b32 v139, v139
    s_waitcnt vmcnt(0)
    v_cmp_gt_u32 vcc, s7, v37
    s_cbranch_vccz L_lfok_0
    s_cmp_eq_u32 s46, 0
    s_cbranch_scc1 L_lfok_0
    s_sub_u32 s46, s46, 1
    s_branch L_lfpoll_0
L_lfok_0:
    s_barrier
    s_sleep 1
L_agstart_0:
L_agpoll_0:
    buffer_load_dwordx4 v[20:23], v1, s[8:11], s48 offen sc1
    buffer_load_dwordx4 v[24:27], v1, s[8:11], s49 offen sc1
    buffer_load_dwordx4 v[28:31], v1, s[8:11], s50 offen sc1
    s_nop 2
    v_mov_b32 v139, v139
    s_nop 2
    v_mov_b32 v139, v139
    s_nop 2
    v_mov_b32 v139, v139
    s_nop 2
    v_mov_b32 v139, v139
    s_nop 2
    v_mov_b32 v139, v139
    s_nop 2
    v_mov_b32 v139, v139
    s_nop 2
    v_mov_b32 v139, v139
    s_nop 2
    v_mov_b32 v139, v139
    s_nop 2
    v_mov_b32 v139, v139
    s_waitcnt vmcnt(0)
    v_max3_u32 v36, v20, v21, v22
    v_max3_u32 v37, v23, v24, v25
    v_max3_u32 v38, v26, v27, v28
    v_max3_u32 v39, v29, v30, v31
    v_max3_u32 v36, v36, v37, v38
    v_max_u32 v36, v36, v39
    v_cmp_eq_u32 vcc, -1, v36
    s_cbranch_vccz L_agokA_0
    s_cmp_eq_u32 s46, 0
    s_cbranch_scc1 L_agokA_0
    s_sub_u32 s46, s46, 1
    s_branch L_agpoll_0
    buffer_load_dwordx4 v[20:23], v1, s[8:11], s48 offen sc1
    buffer_load_dwordx4 v[24:27], v1, s[8:11], s49 offen sc1
    buffer_load_dwordx4 v[28:31], v1, s[8:11], s50 offen sc1
    s_nop 2
    v_mov_b32 v139, v139
    s_nop 2
    v_mov_b32 v139, v139
    s_nop 2
    v_mov_b32 v139, v139
    s_nop 2
    v_mov_b32 v139, v139
    s_nop 2
    v_mov_b32 v139, v139
    s_nop 2
    v_mov_b32 v139, v139
    buffer_load_dwordx4 v[32:35], v1, s[8:11], s48 offen sc1
    buffer_load_dwordx4 v[48:51], v1, s[8:11], s49 offen sc1
    buffer_load_dwordx4 v[64:67], v1, s[8:11], s50 offen sc1
L_agpoll_0x:
    s_nop 2
    v_mov_b32 v139, v139
    s_nop 2
    v_mov_b32 v139, v139
    s_nop 2
    v_mov_b32 v139, v139
    s_nop 2
    v_mov_b32 v139, v139
    s_nop 2
    v_mov_b32 v139, v139
    s_nop 2
    v_mov_b32 v139, v139
    s_nop 2
    v_mov_b32 v139, v139
    s_nop 2
    v_mov_b32 v139, v139
    s_nop 2
    v_mov_b32 v139, v139
    s_waitcnt vmcnt(3)
    v_max3_u32 v36, v20, v21, v22
    v_max3_u32 v37, v23, v24, v25
    v_max3_u32 v38, v26, v27, v28
    v_max3_u32 v39, v29, v30, v31
    v_max3_u32 v36, v36, v37, v38
    v_max_u32 v36, v36, v39
    v_cmp_eq_u32 vcc, -1, v36
    s_cbranch_vccz L_agokA_0
    buffer_load_dwordx4 v[20:23], v1, s[8:11], s48 offen sc1
    buffer_load_dwordx4 v[24:27], v1, s[8:11], s49 offen sc1
    buffer_load_dwordx4 v[28:31], v1, s[8:11], s50 offen sc1
    s_nop 2
    v_mov_b32 v139, v139
    s_nop 2
    v_mov_b32 v139, v139
    s_nop 2
    v_mov_b32 v139, v139
    s_nop 2
    v_mov_b32 v139, v139
    s_nop 2
    v_mov_b32 v139, v139
    s_nop 2
    v_mov_b32 v139, v139
    s_nop 2
    v_mov_b32 v139, v139
    s_nop 2
    v_mov_b32 v139, v139
    s_nop 2
    v_mov_b32 v139, v139
    s_waitcnt vmcnt(3)
    v_max3_u32 v36, v32, v33, v34
    v_max3_u32 v37, v35, v48, v49
    v_max3_u32 v38, v50, v51, v64
    v_max3_u32 v39, v65, v66, v67
    v_max3_u32 v36, v36, v37, v38
    v_max_u32 v36, v36, v39
    v_cmp_eq_u32 vcc, -1, v36
    s_cbranch_vccz L_agokB_0
    buffer_load_dwordx4 v[32:35], v1, s[8:11], s48 offen sc1
    buffer_load_dwordx4 v[48:51], v1, s[8:11], s49 offen sc1
    buffer_load_dwordx4 v[64:67], v1, s[8:11], s50 offen sc1
    s_cmp_eq_u32 s46, 0
    s_cbranch_scc1 L_agokB_0
    s_sub_u32 s46, s46, 1
    s_branch L_agpoll_0x
L_first_0:
    s_mov_b32 s12, s26
    s_and_b32 s13, s27, 0xffff
    s_mov_b32 s14, 0x2800
    s_mov_b32 s15, 0x20000
    v_bfe_u32 v36, v1, 4, 3
    v_mul_u32_u24 v36, 1280, v36
    v_lshrrev_b32 v37, 7, v1
    v_lshl_add_u32 v36, v37, 4, v36
    buffer_load_dwordx4 v[20:23], v36, s[12:15], 0 offen offset:0
    buffer_load_dwordx4 v[24:27], v36, s[12:15], 0 offen offset:512
    buffer_load_dwordx4 v[28:31], v36, s[12:15], 0 offen offset:1024
    s_waitcnt vmcnt(0)
L_agokA_0:
    v_smfmac_f32_16x16x64_bf16 v[88:91], v[20:23], v[144:151], v5
    ds_write_b128 v1, v[20:23] offset:0
    v_smfmac_f32_16x16x64_bf16 v[92:95], v[20:23], v[152:159], v5
    ds_write_b128 v1, v[24:27] offset:4096
    v_smfmac_f32_16x16x64_bf16 v[88:91], v[24:27], v[160:167], v5
    ds_write_b128 v1, v[28:31] offset:8192
    v_smfmac_f32_16x16x64_bf16 v[92:95], v[24:27], v[168:175], v5
    v_smfmac_f32_16x16x64_bf16 v[88:91], v[28:31], v[176:183], v5
    v_smfmac_f32_16x16x64_bf16 v[92:95], v[28:31], v[184:191], v5
    v_smfmac_f32_16x16x64_bf16 v[72:75], v[20:23], v[192:199], v5
    v_smfmac_f32_16x16x64_bf16 v[76:79], v[20:23], a[96:103], v5
    v_smfmac_f32_16x16x64_bf16 v[80:83], v[20:23], a[16:23], v5
    v_permlane32_swap_b32 v88, v92
    v_smfmac_f32_16x16x64_bf16 v[84:87], v[20:23], a[176:183], v5
    v_permlane32_swap_b32 v89, v93
    v_smfmac_f32_16x16x64_bf16 v[72:75], v[24:27], v[224:231], v5
    v_permlane32_swap_b32 v90, v94
    v_smfmac_f32_16x16x64_bf16 v[76:79], v[24:27], a[128:135], v5
    v_permlane32_swap_b32 v91, v95
    v_smfmac_f32_16x16x64_bf16 v[80:83], v[24:27], a[48:55], v5
    v_add_f32 v88, v88, v92
    v_smfmac_f32_16x16x64_bf16 v[84:87], v[24:27], a[208:215], v5
    v_add_f32 v89, v89, v93
    v_smfmac_f32_16x16x64_bf16 v[72:75], v[28:31], a[0:7], v5
    v_add_f32 v90, v90, v94
    v_smfmac_f32_16x16x64_bf16 v[76:79], v[28:31], a[160:167], v5
    v_add_f32 v91, v91, v95
    ds_write_b128 v9, v[88:91] offset:24576
    s_waitcnt vmcnt(0) lgkmcnt(0)
    s_barrier
    ds_read_b128 v[36:39], v1 offset:1024
    ds_read_b128 v[40:43], v1 offset:2048
    ds_read_b128 v[44:47], v1 offset:3072
    ds_read_b128 v[52:55], v1 offset:5120
    ds_read_b128 v[56:59], v1 offset:6144
    ds_read_b128 v[60:63], v1 offset:7168
    ds_read_b128 v[68:71], v1 offset:9216
    v_smfmac_f32_16x16x64_bf16 v[80:83], v[28:31], a[80:87], v5
    v_smfmac_f32_16x16x64_bf16 v[84:87], v[28:31], a[240:247], v5
    s_branch L_join_0
L_agokB_0:
    v_smfmac_f32_16x16x64_bf16 v[88:91], v[32:35], v[144:151], v5
    ds_write_b128 v1, v[32:35] offset:0
    v_smfmac_f32_16x16x64_bf16 v[92:95], v[32:35], v[152:159], v5
    ds_write_b128 v1, v[48:51] offset:4096
    v_smfmac_f32_16x16x64_bf16 v[88:91], v[48:51], v[160:167], v5
    ds_write_b128 v1, v[64:67] offset:8192
    v_smfmac_f32_16x16x64_bf16 v[92:95], v[48:51], v[168:175], v5
    v_smfmac_f32_16x16x64_bf16 v[88:91], v[64:67], v[176:183], v5
    v_smfmac_f32_16x16x64_bf16 v[92:95], v[64:67], v[184:191], v5
    v_smfmac_f32_16x16x64_bf16 v[72:75], v[32:35], v[192:199], v5
    v_smfmac_f32_16x16x64_bf16 v[76:79], v[32:35], a[96:103], v5
    v_smfmac_f32_16x16x64_bf16 v[80:83], v[32:35], a[16:23], v5
    v_permlane32_swap_b32 v88, v92
    v_smfmac_f32_16x16x64_bf16 v[84:87], v[32:35], a[176:183], v5
    v_permlane32_swap_b32 v89, v93
    v_smfmac_f32_16x16x64_bf16 v[72:75], v[48:51], v[224:231], v5
    v_permlane32_swap_b32 v90, v94
    v_smfmac_f32_16x16x64_bf16 v[76:79], v[48:51], a[128:135], v5
    v_permlane32_swap_b32 v91, v95
    v_smfmac_f32_16x16x64_bf16 v[80:83], v[48:51], a[48:55], v5
    v_add_f32 v88, v88, v92
    v_smfmac_f32_16x16x64_bf16 v[84:87], v[48:51], a[208:215], v5
    v_add_f32 v89, v89, v93
    v_smfmac_f32_16x16x64_bf16 v[72:75], v[64:67], a[0:7], v5
    v_add_f32 v90, v90, v94
    v_smfmac_f32_16x16x64_bf16 v[76:79], v[64:67], a[160:167], v5
    v_add_f32 v91, v91, v95
    ds_write_b128 v9, v[88:91] offset:24576
    s_waitcnt vmcnt(0) lgkmcnt(0)
    s_barrier
    ds_read_b128 v[36:39], v1 offset:1024
    ds_read_b128 v[40:43], v1 offset:2048
    ds_read_b128 v[44:47], v1 offset:3072
    ds_read_b128 v[52:55], v1 offset:5120
    ds_read_b128 v[56:59], v1 offset:6144
    ds_read_b128 v[60:63], v1 offset:7168
    ds_read_b128 v[68:71], v1 offset:9216
    v_smfmac_f32_16x16x64_bf16 v[80:83], v[64:67], a[80:87], v5
    v_smfmac_f32_16x16x64_bf16 v[84:87], v[64:67], a[240:247], v5
L_join_0:
    s_waitcnt lgkmcnt(6)
    v_smfmac_f32_16x16x64_bf16 v[72:75], v[36:39], v[200:207], v5
    v_smfmac_f32_16x16x64_bf16 v[76:79], v[36:39], a[104:111], v5
    s_waitcnt lgkmcnt(5)
    v_smfmac_f32_16x16x64_bf16 v[72:75], v[40:43], v[208:215], v5
    v_smfmac_f32_16x16x64_bf16 v[76:79], v[40:43], a[112:119], v5
    s_waitcnt lgkmcnt(4)
    v_smfmac_f32_16x16x64_bf16 v[72:75], v[44:47], v[216:223], v5
    v_smfmac_f32_16x16x64_bf16 v[76:79], v[44:47], a[120:127], v5
    s_waitcnt lgkmcnt(3)
    v_smfmac_f32_16x16x64_bf16 v[72:75], v[52:55], v[232:239], v5
    v_smfmac_f32_16x16x64_bf16 v[76:79], v[52:55], a[136:143], v5
    s_waitcnt lgkmcnt(2)
    v_smfmac_f32_16x16x64_bf16 v[72:75], v[56:59], v[240:247], v5
    v_smfmac_f32_16x16x64_bf16 v[76:79], v[56:59], a[144:151], v5
    s_waitcnt lgkmcnt(1)
    v_smfmac_f32_16x16x64_bf16 v[72:75], v[60:63], v[248:255], v5
    v_smfmac_f32_16x16x64_bf16 v[76:79], v[60:63], a[152:159], v5
    s_waitcnt lgkmcnt(0)
    v_smfmac_f32_16x16x64_bf16 v[72:75], v[68:71], a[8:15], v5
    v_smfmac_f32_16x16x64_bf16 v[76:79], v[68:71], a[168:175], v5
    v_smfmac_f32_16x16x64_bf16 v[80:83], v[36:39], a[24:31], v5
    v_smfmac_f32_16x16x64_bf16 v[84:87], v[36:39], a[184:191], v5
    s_add_u32 s65, s59, 8192
    s_add_u32 m0, s74, 28672
    s_nop 0
    buffer_load_dwordx4 v140, s[8:11], s65 offen sc1 lds
    v_smfmac_f32_16x16x64_bf16 v[80:83], v[40:43], a[32:39], v5
    s_add_u32 s65, s59, 10240
    s_add_u32 m0, s74, 29696
    s_nop 0
    buffer_load_dwordx4 v140, s[8:11], s65 offen sc1 lds
    v_smfmac_f32_16x16x64_bf16 v[84:87], v[40:43], a[192:199], v5
    s_add_u32 s65, s59, 12288
    s_add_u32 m0, s74, 30720
    s_nop 0
    buffer_load_dwordx4 v140, s[8:11], s65 offen sc1 lds
    v_smfmac_f32_16x16x64_bf16 v[80:83], v[44:47], a[40:47], v5
    s_add_u32 s65, s59, 14336
    s_add_u32 m0, s74, 31744
    s_nop 0
    buffer_load_dwordx4 v140, s[8:11], s65 offen sc1 lds
    v_smfmac_f32_16x16x64_bf16 v[84:87], v[44:47], a[200:207], v5
    v_permlane32_swap_b32 v72, v76
    v_smfmac_f32_16x16x64_bf16 v[80:83], v[52:55], a[56:63], v5
    v_permlane32_swap_b32 v73, v77
    v_smfmac_f32_16x16x64_bf16 v[84:87], v[52:55], a[216:223], v5
    v_permlane32_swap_b32 v74, v78
    v_smfmac_f32_16x16x64_bf16 v[80:83], v[56:59], a[64:71], v5
    v_permlane32_swap_b32 v75, v79
    v_smfmac_f32_16x16x64_bf16 v[84:87], v[56:59], a[224:231], v5
    v_add_f32 v72, v72, v76
    v_smfmac_f32_16x16x64_bf16 v[80:83], v[60:63], a[72:79], v5
    v_add_f32 v73, v73, v77
    v_smfmac_f32_16x16x64_bf16 v[84:87], v[60:63], a[232:239], v5
    v_add_f32 v74, v74, v78
    v_smfmac_f32_16x16x64_bf16 v[80:83], v[68:71], a[88:95], v5
    v_add_f32 v75, v75, v79
    v_smfmac_f32_16x16x64_bf16 v[84:87], v[68:71], a[248:255], v5
    v_cvt_pk_bf16_f32 v76, v72, v73
    v_cvt_pk_bf16_f32 v77, v74, v75
    ds_write_b32 v3, v76 offset:0
    ds_write_b32 v143, v77 offset:0
    s_nop 3
    v_permlane32_swap_b32 v80, v84
    v_permlane32_swap_b32 v81, v85
    v_permlane32_swap_b32 v82, v86
    v_permlane32_swap_b32 v83, v87
    v_add_f32 v80, v80, v84
    v_add_f32 v81, v81, v85
    v_add_f32 v82, v82, v86
    v_add_f32 v83, v83, v87
    v_cvt_pk_bf16_f32 v84, v80, v81
    v_cvt_pk_bf16_f32 v85, v82, v83
    ds_write_b32 v3, v84 offset:512
    ds_write_b32 v143, v85 offset:512
    v_mov_b32 v136, -1
    v_mov_b32 v138, -1
    buffer_load_dword v136, v8, s[8:11], s53 offen sc1
    buffer_load_dword v138, v8, s[8:11], s53 offen offset:256 sc1
    s_waitcnt lgkmcnt(0)
    s_barrier
    ds_read_b64_tr_b16 v[32:33], v2 offset:0
    ds_read_b64_tr_b16 v[34:35], v2 offset:256
    ds_read_b64_tr_b16 v[48:49], v2 offset:4096
    ds_read_b64_tr_b16 v[50:51], v2 offset:4352
    ds_read_b64_tr_b16 v[36:37], v2 offset:1024
    ds_read_b64_tr_b16 v[38:39], v2 offset:1280
    ds_read_b64_tr_b16 v[52:53], v2 offset:5120
    ds_read_b64_tr_b16 v[54:55], v2 offset:5376
    ds_read_b64_tr_b16 v[40:41], v2 offset:2048
    ds_read_b64_tr_b16 v[42:43], v2 offset:2304
    ds_read_b64_tr_b16 v[56:57], v2 offset:6144
    ds_read_b64_tr_b16 v[58:59], v2 offset:6400
    ds_read_b64_tr_b16 v[44:45], v2 offset:3072
    ds_read_b64_tr_b16 v[46:47], v2 offset:3328
    ds_read_b64_tr_b16 v[60:61], v2 offset:7168
    ds_read_b64_tr_b16 v[62:63], v2 offset:7424
    s_waitcnt lgkmcnt(12)
    v_mfma_f32_16x16x32_bf16 v[68:71], v[96:99], v[32:35], 0
    ds_read_b128 v[20:23], v9 offset:20480
    v_mfma_f32_16x16x32_bf16 v[72:75], v[112:115], v[32:35], 0
    v_mfma_f32_16x16x32_bf16 v[64:67], v[48:51], v[32:35], 0
    s_waitcnt lgkmcnt(9)
    v_mfma_f32_16x16x32_bf16 v[68:71], v[100:103], v[36:39], v[68:71]
    v_mfma_f32_16x16x32_bf16 v[72:75], v[116:119], v[36:39], v[72:75]
    v_mfma_f32_16x16x32_bf16 v[64:67], v[52:55], v[36:39], v[64:67]
    s_waitcnt lgkmcnt(5)
    v_mfma_f32_16x16x32_bf16 v[68:71], v[104:107], v[40:43], v[68:71]
    v_mfma_f32_16x16x32_bf16 v[72:75], v[120:123], v[40:43], v[72:75]
    v_mfma_f32_16x16x32_bf16 v[64:67], v[56:59], v[40:43], v[64:67]
    s_waitcnt lgkmcnt(1)
    v_mfma_f32_16x16x32_bf16 v[68:71], v[108:111], v[44:47], v[68:71]
    v_mfma_f32_16x16x32_bf16 v[72:75], v[124:127], v[44:47], v[72:75]
    v_mfma_f32_16x16x32_bf16 v[64:67], v[60:63], v[44:47], v[64:67]
    s_waitcnt lgkmcnt(0)
    buffer_store_dwordx4 v[20:23], v7, s[8:11], s99 offen sc1
    s_nop 0
    v_pk_fma_f32 v[68:69], v[68:69], s[70:71], v[10:11]
    s_nop 0
    v_pk_fma_f32 v[70:71], v[70:71], s[70:71], v[12:13]
    s_nop 0
    v_pk_fma_f32 v[72:73], v[72:73], s[70:71], v[14:15]
    v_pk_fma_f32 v[74:75], v[74:75], s[70:71], v[16:17]
    v_pk_mul_f32 v[64:65], v[64:65], s[70:71]
    v_max3_f32 v76, v68, v69, v70
    v_max3_f32 v77, v71, v72, v73
    v_max3_f32 v76, v76, v74, v75
    v_max3_f32 v77, v77, v64, v65
    v_max_f32 v76, v76, v77
    v_mov_b32 v77, v76
    ds_read_b128 v[96:99], v4 offset:0
    ds_read_b128 v[100:103], v4 offset:1024
    v_permlane32_swap_b32 v76, v77
    v_max_f32 v76, v76, v77
    v_mov_b32 v77, v76
    ds_read_b128 v[104:107], v4 offset:2048
    ds_read_b128 v[108:111], v4 offset:3072
    v_permlane16_swap_b32 v76, v77
    v_max_f32 v76, v76, v77
    v_pk_add_f32 v[68:69], v[68:69], v[76:77] op_sel_hi:[1,0] neg_lo:[0,1] neg_hi:[0,1]
    v_pk_add_f32 v[70:71], v[70:71], v[76:77] op_sel_hi:[1,0] neg_lo:[0,1] neg_hi:[0,1]
    v_pk_add_f32 v[72:73], v[72:73], v[76:77] op_sel_hi:[1,0] neg_lo:[0,1] neg_hi:[0,1]
    v_pk_add_f32 v[74:75], v[74:75], v[76:77] op_sel_hi:[1,0] neg_lo:[0,1] neg_hi:[0,1]
    v_pk_add_f32 v[64:65], v[64:65], v[76:77] op_sel_hi:[1,0] neg_lo:[0,1] neg_hi:[0,1]
    v_exp_f32 v68, v68
    ds_read_b128 v[112:115], v4 offset:4096
    v_exp_f32 v69, v69
    ds_read_b128 v[116:119], v4 offset:5120
    v_exp_f32 v70, v70
    ds_read_b128 v[120:123], v4 offset:6144
    v_exp_f32 v71, v71
    ds_read_b128 v[124:127], v4 offset:7168
    v_exp_f32 v72, v72
    ds_read_b128 v[48:51], v4 offset:8192
    v_exp_f32 v73, v73
    ds_read_b128 v[52:55], v4 offset:9216
    v_exp_f32 v74, v74
    ds_read_b128 v[56:59], v4 offset:10240
    v_exp_f32 v75, v75
    ds_read_b128 v[60:63], v4 offset:11264
    v_cvt_pk_bf16_f32 v88, v68, v69
    v_cvt_pk_bf16_f32 v89, v70, v71
    v_exp_f32 v64, v64
    v_cvt_pk_bf16_f32 v90, v72, v73
    v_exp_f32 v65, v65
    v_cvt_pk_bf16_f32 v91, v74, v75
    v_mov_b32 v93, 0
    v_cvt_pk_bf16_f32 v92, v64, v65
    v_mfma_f32_16x16x32_bf16 v[76:79], v[128:131], v[88:91], 0
    v_mfma_f32_16x16x32_bf16 v[80:83], v[132:135], v[88:91], 0
    s_waitcnt vmcnt(1)
L_vmchk_0:
    v_max_u32 v94, v136, v138
    v_cmp_eq_u32 vcc, -1, v94
    s_cbranch_vccnz L_vmretry_0
L_vmok_0:
    v_mfma_f32_16x16x16_bf16 v[76:79], v[136:137], v[92:93], v[76:79]
    v_mfma_f32_16x16x16_bf16 v[80:83], v[138:139], v[92:93], v[80:83]
    v_add_f32 v68, v68, v69
    v_add_f32 v70, v70, v71
    v_add_f32 v72, v72, v73
    v_add_f32 v74, v74, v75
    v_add_f32 v64, v64, v65
    v_add_f32 v68, v68, v70
    v_add_f32 v72, v72, v74
    v_add_f32 v68, v68, v64
    v_add_f32 v68, v68, v72
    v_mov_b32 v69, v68
    s_nop 1
    v_permlane32_swap_b32 v68, v69
    v_add_f32 v68, v68, v69
    v_mov_b32 v69, v68
    s_nop 1
    v_permlane16_swap_b32 v68, v69
    v_add_f32 v68, v68, v69
    v_rcp_f32 v68, v68
    s_nop 0
    v_pk_mul_f32 v[76:77], v[76:77], v[68:69] op_sel_hi:[1,0]
    v_pk_mul_f32 v[78:79], v[78:79], v[68:69] op_sel_hi:[1,0]
    v_pk_mul_f32 v[80:81], v[80:81], v[68:69] op_sel_hi:[1,0]
    v_pk_mul_f32 v[82:83], v[82:83], v[68:69] op_sel_hi:[1,0]
    v_cvt_pk_bf16_f32 v84, v76, v77
    v_cvt_pk_bf16_f32 v85, v78, v79
    v_cvt_pk_bf16_f32 v86, v80, v81
    v_cvt_pk_bf16_f32 v87, v82, v83
    s_cmp_eq_u32 s7, 63
    s_cbranch_scc1 L_last_0
    ds_write_b128 v9, v[84:87] offset:20480
    s_waitcnt lgkmcnt(0)
    s_barrier
    ds_read_b128 v[32:35], v1 offset:20480
    ds_read_b128 v[36:39], v1 offset:21504
    ds_read_b128 v[40:43], v1 offset:22528
    ds_read_b128 v[44:47], v1 offset:23552
    s_waitcnt lgkmcnt(3)
    v_mfma_f32_16x16x32_bf16 v[64:67], v[96:99], v[32:35], 0
    v_mfma_f32_16x16x32_bf16 v[68:71], v[112:115], v[32:35], 0
    v_mfma_f32_16x16x32_bf16 v[72:75], v[48:51], v[32:35], 0
    s_waitcnt lgkmcnt(2)
    v_mfma_f32_16x16x32_bf16 v[64:67], v[100:103], v[36:39], v[64:67]
    v_mfma_f32_16x16x32_bf16 v[68:71], v[116:119], v[36:39], v[68:71]
    v_mfma_f32_16x16x32_bf16 v[72:75], v[52:55], v[36:39], v[72:75]
    s_waitcnt lgkmcnt(1)
    v_mfma_f32_16x16x32_bf16 v[64:67], v[104:107], v[40:43], v[64:67]
    v_mfma_f32_16x16x32_bf16 v[68:71], v[120:123], v[40:43], v[68:71]
    v_mfma_f32_16x16x32_bf16 v[72:75], v[56:59], v[40:43], v[72:75]
    s_waitcnt lgkmcnt(0)
    v_mfma_f32_16x16x32_bf16 v[64:67], v[108:111], v[44:47], v[64:67]
    v_mfma_f32_16x16x32_bf16 v[68:71], v[124:127], v[44:47], v[68:71]
    v_mfma_f32_16x16x32_bf16 v[72:75], v[60:63], v[44:47], v[72:75]
    s_nop 0
    v_bfi_b32 v64, 3, s61, v64
    s_nop 0
    buffer_store_dwordx4 v[64:67], v6, s[8:11], s55 offen
    s_nop 2
    v_bfi_b32 v68, 3, s61, v68
    buffer_store_dwordx4 v[68:71], v6, s[8:11], s56 offen
    v_bfi_b32 v72, 3, s61, v72
    buffer_store_dwordx4 v[72:75], v6, s[8:11], s57 offen
L_next_0:
    s_add_u32 s99, s60, 0
    v_xor_b32 v0, 0x10000, v0
    v_xor_b32 v2, 0x10000, v2
    v_xor_b32 v3, 0x10000, v3
    v_xor_b32 v143, 0x10000, v143
    s_add_u32 s7, s7, 1
    s_branch L_step_0
L_vmretry_0:
    s_cmp_eq_u32 s46, 0
    s_cbranch_scc1 L_vmok_0
    s_sub_u32 s46, s46, 1
    buffer_load_dword v136, v8, s[8:11], s53 offen sc1
    buffer_load_dword v138, v8, s[8:11], s53 offen offset:256 sc1
    s_waitcnt vmcnt(0)
    s_branch L_vmchk_0
L_last_0:
    s_add_u32 s65, s60, 0
    buffer_store_dwordx4 v[84:87], v7, s[8:11], s65 offen sc1
    s_waitcnt vmcnt(0)
    s_barrier
    s_branch L_chain_end
L_start_1:
    s_add_u32 s65, s59, 10304
    s_add_u32 m0, s74, 33792
    s_nop 0
    buffer_load_dwordx4 v140, s[8:11], s65 offen sc1 lds
    s_add_u32 s65, s59, 12352
    s_add_u32 m0, s74, 34816
    s_nop 0
    buffer_load_dwordx4 v140, s[8:11], s65 offen sc1 lds
    s_add_u32 s65, s59, 14400
    s_add_u32 m0, s74, 35840
    s_nop 0
    buffer_load_dwordx4 v140, s[8:11], s65 offen sc1 lds
    s_add_u32 s65, s59, 0
    s_add_u32 m0, s74, 10240
    s_nop 0
    buffer_load_dwordx4 v142, s[8:11], s65 offen sc1 lds
    s_add_u32 s65, s59, 2048
    s_add_u32 m0, s74, 11264
    s_nop 0
    buffer_load_dwordx4 v142, s[8:11], s65 offen sc1 lds
    s_waitcnt vmcnt(0)
    s_barrier
L_step_1:
    s_mul_i32 s65, s7, 10240
    s_add_u32 s65, s65, 0x2000
    s_lshl_b32 s66, s4, 10
    s_add_u32 s66, s66, s65
    s_and_b32 s68, s66, 0xffffe000
    s_add_u32 s48, s66, s68
    s_add_u32 s48, s48, s47
    s_add_u32 s66, s66, 4096
    s_and_b32 s68, s66, 0xffffe000
    s_add_u32 s49, s66, s68
    s_add_u32 s49, s49, s47
    s_lshl_b32 s66, s64, 10
    s_add_u32 s66, s66, s65
    s_and_b32 s68, s66, 0xffffe000
    s_add_u32 s50, s66, s68
    s_add_u32 s50, s50, s47
    s_lshl_b32 s66, s75, 7
    s_add_u32 s66, s66, s65
    s_add_u32 s66, s66, 10240
    s_and_b32 s68, s66, 0xffffe000
    s_add_u32 s51, s66, s68
    s_add_u32 s51, s51, s47
    s_and_b32 s65, s7, 3
    s_lshl_b32 s65, s65, 5
    s_add_u32 s65, s65, s6
    s_lshl_b32 s65, s65, 11
    s_add_u32 s65, s65, 663552
    s_lshl_b32 s66, s5, 9
    s_add_u32 s66, s66, s65
    s_and_b32 s68, s66, 0xffffe000
    s_add_u32 s52, s66, s68
    s_add_u32 s52, s52, s47
    s_lshl_b32 s66, s4, 9
    s_add_u32 s66, s66, s65
    s_and_b32 s68, s66, 0xffffe000
    s_add_u32 s53, s66, s68
    s_add_u32 s53, s53, s47
    s_add_u32 s65, s7, 2
    s_and_b32 s65, s65, 3
    s_lshl_b32 s65, s65, 5
    s_add_u32 s65, s65, s6
    s_lshl_b32 s65, s65, 11
    s_add_u32 s65, s65, 663552
    s_lshl_b32 s66, s5, 9
    s_add_u32 s66, s66, s65
    s_and_b32 s68, s66, 0xffffe000
    s_add_u32 s54, s66, s68
    s_add_u32 s54, s54, s47
    s_and_b32 s65, s7, 1
    s_sub_u32 s61, 2, s65
    s_add_u32 s62, s65, 1
    s_lshl_b32 s65, s6, 6
    s_add_u32 s65, s65, s7
    s_lshl_b32 s66, s65, 13
    s_lshl_b32 s67, s5, 7
    s_add_u32 s66, s66, s67
    s_add_u32 s60, s66, 50331648
    s_add_u32 s65, s65, 1
    s_mul_i32 s59, s65, 24576
    s_add_u32 s98, s7, 1
    ds_read_b128 v[96:99], v0 offset:28672
    ds_read_b128 v[100:103], v0 offset:29696
    ds_read_b128 v[104:107], v0 offset:30720
    ds_read_b128 v[108:111], v0 offset:31744
    ds_read_b128 v[112:115], v0 offset:32768
    ds_read_b128 v[116:119], v0 offset:33792
    ds_read_b128 v[120:123], v0 offset:34816
    ds_read_b128 v[124:127], v0 offset:35840
    ds_read_b128 v[128:131], v0 offset:38912
    ds_read_b128 v[132:135], v0 offset:39936
    v_mov_b32 v72, 0
    v_mov_b32 v73, 0
    v_mov_b32 v74, 0
    v_mov_b32 v75, 0
    v_mov_b32 v76, 0
    v_mov_b32 v77, 0
    v_mov_b32 v78, 0
    v_mov_b32 v79, 0
    v_mov_b32 v80, 0
    v_mov_b32 v81, 0
    v_mov_b32 v82, 0
    v_mov_b32 v83, 0
    v_mov_b32 v84, 0
    v_mov_b32 v85, 0
    v_mov_b32 v86, 0
    v_mov_b32 v87, 0
    v_mov_b32 v88, 0
    v_mov_b32 v89, 0
    v_mov_b32 v90, 0
    v_mov_b32 v91, 0
    v_mov_b32 v92, 0
    v_mov_b32 v93, 0
    v_mov_b32 v94, 0
    v_mov_b32 v95, 0
    s_add_u32 s79, s7, 1
    s_and_b32 s74, s79, 1
    s_lshl_b32 s74, s74, 16
    s_min_u32 s79, s79, 63
    s_cmp_gt_u32 s63, s79
    s_cbranch_scc1 L_pw_ok_st_1
    s_lshl_b32 s78, s6, 9
    s_add_u32 s78, s78, 72220672
L_pw_st_1:
    v_mov_b32 v20, 0
    buffer_load_dword v24, v20, s[8:11], s78 offen sc1
    buffer_load_dword v25, v20, s[8:11], s78 offen offset:128 sc1
    buffer_load_dword v26, v20, s[8:11], s78 offen offset:256 sc1
    s_waitcnt vmcnt(0)
    v_min3_u32 v24, v24, v25, v26
    s_nop 0
    v_readfirstlane_b32 s63, v24
    s_cmp_gt_u32 s63, s79
    s_cbranch_scc1 L_pw_ok_st_1
    s_cmp_eq_u32 s46, 0
    s_cbranch_scc1 L_pw_ok_st_1
    s_sub_u32 s46, s46, 1
    s_branch L_pw_st_1
L_pw_ok_st_1:
    s_cmp_eq_u32 s7, 0
    s_cbranch_scc1 L_first_1
    s_barrier
    s_sleep 1
L_agstart_1:
L_agpoll_1:
    buffer_load_dwordx4 v[20:23], v1, s[8:11], s48 offen sc1
    buffer_load_dwordx4 v[24:27], v1, s[8:11], s49 offen sc1
    buffer_load_dwordx4 v[28:31], v1, s[8:11], s50 offen sc1
    s_nop 2
    v_mov_b32 v139, v139
    s_nop 2
    v_mov_b32 v139, v139
    s_nop 2
    v_mov_b32 v139, v139
    s_nop 2
    v_mov_b32 v139, v139
    s_nop 2
    v_mov_b32 v139, v139
    s_nop 2
    v_mov_b32 v139, v139
    s_nop 2
    v_mov_b32 v139, v139
    s_nop 2
    v_mov_b32 v139, v139
    s_nop 2
    v_mov_b32 v139, v139
    s_waitcnt vmcnt(0)
    v_max3_u32 v32, v20, v21, v22
    v_max3_u32 v33, v23, v24, v25
    v_max3_u32 v34, v26, v27, v28
    v_max3_u32 v35, v29, v30, v31
    v_max3_u32 v32, v32, v33, v34
    v_max_u32 v32, v32, v35
    v_cmp_eq_u32 vcc, -1, v32
    s_cbranch_vccz L_agokA_1
    s_cmp_eq_u32 s46, 0
    s_cbranch_scc1 L_agokA_1
    s_sub_u32 s46, s46, 1
    s_branch L_agpoll_1
    buffer_load_dwordx4 v[20:23], v1, s[8:11], s48 offen sc1
    buffer_load_dwordx4 v[24:27], v1, s[8:11], s49 offen sc1
    buffer_load_dwordx4 v[28:31], v1, s[8:11], s50 offen sc1
    s_nop 2
    v_mov_b32 v139, v139
    s_nop 2
    v_mov_b32 v139, v139
    s_nop 2
    v_mov_b32 v139, v139
    s_nop 2
    v_mov_b32 v139, v139
    s_nop 2
    v_mov_b32 v139, v139
    s_nop 2
    v_mov_b32 v139, v139
    buffer_load_dwordx4 v[36:39], v1, s[8:11], s48 offen sc1
    buffer_load_dwordx4 v[52:55], v1, s[8:11], s49 offen sc1
    buffer_load_dwordx4 v[68:71], v1, s[8:11], s50 offen sc1
L_agpoll_1x:
    s_nop 2
    v_mov_b32 v139, v139
    s_nop 2
    v_mov_b32 v139, v139
    s_nop 2
    v_mov_b32 v139, v139
    s_nop 2
    v_mov_b32 v139, v139
    s_nop 2
    v_mov_b32 v139, v139
    s_nop 2
    v_mov_b32 v139, v139
    s_nop 2
    v_mov_b32 v139, v139
    s_nop 2
    v_mov_b32 v139, v139
    s_nop 2
    v_mov_b32 v139, v139
    s_waitcnt vmcnt(3)
    v_max3_u32 v32, v20, v21, v22
    v_max3_u32 v33, v23, v24, v25
    v_max3_u32 v34, v26, v27, v28
    v_max3_u32 v35, v29, v30, v31
    v_max3_u32 v32, v32, v33, v34
    v_max_u32 v32, v32, v35
    v_cmp_eq_u32 vcc, -1, v32
    s_cbranch_vccz L_agokA_1
    buffer_load_dwordx4 v[20:23], v1, s[8:11], s48 offen sc1
    buffer_load_dwordx4 v[24:27], v1, s[8:11], s49 offen sc1
    buffer_load_dwordx4 v[28:31], v1, s[8:11], s50 offen sc1
    s_nop 2
    v_mov_b32 v139, v139
    s_nop 2
    v_mov_b32 v139, v139
    s_nop 2
    v_mov_b32 v139, v139
    s_nop 2
    v_mov_b32 v139, v139
    s_nop 2
    v_mov_b32 v139, v139
    s_nop 2
    v_mov_b32 v139, v139
    s_nop 2
    v_mov_b32 v139, v139
    s_nop 2
    v_mov_b32 v139, v139
    s_nop 2
    v_mov_b32 v139, v139
    s_waitcnt vmcnt(3)
    v_max3_u32 v32, v36, v37, v38
    v_max3_u32 v33, v39, v52, v53
    v_max3_u32 v34, v54, v55, v68
    v_max3_u32 v35, v69, v70, v71
    v_max3_u32 v32, v32, v33, v34
    v_max_u32 v32, v32, v35
    v_cmp_eq_u32 vcc, -1, v32
    s_cbranch_vccz L_agokB_1
    buffer_load_dwordx4 v[36:39], v1, s[8:11], s48 offen sc1
    buffer_load_dwordx4 v[52:55], v1, s[8:11], s49 offen sc1
    buffer_load_dwordx4 v[68:71], v1, s[8:11], s50 offen sc1
    s_cmp_eq_u32 s46, 0
    s_cbranch_scc1 L_agokB_1
    s_sub_u32 s46, s46, 1
    s_branch L_agpoll_1x
L_first_1:
    s_mov_b32 s12, s26
    s_and_b32 s13, s27, 0xffff
    s_mov_b32 s14, 0x2800
    s_mov_b32 s15, 0x20000
    v_bfe_u32 v32, v1, 4, 3
    v_mul_u32_u24 v32, 1280, v32
    v_lshrrev_b32 v33, 7, v1
    v_lshl_add_u32 v32, v33, 4, v32
    buffer_load_dwordx4 v[20:23], v32, s[12:15], 0 offen offset:128
    buffer_load_dwordx4 v[24:27], v32, s[12:15], 0 offen offset:640
    buffer_load_dwordx4 v[28:31], v32, s[12:15], 0 offen offset:1152
    s_waitcnt vmcnt(0)
L_agokA_1:
    v_smfmac_f32_16x16x64_bf16 v[88:91], v[20:23], v[144:151], v5
    ds_write_b128 v1, v[20:23] offset:1024
    v_smfmac_f32_16x16x64_bf16 v[92:95], v[20:23], v[152:159], v5
    ds_write_b128 v1, v[24:27] offset:5120
    v_smfmac_f32_16x16x64_bf16 v[88:91], v[24:27], v[160:167], v5
    ds_write_b128 v1, v[28:31] offset:9216
    v_smfmac_f32_16x16x64_bf16 v[92:95], v[24:27], v[168:175], v5
    v_smfmac_f32_16x16x64_bf16 v[88:91], v[28:31], v[176:183], v5
    v_smfmac_f32_16x16x64_bf16 v[92:95], v[28:31], v[184:191], v5
    v_smfmac_f32_16x16x64_bf16 v[72:75], v[20:23], v[200:207], v5
    v_smfmac_f32_16x16x64_bf16 v[76:79], v[20:23], a[104:111], v5
    v_smfmac_f32_16x16x64_bf16 v[80:83], v[20:23], a[24:31], v5
    v_permlane32_swap_b32 v88, v92
    v_smfmac_f32_16x16x64_bf16 v[84:87], v[20:23], a[184:191], v5
    v_permlane32_swap_b32 v89, v93
    v_smfmac_f32_16x16x64_bf16 v[72:75], v[24:27], v[232:239], v5
    v_permlane32_swap_b32 v90, v94
    v_smfmac_f32_16x16x64_bf16 v[76:79], v[24:27], a[136:143], v5
    v_permlane32_swap_b32 v91, v95
    v_smfmac_f32_16x16x64_bf16 v[80:83], v[24:27], a[56:63], v5
    v_add_f32 v88, v88, v92
    v_smfmac_f32_16x16x64_bf16 v[84:87], v[24:27], a[216:223], v5
    v_add_f32 v89, v89, v93
    v_smfmac_f32_16x16x64_bf16 v[72:75], v[28:31], a[8:15], v5
    v_add_f32 v90, v90, v94
    v_smfmac_f32_16x16x64_bf16 v[76:79], v[28:31], a[168:175], v5
    v_add_f32 v91, v91, v95
    ds_write_b128 v9, v[88:91] offset:24576
    s_waitcnt vmcnt(0) lgkmcnt(0)
    s_barrier
    ds_read_b128 v[32:35], v1 offset:0
    ds_read_b128 v[40:43], v1 offset:2048
    ds_read_b128 v[44:47], v1 offset:3072
    ds_read_b128 v[48:51], v1 offset:4096
    ds_read_b128 v[56:59], v1 offset:6144
    ds_read_b128 v[60:63], v1 offset:7168
    ds_read_b128 v[64:67], v1 offset:8192
    v_smfmac_f32_16x16x64_bf16 v[80:83], v[28:31], a[88:95], v5
    v_smfmac_f32_16x16x64_bf16 v[84:87], v[28:31], a[248:255], v5
    s_branch L_join_1
L_agokB_1:
    v_smfmac_f32_16x16x64_bf16 v[88:91], v[36:39], v[144:151], v5
    ds_write_b128 v1, v[36:39] offset:1024
    v_smfmac_f32_16x16x64_bf16 v[92:95], v[36:39], v[152:159], v5
    ds_write_b128 v1, v[52:55] offset:5120
    v_smfmac_f32_16x16x64_bf16 v[88:91], v[52:55], v[160:167], v5
    ds_write_b128 v1, v[68:71] offset:9216
    v_smfmac_f32_16x16x64_bf16 v[92:95], v[52:55], v[168:175], v5
    v_smfmac_f32_16x16x64_bf16 v[88:91], v[68:71], v[176:183], v5
    v_smfmac_f32_16x16x64_bf16 v[92:95], v[68:71], v[184:191], v5
    v_smfmac_f32_16x16x64_bf16 v[72:75], v[36:39], v[200:207], v5
    v_smfmac_f32_16x16x64_bf16 v[76:79], v[36:39], a[104:111], v5
    v_smfmac_f32_16x16x64_bf16 v[80:83], v[36:39], a[24:31], v5
    v_permlane32_swap_b32 v88, v92
    v_smfmac_f32_16x16x64_bf16 v[84:87], v[36:39], a[184:191], v5
    v_permlane32_swap_b32 v89, v93
    v_smfmac_f32_16x16x64_bf16 v[72:75], v[52:55], v[232:239], v5
    v_permlane32_swap_b32 v90, v94
    v_smfmac_f32_16x16x64_bf16 v[76:79], v[52:55], a[136:143], v5
    v_permlane32_swap_b32 v91, v95
    v_smfmac_f32_16x16x64_bf16 v[80:83], v[52:55], a[56:63], v5
    v_add_f32 v88, v88, v92
    v_smfmac_f32_16x16x64_bf16 v[84:87], v[52:55], a[216:223], v5
    v_add_f32 v89, v89, v93
    v_smfmac_f32_16x16x64_bf16 v[72:75], v[68:71], a[8:15], v5
    v_add_f32 v90, v90, v94
    v_smfmac_f32_16x16x64_bf16 v[76:79], v[68:71], a[168:175], v5
    v_add_f32 v91, v91, v95
    ds_write_b128 v9, v[88:91] offset:24576
    s_waitcnt vmcnt(0) lgkmcnt(0)
    s_barrier
    ds_read_b128 v[32:35], v1 offset:0
    ds_read_b128 v[40:43], v1 offset:2048
    ds_read_b128 v[44:47], v1 offset:3072
    ds_read_b128 v[48:51], v1 offset:4096
    ds_read_b128 v[56:59], v1 offset:6144
    ds_read_b128 v[60:63], v1 offset:7168
    ds_read_b128 v[64:67], v1 offset:8192
    v_smfmac_f32_16x16x64_bf16 v[80:83], v[68:71], a[88:95], v5
    v_smfmac_f32_16x16x64_bf16 v[84:87], v[68:71], a[248:255], v5
L_join_1:
    s_waitcnt lgkmcnt(6)
    v_smfmac_f32_16x16x64_bf16 v[72:75], v[32:35], v[192:199], v5
    v_smfmac_f32_16x16x64_bf16 v[76:79], v[32:35], a[96:103], v5
    s_waitcnt lgkmcnt(5)
    v_smfmac_f32_16x16x64_bf16 v[72:75], v[40:43], v[208:215], v5
    v_smfmac_f32_16x16x64_bf16 v[76:79], v[40:43], a[112:119], v5
    s_waitcnt lgkmcnt(4)
    v_smfmac_f32_16x16x64_bf16 v[72:75], v[44:47], v[216:223], v5
    v_smfmac_f32_16x16x64_bf16 v[76:79], v[44:47], a[120:127], v5
    s_waitcnt lgkmcnt(3)
    v_smfmac_f32_16x16x64_bf16 v[72:75], v[48:51], v[224:231], v5
    v_smfmac_f32_16x16x64_bf16 v[76:79], v[48:51], a[128:135], v5
    s_waitcnt lgkmcnt(2)
    v_smfmac_f32_16x16x64_bf16 v[72:75], v[56:59], v[240:247], v5
    v_smfmac_f32_16x16x64_bf16 v[76:79], v[56:59], a[144:151], v5
    s_waitcnt lgkmcnt(1)
    v_smfmac_f32_16x16x64_bf16 v[72:75], v[60:63], v[248:255], v5
    v_smfmac_f32_16x16x64_bf16 v[76:79], v[60:63], a[152:159], v5
    s_waitcnt lgkmcnt(0)
    v_smfmac_f32_16x16x64_bf16 v[72:75], v[64:67], a[0:7], v5
    v_smfmac_f32_16x16x64_bf16 v[76:79], v[64:67], a[160:167], v5
    v_smfmac_f32_16x16x64_bf16 v[80:83], v[32:35], a[16:23], v5
    v_smfmac_f32_16x16x64_bf16 v[84:87], v[32:35], a[176:183], v5
    s_add_u32 s65, s59, 8256
    s_add_u32 m0, s74, 32768
    s_nop 0
    buffer_load_dwordx4 v140, s[8:11], s65 offen sc1 lds
    v_smfmac_f32_16x16x64_bf16 v[80:83], v[40:43], a[32:39], v5
    s_add_u32 s65, s59, 10304
    s_add_u32 m0, s74, 33792
    s_nop 0
    buffer_load_dwordx4 v140, s[8:11], s65 offen sc1 lds
    v_smfmac_f32_16x16x64_bf16 v[84:87], v[40:43], a[192:199], v5
    s_add_u32 s65, s59, 12352
    s_add_u32 m0, s74, 34816
    s_nop 0
    buffer_load_dwordx4 v140, s[8:11], s65 offen sc1 lds
    v_smfmac_f32_16x16x64_bf16 v[80:83], v[44:47], a[40:47], v5
    s_add_u32 s65, s59, 14400
    s_add_u32 m0, s74, 35840
    s_nop 0
    buffer_load_dwordx4 v140, s[8:11], s65 offen sc1 lds
    v_smfmac_f32_16x16x64_bf16 v[84:87], v[44:47], a[200:207], v5
    v_permlane32_swap_b32 v72, v76
    v_smfmac_f32_16x16x64_bf16 v[80:83], v[48:51], a[48:55], v5
    v_permlane32_swap_b32 v73, v77
    v_smfmac_f32_16x16x64_bf16 v[84:87], v[48:51], a[208:215], v5
    v_permlane32_swap_b32 v74, v78
    v_smfmac_f32_16x16x64_bf16 v[80:83], v[56:59], a[64:71], v5
    v_permlane32_swap_b32 v75, v79
    v_smfmac_f32_16x16x64_bf16 v[84:87], v[56:59], a[224:231], v5
    v_add_f32 v72, v72, v76
    v_smfmac_f32_16x16x64_bf16 v[80:83], v[60:63], a[72:79], v5
    v_add_f32 v73, v73, v77
    v_smfmac_f32_16x16x64_bf16 v[84:87], v[60:63], a[232:239], v5
    v_add_f32 v74, v74, v78
    v_smfmac_f32_16x16x64_bf16 v[80:83], v[64:67], a[80:87], v5
    v_add_f32 v75, v75, v79
    v_smfmac_f32_16x16x64_bf16 v[84:87], v[64:67], a[240:247], v5
    v_cvt_pk_bf16_f32 v76, v72, v73
    v_cvt_pk_bf16_f32 v77, v74, v75
    ds_write_b32 v3, v76 offset:0
    ds_write_b32 v143, v77 offset:0
    s_nop 3
    v_permlane32_swap_b32 v80, v84
    v_permlane32_swap_b32 v81, v85
    v_permlane32_swap_b32 v82, v86
    v_permlane32_swap_b32 v83, v87
    v_add_f32 v80, v80, v84
    v_add_f32 v81, v81, v85
    v_add_f32 v82, v82, v86
    v_add_f32 v83, v83, v87
    v_cvt_pk_bf16_f32 v84, v80, v81
    v_cvt_pk_bf16_f32 v85, v82, v83
    ds_write_b32 v3, v84 offset:512
    ds_write_b32 v143, v85 offset:512
    v_mov_b32 v136, -1
    v_mov_b32 v138, -1
    buffer_load_dword v136, v8, s[8:11], s53 offen sc1
    buffer_load_dword v138, v8, s[8:11], s53 offen offset:256 sc1
    s_waitcnt lgkmcnt(0)
    s_barrier
    ds_read_b64_tr_b16 v[32:33], v2 offset:0
    ds_read_b64_tr_b16 v[34:35], v2 offset:256
    ds_read_b64_tr_b16 v[48:49], v2 offset:4096
    ds_read_b64_tr_b16 v[50:51], v2 offset:4352
    ds_read_b64_tr_b16 v[36:37], v2 offset:1024
    ds_read_b64_tr_b16 v[38:39], v2 offset:1280
    ds_read_b64_tr_b16 v[52:53], v2 offset:5120
    ds_read_b64_tr_b16 v[54:55], v2 offset:5376
    ds_read_b64_tr_b16 v[40:41], v2 offset:2048
    ds_read_b64_tr_b16 v[42:43], v2 offset:2304
    ds_read_b64_tr_b16 v[56:57], v2 offset:6144
    ds_read_b64_tr_b16 v[58:59], v2 offset:6400
    ds_read_b64_tr_b16 v[44:45], v2 offset:3072
    ds_read_b64_tr_b16 v[46:47], v2 offset:3328
    ds_read_b64_tr_b16 v[60:61], v2 offset:7168
    ds_read_b64_tr_b16 v[62:63], v2 offset:7424
    s_waitcnt lgkmcnt(12)
    v_mfma_f32_16x16x32_bf16 v[68:71], v[96:99], v[32:35], 0
    ds_read_b128 v[20:23], v9 offset:20480
    v_mfma_f32_16x16x32_bf16 v[72:75], v[112:115], v[32:35], 0
    v_mfma_f32_16x16x32_bf16 v[64:67], v[48:51], v[32:35], 0
    s_waitcnt lgkmcnt(9)
    v_mfma_f32_16x16x32_bf16 v[68:71], v[100:103], v[36:39], v[68:71]
    v_mfma_f32_16x16x32_bf16 v[72:75], v[116:119], v[36:39], v[72:75]
    v_mfma_f32_16x16x32_bf16 v[64:67], v[52:55], v[36:39], v[64:67]
    s_waitcnt lgkmcnt(5)
    v_mfma_f32_16x16x32_bf16 v[68:71], v[104:107], v[40:43], v[68:71]
    v_mfma_f32_16x16x32_bf16 v[72:75], v[120:123], v[40:43], v[72:75]
    v_mfma_f32_16x16x32_bf16 v[64:67], v[56:59], v[40:43], v[64:67]
    s_waitcnt lgkmcnt(1)
    v_mfma_f32_16x16x32_bf16 v[68:71], v[108:111], v[44:47], v[68:71]
    v_mfma_f32_16x16x32_bf16 v[72:75], v[124:127], v[44:47], v[72:75]
    v_mfma_f32_16x16x32_bf16 v[64:67], v[60:63], v[44:47], v[64:67]
    s_waitcnt lgkmcnt(0)
    buffer_store_dwordx4 v[20:23], v7, s[8:11], s99 offen sc1
    s_nop 0
    v_pk_fma_f32 v[68:69], v[68:69], s[70:71], v[10:11]
    s_nop 0
    v_pk_fma_f32 v[70:71], v[70:71], s[70:71], v[12:13]
    s_nop 0
    v_pk_fma_f32 v[72:73], v[72:73], s[70:71], v[14:15]
    v_pk_fma_f32 v[74:75], v[74:75], s[70:71], v[16:17]
    v_pk_mul_f32 v[64:65], v[64:65], s[70:71]
    v_max3_f32 v76, v68, v69, v70
    v_max3_f32 v77, v71, v72, v73
    v_max3_f32 v76, v76, v74, v75
    v_max3_f32 v77, v77, v64, v65
    v_max_f32 v76, v76, v77
    v_mov_b32 v77, v76
    ds_read_b128 v[96:99], v4 offset:0
    ds_read_b128 v[100:103], v4 offset:1024
    v_permlane32_swap_b32 v76, v77
    v_max_f32 v76, v76, v77
    v_mov_b32 v77, v76
    ds_read_b128 v[104:107], v4 offset:2048
    ds_read_b128 v[108:111], v4 offset:3072
    v_permlane16_swap_b32 v76, v77
    v_max_f32 v76, v76, v77
    v_pk_add_f32 v[68:69], v[68:69], v[76:77] op_sel_hi:[1,0] neg_lo:[0,1] neg_hi:[0,1]
    v_pk_add_f32 v[70:71], v[70:71], v[76:77] op_sel_hi:[1,0] neg_lo:[0,1] neg_hi:[0,1]
    v_pk_add_f32 v[72:73], v[72:73], v[76:77] op_sel_hi:[1,0] neg_lo:[0,1] neg_hi:[0,1]
    v_pk_add_f32 v[74:75], v[74:75], v[76:77] op_sel_hi:[1,0] neg_lo:[0,1] neg_hi:[0,1]
    v_pk_add_f32 v[64:65], v[64:65], v[76:77] op_sel_hi:[1,0] neg_lo:[0,1] neg_hi:[0,1]
    v_exp_f32 v68, v68
    ds_read_b128 v[112:115], v4 offset:4096
    v_exp_f32 v69, v69
    ds_read_b128 v[116:119], v4 offset:5120
    v_exp_f32 v70, v70
    ds_read_b128 v[120:123], v4 offset:6144
    v_exp_f32 v71, v71
    ds_read_b128 v[124:127], v4 offset:7168
    v_exp_f32 v72, v72
    ds_read_b128 v[48:51], v4 offset:8192
    v_exp_f32 v73, v73
    ds_read_b128 v[52:55], v4 offset:9216
    v_exp_f32 v74, v74
    ds_read_b128 v[56:59], v4 offset:10240
    v_exp_f32 v75, v75
    ds_read_b128 v[60:63], v4 offset:11264
    v_cvt_pk_bf16_f32 v88, v68, v69
    v_cvt_pk_bf16_f32 v89, v70, v71
    v_exp_f32 v64, v64
    v_cvt_pk_bf16_f32 v90, v72, v73
    v_exp_f32 v65, v65
    v_cvt_pk_bf16_f32 v91, v74, v75
    v_mov_b32 v93, 0
    v_cvt_pk_bf16_f32 v92, v64, v65
    v_mfma_f32_16x16x32_bf16 v[76:79], v[128:131], v[88:91], 0
    v_mfma_f32_16x16x32_bf16 v[80:83], v[132:135], v[88:91], 0
    s_waitcnt vmcnt(1)
L_vmchk_1:
    v_max_u32 v94, v136, v138
    v_cmp_eq_u32 vcc, -1, v94
    s_cbranch_vccnz L_vmretry_1
L_vmok_1:
    v_mfma_f32_16x16x16_bf16 v[76:79], v[136:137], v[92:93], v[76:79]
    v_mfma_f32_16x16x16_bf16 v[80:83], v[138:139], v[92:93], v[80:83]
    v_add_f32 v68, v68, v69
    v_add_f32 v70, v70, v71
    v_add_f32 v72, v72, v73
    v_add_f32 v74, v74, v75
    v_add_f32 v64, v64, v65
    v_add_f32 v68, v68, v70
    v_add_f32 v72, v72, v74
    v_add_f32 v68, v68, v64
    v_add_f32 v68, v68, v72
    v_mov_b32 v69, v68
    s_nop 1
    v_permlane32_swap_b32 v68, v69
    v_add_f32 v68, v68, v69
    v_mov_b32 v69, v68
    s_nop 1
    v_permlane16_swap_b32 v68, v69
    v_add_f32 v68, v68, v69
    v_rcp_f32 v68, v68
    s_nop 0
    v_pk_mul_f32 v[76:77], v[76:77], v[68:69] op_sel_hi:[1,0]
    v_pk_mul_f32 v[78:79], v[78:79], v[68:69] op_sel_hi:[1,0]
    v_pk_mul_f32 v[80:81], v[80:81], v[68:69] op_sel_hi:[1,0]
    v_pk_mul_f32 v[82:83], v[82:83], v[68:69] op_sel_hi:[1,0]
    v_cvt_pk_bf16_f32 v84, v76, v77
    v_cvt_pk_bf16_f32 v85, v78, v79
    v_cvt_pk_bf16_f32 v86, v80, v81
    v_cvt_pk_bf16_f32 v87, v82, v83
    s_cmp_eq_u32 s7, 63
    s_cbranch_scc1 L_last_1
    ds_write_b128 v9, v[84:87] offset:20480
    s_waitcnt lgkmcnt(0)
    s_barrier
    ds_read_b128 v[32:35], v1 offset:20480
    ds_read_b128 v[36:39], v1 offset:21504
    ds_read_b128 v[40:43], v1 offset:22528
    ds_read_b128 v[44:47], v1 offset:23552
    s_waitcnt lgkmcnt(3)
    v_mfma_f32_16x16x32_bf16 v[64:67], v[96:99], v[32:35], 0
    v_mfma_f32_16x16x32_bf16 v[68:71], v[112:115], v[32:35], 0
    v_mfma_f32_16x16x32_bf16 v[72:75], v[48:51], v[32:35], 0
    s_waitcnt lgkmcnt(2)
    v_mfma_f32_16x16x32_bf16 v[64:67], v[100:103], v[36:39], v[64:67]
    v_mfma_f32_16x16x32_bf16 v[68:71], v[116:119], v[36:39], v[68:71]
    v_mfma_f32_16x16x32_bf16 v[72:75], v[52:55], v[36:39], v[72:75]
    s_waitcnt lgkmcnt(1)
    v_mfma_f32_16x16x32_bf16 v[64:67], v[104:107], v[40:43], v[64:67]
    v_mfma_f32_16x16x32_bf16 v[68:71], v[120:123], v[40:43], v[68:71]
    v_mfma_f32_16x16x32_bf16 v[72:75], v[56:59], v[40:43], v[72:75]
    s_waitcnt lgkmcnt(0)
    v_mfma_f32_16x16x32_bf16 v[64:67], v[108:111], v[44:47], v[64:67]
    v_mfma_f32_16x16x32_bf16 v[68:71], v[124:127], v[44:47], v[68:71]
    v_mfma_f32_16x16x32_bf16 v[72:75], v[60:63], v[44:47], v[72:75]
    s_nop 0
    v_bfi_b32 v64, 3, s61, v64
    s_nop 0
    buffer_store_dwordx4 v[64:67], v6, s[8:11], s55 offen
    s_nop 2
    v_bfi_b32 v68, 3, s61, v68
    buffer_store_dwordx4 v[68:71], v6, s[8:11], s56 offen
    v_bfi_b32 v72, 3, s61, v72
    buffer_store_dwordx4 v[72:75], v6, s[8:11], s57 offen
    v_mov_b32 v92, -1
    v_mov_b32 v93, -1
    v_lshrrev_b32 v94, 1, v1
    buffer_store_dwordx2 v[92:93], v94, s[8:11], s54 offen sc1
L_next_1:
    s_add_u32 s99, s60, 2048
    v_xor_b32 v0, 0x10000, v0
    v_xor_b32 v2, 0x10000, v2
    v_xor_b32 v3, 0x10000, v3
    v_xor_b32 v143, 0x10000, v143
    s_add_u32 s7, s7, 1
    s_branch L_step_1
L_vmretry_1:
    s_cmp_eq_u32 s46, 0
    s_cbranch_scc1 L_vmok_1
    s_sub_u32 s46, s46, 1
    buffer_load_dword v136, v8, s[8:11], s53 offen sc1
    buffer_load_dword v138, v8, s[8:11], s53 offen offset:256 sc1
    s_waitcnt vmcnt(0)
    s_branch L_vmchk_1
L_last_1:
    s_add_u32 s65, s60, 2048
    buffer_store_dwordx4 v[84:87], v7, s[8:11], s65 offen sc1
    s_waitcnt vmcnt(0)
    s_barrier
    s_branch L_chain_end
L_start_2:
    s_add_u32 s65, s59, 4096
    s_add_u32 m0, s74, 12288
    s_nop 0
    buffer_load_dwordx4 v142, s[8:11], s65 offen sc1 lds
    s_add_u32 s65, s59, 6144
    s_add_u32 m0, s74, 13312
    s_nop 0
    buffer_load_dwordx4 v142, s[8:11], s65 offen sc1 lds
    s_add_u32 s65, s59, 16384
    s_add_u32 m0, s74, 36864
    s_nop 0
    buffer_load_dwordx4 v141, s[8:11], s65 offen sc1 lds
    s_add_u32 s65, s59, 16640
    s_add_u32 m0, s74, 37888
    s_nop 0
    buffer_load_dwordx4 v141, s[8:11], s65 offen sc1 lds
    s_add_u32 s65, s59, 18432
    s_add_u32 m0, s74, 38912
    s_nop 0
    buffer_load_dwordx4 v141, s[8:11], s65 offen sc1 lds
    s_waitcnt vmcnt(0)
    s_barrier
L_step_2:
    s_mul_i32 s65, s7, 10240
    s_add_u32 s65, s65, 0x2000
    s_lshl_b32 s66, s4, 10
    s_add_u32 s66, s66, s65
    s_and_b32 s68, s66, 0xffffe000
    s_add_u32 s48, s66, s68
    s_add_u32 s48, s48, s47
    s_add_u32 s66, s66, 4096
    s_and_b32 s68, s66, 0xffffe000
    s_add_u32 s49, s66, s68
    s_add_u32 s49, s49, s47
    s_lshl_b32 s66, s64, 10
    s_add_u32 s66, s66, s65
    s_and_b32 s68, s66, 0xffffe000
    s_add_u32 s50, s66, s68
    s_add_u32 s50, s50, s47
    s_lshl_b32 s66, s75, 7
    s_add_u32 s66, s66, s65
    s_add_u32 s66, s66, 10240
    s_and_b32 s68, s66, 0xffffe000
    s_add_u32 s51, s66, s68
    s_add_u32 s51, s51, s47
    s_and_b32 s65, s7, 3
    s_lshl_b32 s65, s65, 5
    s_add_u32 s65, s65, s6
    s_lshl_b32 s65, s65, 11
    s_add_u32 s65, s65, 663552
    s_lshl_b32 s66, s5, 9
    s_add_u32 s66, s66, s65
    s_and_b32 s68, s66, 0xffffe000
    s_add_u32 s52, s66, s68
    s_add_u32 s52, s52, s47
    s_lshl_b32 s66, s4, 9
    s_add_u32 s66, s66, s65
    s_and_b32 s68, s66, 0xffffe000
    s_add_u32 s53, s66, s68
    s_add_u32 s53, s53, s47
    s_add_u32 s65, s7, 2
    s_and_b32 s65, s65, 3
    s_lshl_b32 s65, s65, 5
    s_add_u32 s65, s65, s6
    s_lshl_b32 s65, s65, 11
    s_add_u32 s65, s65, 663552
    s_lshl_b32 s66, s5, 9
    s_add_u32 s66, s66, s65
    s_and_b32 s68, s66, 0xffffe000
    s_add_u32 s54, s66, s68
    s_add_u32 s54, s54, s47
    s_and_b32 s65, s7, 1
    s_sub_u32 s61, 2, s65
    s_add_u32 s62, s65, 1
    s_lshl_b32 s65, s6, 6
    s_add_u32 s65, s65, s7
    s_lshl_b32 s66, s65, 13
    s_lshl_b32 s67, s5, 7
    s_add_u32 s66, s66, s67
    s_add_u32 s60, s66, 50331648
    s_add_u32 s65, s65, 1
    s_mul_i32 s59, s65, 24576
    s_add_u32 s98, s7, 1
    ds_read_b128 v[96:99], v0 offset:28672
    ds_read_b128 v[100:103], v0 offset:29696
    ds_read_b128 v[104:107], v0 offset:30720
    ds_read_b128 v[108:111], v0 offset:31744
    ds_read_b128 v[112:115], v0 offset:32768
    ds_read_b128 v[116:119], v0 offset:33792
    ds_read_b128 v[120:123], v0 offset:34816
    ds_read_b128 v[124:127], v0 offset:35840
    ds_read_b128 v[128:131], v0 offset:40960
    ds_read_b128 v[132:135], v0 offset:41984
    v_mov_b32 v72, 0
    v_mov_b32 v73, 0
    v_mov_b32 v74, 0
    v_mov_b32 v75, 0
    v_mov_b32 v76, 0
    v_mov_b32 v77, 0
    v_mov_b32 v78, 0
    v_mov_b32 v79, 0
    v_mov_b32 v80, 0
    v_mov_b32 v81, 0
    v_mov_b32 v82, 0
    v_mov_b32 v83, 0
    v_mov_b32 v84, 0
    v_mov_b32 v85, 0
    v_mov_b32 v86, 0
    v_mov_b32 v87, 0
    v_mov_b32 v88, 0
    v_mov_b32 v89, 0
    v_mov_b32 v90, 0
    v_mov_b32 v91, 0
    v_mov_b32 v92, 0
    v_mov_b32 v93, 0
    v_mov_b32 v94, 0
    v_mov_b32 v95, 0
    s_add_u32 s79, s7, 1
    s_and_b32 s74, s79, 1
    s_lshl_b32 s74, s74, 16
    s_min_u32 s79, s79, 63
    s_cmp_gt_u32 s63, s79
    s_cbranch_scc1 L_pw_ok_st_2
    s_lshl_b32 s78, s6, 9
    s_add_u32 s78, s78, 72220672
L_pw_st_2:
    v_mov_b32 v20, 0
    buffer_load_dword v24, v20, s[8:11], s78 offen sc1
    buffer_load_dword v25, v20, s[8:11], s78 offen offset:128 sc1
    buffer_load_dword v26, v20, s[8:11], s78 offen offset:256 sc1
    s_waitcnt vmcnt(0)
    v_min3_u32 v24, v24, v25, v26
    s_nop 0
    v_readfirstlane_b32 s63, v24
    s_cmp_gt_u32 s63, s79
    s_cbranch_scc1 L_pw_ok_st_2
    s_cmp_eq_u32 s46, 0
    s_cbranch_scc1 L_pw_ok_st_2
    s_sub_u32 s46, s46, 1
    s_branch L_pw_st_2
L_pw_ok_st_2:
    s_cmp_eq_u32 s7, 0
    s_cbranch_scc1 L_first_2
    s_barrier
    s_sleep 1
L_agstart_2:
L_agpoll_2:
    buffer_load_dwordx4 v[20:23], v1, s[8:11], s48 offen sc1
    buffer_load_dwordx4 v[24:27], v1, s[8:11], s49 offen sc1
    s_nop 2
    v_mov_b32 v139, v139
    s_nop 2
    v_mov_b32 v139, v139
    s_nop 2
    v_mov_b32 v139, v139
    s_nop 2
    v_mov_b32 v139, v139
    s_nop 2
    v_mov_b32 v139, v139
    s_nop 2
    v_mov_b32 v139, v139
    s_nop 2
    v_mov_b32 v139, v139
    s_nop 2
    v_mov_b32 v139, v139
    s_nop 2
    v_mov_b32 v139, v139
    s_waitcnt vmcnt(0)
    v_max3_u32 v32, v20, v21, v22
    v_max3_u32 v33, v23, v24, v25
    v_max3_u32 v32, v32, v26, v27
    v_max_u32 v32, v32, v33
    v_cmp_eq_u32 vcc, -1, v32
    s_cbranch_vccz L_agokA_2
    s_cmp_eq_u32 s46, 0
    s_cbranch_scc1 L_agokA_2
    s_sub_u32 s46, s46, 1
    s_branch L_agpoll_2
    buffer_load_dwordx4 v[20:23], v1, s[8:11], s48 offen sc1
    buffer_load_dwordx4 v[24:27], v1, s[8:11], s49 offen sc1
    s_nop 2
    v_mov_b32 v139, v139
    s_nop 2
    v_mov_b32 v139, v139
    s_nop 2
    v_mov_b32 v139, v139
    s_nop 2
    v_mov_b32 v139, v139
    s_nop 2
    v_mov_b32 v139, v139
    s_nop 2
    v_mov_b32 v139, v139
    buffer_load_dwordx4 v[40:43], v1, s[8:11], s48 offen sc1
    buffer_load_dwordx4 v[56:59], v1, s[8:11], s49 offen sc1
L_agpoll_2x:
    s_nop 2
    v_mov_b32 v139, v139
    s_nop 2
    v_mov_b32 v139, v139
    s_nop 2
    v_mov_b32 v139, v139
    s_nop 2
    v_mov_b32 v139, v139
    s_nop 2
    v_mov_b32 v139, v139
    s_nop 2
    v_mov_b32 v139, v139
    s_nop 2
    v_mov_b32 v139, v139
    s_nop 2
    v_mov_b32 v139, v139
    s_nop 2
    v_mov_b32 v139, v139
    s_waitcnt vmcnt(2)
    v_max3_u32 v32, v20, v21, v22
    v_max3_u32 v33, v23, v24, v25
    v_max3_u32 v32, v32, v26, v27
    v_max_u32 v32, v32, v33
    v_cmp_eq_u32 vcc, -1, v32
    s_cbranch_vccz L_agokA_2
    buffer_load_dwordx4 v[20:23], v1, s[8:11], s48 offen sc1
    buffer_load_dwordx4 v[24:27], v1, s[8:11], s49 offen sc1
    s_nop 2
    v_mov_b32 v139, v139
    s_nop 2
    v_mov_b32 v139, v139
    s_nop 2
    v_mov_b32 v139, v139
    s_nop 2
    v_mov_b32 v139, v139
    s_nop 2
    v_mov_b32 v139, v139
    s_nop 2
    v_mov_b32 v139, v139
    s_nop 2
    v_mov_b32 v139, v139
    s_nop 2
    v_mov_b32 v139, v139
    s_nop 2
    v_mov_b32 v139, v139
    s_waitcnt vmcnt(2)
    v_max3_u32 v32, v40, v41, v42
    v_max3_u32 v33, v43, v56, v57
    v_max3_u32 v32, v32, v58, v59
    v_max_u32 v32, v32, v33
    v_cmp_eq_u32 vcc, -1, v32
    s_cbranch_vccz L_agokB_2
    buffer_load_dwordx4 v[40:43], v1, s[8:11], s48 offen sc1
    buffer_load_dwordx4 v[56:59], v1, s[8:11], s49 offen sc1
    s_cmp_eq_u32 s46, 0
    s_cbranch_scc1 L_agokB_2
    s_sub_u32 s46, s46, 1
    s_branch L_agpoll_2x
L_first_2:
    s_mov_b32 s12, s26
    s_and_b32 s13, s27, 0xffff
    s_mov_b32 s14, 0x2800
    s_mov_b32 s15, 0x20000
    v_bfe_u32 v32, v1, 4, 3
    v_mul_u32_u24 v32, 1280, v32
    v_lshrrev_b32 v33, 7, v1
    v_lshl_add_u32 v32, v33, 4, v32
    buffer_load_dwordx4 v[20:23], v32, s[12:15], 0 offen offset:256
    buffer_load_dwordx4 v[24:27], v32, s[12:15], 0 offen offset:768
    s_waitcnt vmcnt(0)
L_agokA_2:
    v_smfmac_f32_16x16x64_bf16 v[88:91], v[20:23], v[144:151], v5
    v_smfmac_f32_16x16x64_bf16 v[92:95], v[20:23], v[152:159], v5
    v_smfmac_f32_16x16x64_bf16 v[88:91], v[24:27], v[160:167], v5
    v_smfmac_f32_16x16x64_bf16 v[92:95], v[24:27], v[168:175], v5
    ds_write_b128 v1, v[20:23] offset:2048
    v_smfmac_f32_16x16x64_bf16 v[72:75], v[20:23], v[208:215], v5
    ds_write_b128 v1, v[24:27] offset:6144
    v_smfmac_f32_16x16x64_bf16 v[76:79], v[20:23], a[112:119], v5
    v_smfmac_f32_16x16x64_bf16 v[80:83], v[20:23], a[32:39], v5
    v_permlane32_swap_b32 v88, v92
    v_permlane32_swap_b32 v89, v93
    v_smfmac_f32_16x16x64_bf16 v[84:87], v[20:23], a[192:199], v5
    v_permlane32_swap_b32 v90, v94
    v_permlane32_swap_b32 v91, v95
    v_smfmac_f32_16x16x64_bf16 v[72:75], v[24:27], v[240:247], v5
    v_add_f32 v88, v88, v92
    v_add_f32 v89, v89, v93
    v_smfmac_f32_16x16x64_bf16 v[76:79], v[24:27], a[144:151], v5
    v_add_f32 v90, v90, v94
    v_add_f32 v91, v91, v95
    v_smfmac_f32_16x16x64_bf16 v[80:83], v[24:27], a[64:71], v5
    ds_write_b128 v9, v[88:91] offset:24576
    v_smfmac_f32_16x16x64_bf16 v[84:87], v[24:27], a[224:231], v5
    s_add_u32 s65, s59, 0
    s_add_u32 m0, s74, 10240
    s_nop 0
    buffer_load_dwordx4 v142, s[8:11], s65 offen sc1 lds
    s_add_u32 s65, s59, 2048
    s_add_u32 m0, s74, 11264
    s_nop 0
    buffer_load_dwordx4 v142, s[8:11], s65 offen sc1 lds
    s_add_u32 s65, s59, 4096
    s_add_u32 m0, s74, 12288
    s_nop 0
    buffer_load_dwordx4 v142, s[8:11], s65 offen sc1 lds
    s_add_u32 s65, s59, 6144
    s_add_u32 m0, s74, 13312
    s_nop 0
    buffer_load_dwordx4 v142, s[8:11], s65 offen sc1 lds
    s_waitcnt vmcnt(4) lgkmcnt(0)
    s_barrier
    ds_read_b128 v[32:35], v1 offset:0
    ds_read_b128 v[36:39], v1 offset:1024
    ds_read_b128 v[20:23], v1 offset:24576
    ds_read_b128 v[24:27], v1 offset:25600
    ds_read_b128 v[88:91], v1 offset:26624
    ds_read_b128 v[92:95], v1 offset:27648
    ds_read_b128 v[44:47], v1 offset:3072
    ds_read_b128 v[48:51], v1 offset:4096
    ds_read_b128 v[52:55], v1 offset:5120
    ds_read_b128 v[60:63], v1 offset:7168
    ds_read_b128 v[64:67], v1 offset:8192
    ds_read_b128 v[68:71], v1 offset:9216
    s_branch L_join_2
L_agokB_2:
    v_smfmac_f32_16x16x64_bf16 v[88:91], v[40:43], v[144:151], v5
    v_smfmac_f32_16x16x64_bf16 v[92:95], v[40:43], v[152:159], v5
    v_smfmac_f32_16x16x64_bf16 v[88:91], v[56:59], v[160:167], v5
    v_smfmac_f32_16x16x64_bf16 v[92:95], v[56:59], v[168:175], v5
    ds_write_b128 v1, v[40:43] offset:2048
    v_smfmac_f32_16x16x64_bf16 v[72:75], v[40:43], v[208:215], v5
    ds_write_b128 v1, v[56:59] offset:6144
    v_smfmac_f32_16x16x64_bf16 v[76:79], v[40:43], a[112:119], v5
    v_smfmac_f32_16x16x64_bf16 v[80:83], v[40:43], a[32:39], v5
    v_permlane32_swap_b32 v88, v92
    v_permlane32_swap_b32 v89, v93
    v_smfmac_f32_16x16x64_bf16 v[84:87], v[40:43], a[192:199], v5
    v_permlane32_swap_b32 v90, v94
    v_permlane32_swap_b32 v91, v95
    v_smfmac_f32_16x16x64_bf16 v[72:75], v[56:59], v[240:247], v5
    v_add_f32 v88, v88, v92
    v_add_f32 v89, v89, v93
    v_smfmac_f32_16x16x64_bf16 v[76:79], v[56:59], a[144:151], v5
    v_add_f32 v90, v90, v94
    v_add_f32 v91, v91, v95
    v_smfmac_f32_16x16x64_bf16 v[80:83], v[56:59], a[64:71], v5
    ds_write_b128 v9, v[88:91] offset:24576
    v_smfmac_f32_16x16x64_bf16 v[84:87], v[56:59], a[224:231], v5
    s_add_u32 s65, s59, 0
    s_add_u32 m0, s74, 10240
    s_nop 0
    buffer_load_dwordx4 v142, s[8:11], s65 offen sc1 lds
    s_add_u32 s65, s59, 2048
    s_add_u32 m0, s74, 11264
    s_nop 0
    buffer_load_dwordx4 v142, s[8:11], s65 offen sc1 lds
    s_add_u32 s65, s59, 4096
    s_add_u32 m0, s74, 12288
    s_nop 0
    buffer_load_dwordx4 v142, s[8:11], s65 offen sc1 lds
    s_add_u32 s65, s59, 6144
    s_add_u32 m0, s74, 13312
    s_nop 0
    buffer_load_dwordx4 v142, s[8:11], s65 offen sc1 lds
    s_waitcnt vmcnt(4) lgkmcnt(0)
    s_barrier
    ds_read_b128 v[32:35], v1 offset:0
    ds_read_b128 v[36:39], v1 offset:1024
    ds_read_b128 v[20:23], v1 offset:24576
    ds_read_b128 v[24:27], v1 offset:25600
    ds_read_b128 v[88:91], v1 offset:26624
    ds_read_b128 v[92:95], v1 offset:27648
    ds_read_b128 v[44:47], v1 offset:3072
    ds_read_b128 v[48:51], v1 offset:4096
    ds_read_b128 v[52:55], v1 offset:5120
    ds_read_b128 v[60:63], v1 offset:7168
    ds_read_b128 v[64:67], v1 offset:8192
    ds_read_b128 v[68:71], v1 offset:9216
L_join_2:
    s_waitcnt lgkmcnt(11)
    v_smfmac_f32_16x16x64_bf16 v[72:75], v[32:35], v[192:199], v5
    v_smfmac_f32_16x16x64_bf16 v[76:79], v[32:35], a[96:103], v5
    s_waitcnt lgkmcnt(10)
    v_smfmac_f32_16x16x64_bf16 v[72:75], v[36:39], v[200:207], v5
    v_smfmac_f32_16x16x64_bf16 v[76:79], v[36:39], a[104:111], v5
    s_waitcnt lgkmcnt(5)
    v_smfmac_f32_16x16x64_bf16 v[72:75], v[44:47], v[216:223], v5
    v_add_f32 v20, v20, v24
    v_add_f32 v21, v21, v25
    v_smfmac_f32_16x16x64_bf16 v[76:79], v[44:47], a[120:127], v5
    v_add_f32 v22, v22, v26
    v_add_f32 v23, v23, v27
    s_waitcnt lgkmcnt(4)
    v_smfmac_f32_16x16x64_bf16 v[72:75], v[48:51], v[224:231], v5
    v_add_f32 v88, v88, v92
    v_add_f32 v89, v89, v93
    v_smfmac_f32_16x16x64_bf16 v[76:79], v[48:51], a[128:135], v5
    v_add_f32 v90, v90, v94
    v_add_f32 v91, v91, v95
    s_waitcnt lgkmcnt(3)
    v_smfmac_f32_16x16x64_bf16 v[72:75], v[52:55], v[232:239], v5
    v_add_f32 v20, v20, v88
    v_add_f32 v21, v21, v89
    v_smfmac_f32_16x16x64_bf16 v[76:79], v[52:55], a[136:143], v5
    v_add_f32 v22, v22, v90
    v_add_f32 v23, v23, v91
    s_waitcnt lgkmcnt(2)
    v_smfmac_f32_16x16x64_bf16 v[72:75], v[60:63], v[248:255], v5
    v_cvt_pk_bf16_f32 v24, v20, v21
    v_cvt_pk_bf16_f32 v25, v22, v23
    v_smfmac_f32_16x16x64_bf16 v[76:79], v[60:63], a[152:159], v5
    v_min_u32 v24, -2, v24
    v_min_u32 v25, -2, v25
    s_waitcnt lgkmcnt(1)
    v_smfmac_f32_16x16x64_bf16 v[72:75], v[64:67], a[0:7], v5
    buffer_store_dwordx2 v[24:25], v18, s[8:11], s52 offen sc1
    v_smfmac_f32_16x16x64_bf16 v[76:79], v[64:67], a[160:167], v5
    s_waitcnt lgkmcnt(0)
    v_smfmac_f32_16x16x64_bf16 v[72:75], v[68:71], a[8:15], v5
    v_smfmac_f32_16x16x64_bf16 v[76:79], v[68:71], a[168:175], v5
    v_smfmac_f32_16x16x64_bf16 v[80:83], v[32:35], a[16:23], v5
    v_smfmac_f32_16x16x64_bf16 v[84:87], v[32:35], a[176:183], v5
    s_nop 0
    v_permlane32_swap_b32 v72, v76
    v_smfmac_f32_16x16x64_bf16 v[80:83], v[36:39], a[24:31], v5
    v_permlane32_swap_b32 v73, v77
    v_smfmac_f32_16x16x64_bf16 v[84:87], v[36:39], a[184:191], v5
    v_permlane32_swap_b32 v74, v78
    v_smfmac_f32_16x16x64_bf16 v[80:83], v[44:47], a[40:47], v5
    v_permlane32_swap_b32 v75, v79
    v_smfmac_f32_16x16x64_bf16 v[84:87], v[44:47], a[200:207], v5
    v_add_f32 v72, v72, v76
    v_smfmac_f32_16x16x64_bf16 v[80:83], v[48:51], a[48:55], v5
    v_add_f32 v73, v73, v77
    v_smfmac_f32_16x16x64_bf16 v[84:87], v[48:51], a[208:215], v5
    v_add_f32 v74, v74, v78
    v_smfmac_f32_16x16x64_bf16 v[80:83], v[52:55], a[56:63], v5
    v_add_f32 v75, v75, v79
    v_smfmac_f32_16x16x64_bf16 v[84:87], v[52:55], a[216:223], v5
    v_cvt_pk_bf16_f32 v76, v72, v73
    v_smfmac_f32_16x16x64_bf16 v[80:83], v[60:63], a[72:79], v5
    v_cvt_pk_bf16_f32 v77, v74, v75
    v_smfmac_f32_16x16x64_bf16 v[84:87], v[60:63], a[232:239], v5
    ds_write_b32 v3, v76 offset:0
    v_smfmac_f32_16x16x64_bf16 v[80:83], v[64:67], a[80:87], v5
    ds_write_b32 v143, v77 offset:0
    v_smfmac_f32_16x16x64_bf16 v[84:87], v[64:67], a[240:247], v5
    v_smfmac_f32_16x16x64_bf16 v[80:83], v[68:71], a[88:95], v5
    v_smfmac_f32_16x16x64_bf16 v[84:87], v[68:71], a[248:255], v5
    s_nop 7
    v_permlane32_swap_b32 v80, v84
    v_permlane32_swap_b32 v81, v85
    v_permlane32_swap_b32 v82, v86
    v_permlane32_swap_b32 v83, v87
    v_add_f32 v80, v80, v84
    v_add_f32 v81, v81, v85
    v_add_f32 v82, v82, v86
    v_add_f32 v83, v83, v87
    v_cvt_pk_bf16_f32 v84, v80, v81
    v_cvt_pk_bf16_f32 v85, v82, v83
    ds_write_b32 v3, v84 offset:512
    ds_write_b32 v143, v85 offset:512
    v_mov_b32 v136, -1
    v_mov_b32 v138, -1
    buffer_load_dword v136, v8, s[8:11], s53 offen sc1
    buffer_load_dword v138, v8, s[8:11], s53 offen offset:256 sc1
    s_waitcnt lgkmcnt(0)
    s_barrier
    s_max_u32 s65, s7, 1
    s_sub_u32 s65, s65, 1
    s_lshl_b32 s66, s6, 2
    s_add_u32 s66, s66, s5
    s_lshl_b32 s66, s66, 7
    s_add_u32 s66, s66, 72155136
    v_mov_b32 v92, s65
    v_mov_b32 v93, s65
    v_mov_b32 v94, s65
    v_mov_b32 v95, s65
    s_mov_b64 exec, 0xff
    buffer_store_dwordx4 v[92:95], v1, s[8:11], s66 offen sc1
    s_mov_b64 exec, -1
    ds_read_b64_tr_b16 v[32:33], v2 offset:0
    ds_read_b64_tr_b16 v[34:35], v2 offset:256
    ds_read_b64_tr_b16 v[48:49], v2 offset:4096
    ds_read_b64_tr_b16 v[50:51], v2 offset:4352
    ds_read_b64_tr_b16 v[36:37], v2 offset:1024
    ds_read_b64_tr_b16 v[38:39], v2 offset:1280
    ds_read_b64_tr_b16 v[52:53], v2 offset:5120
    ds_read_b64_tr_b16 v[54:55], v2 offset:5376
    ds_read_b64_tr_b16 v[40:41], v2 offset:2048
    ds_read_b64_tr_b16 v[42:43], v2 offset:2304
    ds_read_b64_tr_b16 v[56:57], v2 offset:6144
    ds_read_b64_tr_b16 v[58:59], v2 offset:6400
    ds_read_b64_tr_b16 v[44:45], v2 offset:3072
    ds_read_b64_tr_b16 v[46:47], v2 offset:3328
    ds_read_b64_tr_b16 v[60:61], v2 offset:7168
    ds_read_b64_tr_b16 v[62:63], v2 offset:7424
    s_waitcnt lgkmcnt(12)
    v_mfma_f32_16x16x32_bf16 v[68:71], v[96:99], v[32:35], 0
    ds_read_b128 v[20:23], v9 offset:20480
    v_mfma_f32_16x16x32_bf16 v[72:75], v[112:115], v[32:35], 0
    v_mfma_f32_16x16x32_bf16 v[64:67], v[48:51], v[32:35], 0
    s_waitcnt lgkmcnt(9)
    v_mfma_f32_16x16x32_bf16 v[68:71], v[100:103], v[36:39], v[68:71]
    v_mfma_f32_16x16x32_bf16 v[72:75], v[116:119], v[36:39], v[72:75]
    v_mfma_f32_16x16x32_bf16 v[64:67], v[52:55], v[36:39], v[64:67]
    s_waitcnt lgkmcnt(5)
    v_mfma_f32_16x16x32_bf16 v[68:71], v[104:107], v[40:43], v[68:71]
    v_mfma_f32_16x16x32_bf16 v[72:75], v[120:123], v[40:43], v[72:75]
    v_mfma_f32_16x16x32_bf16 v[64:67], v[56:59], v[40:43], v[64:67]
    s_waitcnt lgkmcnt(1)
    v_mfma_f32_16x16x32_bf16 v[68:71], v[108:111], v[44:47], v[68:71]
    v_mfma_f32_16x16x32_bf16 v[72:75], v[124:127], v[44:47], v[72:75]
    v_mfma_f32_16x16x32_bf16 v[64:67], v[60:63], v[44:47], v[64:67]
    s_waitcnt lgkmcnt(0)
    buffer_store_dwordx4 v[20:23], v7, s[8:11], s99 offen sc1
    s_nop 0
    v_pk_fma_f32 v[68:69], v[68:69], s[70:71], v[10:11]
    s_nop 0
    v_pk_fma_f32 v[70:71], v[70:71], s[70:71], v[12:13]
    s_nop 0
    v_pk_fma_f32 v[72:73], v[72:73], s[70:71], v[14:15]
    v_pk_fma_f32 v[74:75], v[74:75], s[70:71], v[16:17]
    v_pk_mul_f32 v[64:65], v[64:65], s[70:71]
    v_max3_f32 v76, v68, v69, v70
    v_max3_f32 v77, v71, v72, v73
    v_max3_f32 v76, v76, v74, v75
    v_max3_f32 v77, v77, v64, v65
    v_max_f32 v76, v76, v77
    v_mov_b32 v77, v76
    ds_read_b128 v[96:99], v4 offset:0
    ds_read_b128 v[100:103], v4 offset:1024
    v_permlane32_swap_b32 v76, v77
    v_max_f32 v76, v76, v77
    v_mov_b32 v77, v76
    ds_read_b128 v[104:107], v4 offset:2048
    ds_read_b128 v[108:111], v4 offset:3072
    v_permlane16_swap_b32 v76, v77
    v_max_f32 v76, v76, v77
    v_pk_add_f32 v[68:69], v[68:69], v[76:77] op_sel_hi:[1,0] neg_lo:[0,1] neg_hi:[0,1]
    v_pk_add_f32 v[70:71], v[70:71], v[76:77] op_sel_hi:[1,0] neg_lo:[0,1] neg_hi:[0,1]
    v_pk_add_f32 v[72:73], v[72:73], v[76:77] op_sel_hi:[1,0] neg_lo:[0,1] neg_hi:[0,1]
    v_pk_add_f32 v[74:75], v[74:75], v[76:77] op_sel_hi:[1,0] neg_lo:[0,1] neg_hi:[0,1]
    v_pk_add_f32 v[64:65], v[64:65], v[76:77] op_sel_hi:[1,0] neg_lo:[0,1] neg_hi:[0,1]
    v_exp_f32 v68, v68
    ds_read_b128 v[112:115], v4 offset:4096
    v_exp_f32 v69, v69
    ds_read_b128 v[116:119], v4 offset:5120
    v_exp_f32 v70, v70
    ds_read_b128 v[120:123], v4 offset:6144
    v_exp_f32 v71, v71
    ds_read_b128 v[124:127], v4 offset:7168
    v_exp_f32 v72, v72
    v_exp_f32 v73, v73
    v_exp_f32 v74, v74
    v_exp_f32 v75, v75
    v_cvt_pk_bf16_f32 v88, v68, v69
    v_cvt_pk_bf16_f32 v89, v70, v71
    v_exp_f32 v64, v64
    v_cvt_pk_bf16_f32 v90, v72, v73
    v_exp_f32 v65, v65
    v_cvt_pk_bf16_f32 v91, v74, v75
    v_mov_b32 v93, 0
    v_cvt_pk_bf16_f32 v92, v64, v65
    v_mfma_f32_16x16x32_bf16 v[76:79], v[128:131], v[88:91], 0
    v_mfma_f32_16x16x32_bf16 v[80:83], v[132:135], v[88:91], 0
    s_waitcnt vmcnt(2)
L_vmchk_2:
    v_max_u32 v94, v136, v138
    v_cmp_eq_u32 vcc, -1, v94
    s_cbranch_vccnz L_vmretry_2
L_vmok_2:
    v_mfma_f32_16x16x16_bf16 v[76:79], v[136:137], v[92:93], v[76:79]
    v_mfma_f32_16x16x16_bf16 v[80:83], v[138:139], v[92:93], v[80:83]
    v_add_f32 v68, v68, v69
    v_add_f32 v70, v70, v71
    v_add_f32 v72, v72, v73
    v_add_f32 v74, v74, v75
    v_add_f32 v64, v64, v65
    v_add_f32 v68, v68, v70
    v_add_f32 v72, v72, v74
    v_add_f32 v68, v68, v64
    v_add_f32 v68, v68, v72
    v_mov_b32 v69, v68
    s_nop 1
    v_permlane32_swap_b32 v68, v69
    v_add_f32 v68, v68, v69
    v_mov_b32 v69, v68
    s_nop 1
    v_permlane16_swap_b32 v68, v69
    v_add_f32 v68, v68, v69
    v_rcp_f32 v68, v68
    s_nop 0
    v_pk_mul_f32 v[76:77], v[76:77], v[68:69] op_sel_hi:[1,0]
    v_pk_mul_f32 v[78:79], v[78:79], v[68:69] op_sel_hi:[1,0]
    v_pk_mul_f32 v[80:81], v[80:81], v[68:69] op_sel_hi:[1,0]
    v_pk_mul_f32 v[82:83], v[82:83], v[68:69] op_sel_hi:[1,0]
    v_cvt_pk_bf16_f32 v84, v76, v77
    v_cvt_pk_bf16_f32 v85, v78, v79
    v_cvt_pk_bf16_f32 v86, v80, v81
    v_cvt_pk_bf16_f32 v87, v82, v83
    s_cmp_eq_u32 s7, 63
    s_cbranch_scc1 L_last_2
    ds_write_b128 v9, v[84:87] offset:20480
    s_waitcnt lgkmcnt(0)
    s_barrier
    ds_read_b128 v[32:35], v1 offset:20480
    ds_read_b128 v[36:39], v1 offset:21504
    ds_read_b128 v[40:43], v1 offset:22528
    ds_read_b128 v[44:47], v1 offset:23552
    s_waitcnt lgkmcnt(3)
    v_mfma_f32_16x16x32_bf16 v[64:67], v[96:99], v[32:35], 0
    v_mfma_f32_16x16x32_bf16 v[68:71], v[112:115], v[32:35], 0
    s_waitcnt lgkmcnt(2)
    v_mfma_f32_16x16x32_bf16 v[64:67], v[100:103], v[36:39], v[64:67]
    v_mfma_f32_16x16x32_bf16 v[68:71], v[116:119], v[36:39], v[68:71]
    s_waitcnt lgkmcnt(1)
    v_mfma_f32_16x16x32_bf16 v[64:67], v[104:107], v[40:43], v[64:67]
    v_mfma_f32_16x16x32_bf16 v[68:71], v[120:123], v[40:43], v[68:71]
    s_waitcnt lgkmcnt(0)
    v_mfma_f32_16x16x32_bf16 v[64:67], v[108:111], v[44:47], v[64:67]
    v_mfma_f32_16x16x32_bf16 v[68:71], v[124:127], v[44:47], v[68:71]
    s_nop 6
    v_bfi_b32 v64, 3, s61, v64
    buffer_store_dwordx4 v[64:67], v6, s[8:11], s55 offen
    v_bfi_b32 v68, 3, s61, v68
    buffer_store_dwordx4 v[68:71], v6, s[8:11], s56 offen
L_next_2:
    s_add_u32 s99, s60, 4096
    v_xor_b32 v0, 0x10000, v0
    v_xor_b32 v2, 0x10000, v2
    v_xor_b32 v3, 0x10000, v3
    v_xor_b32 v143, 0x10000, v143
    s_add_u32 s7, s7, 1
    s_branch L_step_2
L_vmretry_2:
    s_cmp_eq_u32 s46, 0
    s_cbranch_scc1 L_vmok_2
    s_sub_u32 s46, s46, 1
    buffer_load_dword v136, v8, s[8:11], s53 offen sc1
    buffer_load_dword v138, v8, s[8:11], s53 offen offset:256 sc1
    s_waitcnt vmcnt(0)
    s_branch L_vmchk_2
L_last_2:
    s_add_u32 s65, s60, 4096
    buffer_store_dwordx4 v[84:87], v7, s[8:11], s65 offen sc1
    s_waitcnt vmcnt(0)
    s_barrier
    s_mov_b32 s65, 64
    s_lshl_b32 s66, s6, 2
    s_add_u32 s66, s66, s5
    s_lshl_b32 s66, s66, 7
    s_add_u32 s66, s66, 72155136
    v_mov_b32 v92, s65
    v_mov_b32 v93, s65
    v_mov_b32 v94, s65
    v_mov_b32 v95, s65
    s_mov_b64 exec, 0xff
    buffer_store_dwordx4 v[92:95], v1, s[8:11], s66 offen sc1
    s_mov_b64 exec, -1
    s_branch L_chain_end
L_start_3:
    s_add_u32 s65, s59, 18688
    s_add_u32 m0, s74, 39936
    s_nop 0
    buffer_load_dwordx4 v141, s[8:11], s65 offen sc1 lds
    s_add_u32 s65, s59, 20480
    s_add_u32 m0, s74, 40960
    s_nop 0
    buffer_load_dwordx4 v141, s[8:11], s65 offen sc1 lds
    s_add_u32 s65, s59, 20736
    s_add_u32 m0, s74, 41984
    s_nop 0
    buffer_load_dwordx4 v141, s[8:11], s65 offen sc1 lds
    s_add_u32 s65, s59, 22528
    s_add_u32 m0, s74, 43008
    s_nop 0
    buffer_load_dwordx4 v141, s[8:11], s65 offen sc1 lds
    s_add_u32 s65, s59, 22784
    s_add_u32 m0, s74, 44032
    s_nop 0
    buffer_load_dwordx4 v141, s[8:11], s65 offen sc1 lds
    s_waitcnt vmcnt(0)
    s_barrier
L_step_3:
    s_mul_i32 s65, s7, 10240
    s_add_u32 s65, s65, 0x2000
    s_lshl_b32 s66, s4, 10
    s_add_u32 s66, s66, s65
    s_and_b32 s68, s66, 0xffffe000
    s_add_u32 s48, s66, s68
    s_add_u32 s48, s48, s47
    s_add_u32 s66, s66, 4096
    s_and_b32 s68, s66, 0xffffe000
    s_add_u32 s49, s66, s68
    s_add_u32 s49, s49, s47
    s_lshl_b32 s66, s64, 10
    s_add_u32 s66, s66, s65
    s_and_b32 s68, s66, 0xffffe000
    s_add_u32 s50, s66, s68
    s_add_u32 s50, s50, s47
    s_lshl_b32 s66, s75, 7
    s_add_u32 s66, s66, s65
    s_add_u32 s66, s66, 10240
    s_and_b32 s68, s66, 0xffffe000
    s_add_u32 s51, s66, s68
    s_add_u32 s51, s51, s47
    s_and_b32 s65, s7, 3
    s_lshl_b32 s65, s65, 5
    s_add_u32 s65, s65, s6
    s_lshl_b32 s65, s65, 11
    s_add_u32 s65, s65, 663552
    s_lshl_b32 s66, s5, 9
    s_add_u32 s66, s66, s65
    s_and_b32 s68, s66, 0xffffe000
    s_add_u32 s52, s66, s68
    s_add_u32 s52, s52, s47
    s_lshl_b32 s66, s4, 9
    s_add_u32 s66, s66, s65
    s_and_b32 s68, s66, 0xffffe000
    s_add_u32 s53, s66, s68
    s_add_u32 s53, s53, s47
    s_add_u32 s65, s7, 2
    s_and_b32 s65, s65, 3
    s_lshl_b32 s65, s65, 5
    s_add_u32 s65, s65, s6
    s_lshl_b32 s65, s65, 11
    s_add_u32 s65, s65, 663552
    s_lshl_b32 s66, s5, 9
    s_add_u32 s66, s66, s65
    s_and_b32 s68, s66, 0xffffe000
    s_add_u32 s54, s66, s68
    s_add_u32 s54, s54, s47
    s_and_b32 s65, s7, 1
    s_sub_u32 s61, 2, s65
    s_add_u32 s62, s65, 1
    s_lshl_b32 s65, s6, 6
    s_add_u32 s65, s65, s7
    s_lshl_b32 s66, s65, 13
    s_lshl_b32 s67, s5, 7
    s_add_u32 s66, s66, s67
    s_add_u32 s60, s66, 50331648
    s_add_u32 s65, s65, 1
    s_mul_i32 s59, s65, 24576
    s_add_u32 s98, s7, 1
    s_add_u32 s79, s7, 1
    s_and_b32 s74, s79, 1
    s_lshl_b32 s74, s74, 16
    s_min_u32 s79, s79, 63
    s_cmp_gt_u32 s63, s79
    s_cbranch_scc1 L_pw_ok_st_3
    s_lshl_b32 s78, s6, 9
    s_add_u32 s78, s78, 72220672
L_pw_st_3:
    v_mov_b32 v20, 0
    buffer_load_dword v24, v20, s[8:11], s78 offen sc1
    buffer_load_dword v25, v20, s[8:11], s78 offen offset:128 sc1
    buffer_load_dword v26, v20, s[8:11], s78 offen offset:256 sc1
    s_waitcnt vmcnt(0)
    v_min3_u32 v24, v24, v25, v26
    s_nop 0
    v_readfirstlane_b32 s63, v24
    s_cmp_gt_u32 s63, s79
    s_cbranch_scc1 L_pw_ok_st_3
    s_cmp_eq_u32 s46, 0
    s_cbranch_scc1 L_pw_ok_st_3
    s_sub_u32 s46, s46, 1
    s_branch L_pw_st_3
L_pw_ok_st_3:
    s_cmp_eq_u32 s7, 0
    s_cbranch_scc1 L_nored_3
    s_cmp_ge_u32 s6, 20
    s_cbranch_scc1 L_nored_3
    s_sleep 2
    buffer_load_dwordx4 v[32:35], v1, s[8:11], s58 offen offset:0 sc1
    buffer_load_dwordx4 v[36:39], v1, s[8:11], s58 offen offset:1024 sc1
    buffer_load_dwordx4 v[40:43], v1, s[8:11], s58 offen offset:2048 sc1
    buffer_load_dwordx4 v[44:47], v1, s[8:11], s58 offen offset:3072 sc1
    buffer_load_dwordx4 v[48:51], v1, s[8:11], s72 offen offset:0 sc1
    buffer_load_dwordx4 v[52:55], v1, s[8:11], s72 offen offset:1024 sc1
    buffer_load_dwordx4 v[56:59], v1, s[8:11], s72 offen offset:2048 sc1
    buffer_load_dwordx4 v[60:63], v1, s[8:11], s72 offen offset:3072 sc1
    buffer_load_dwordx4 v[64:67], v1, s[8:11], s58 offen offset:0 sc1
    buffer_load_dwordx4 v[68:71], v1, s[8:11], s58 offen offset:1024 sc1
    buffer_load_dwordx4 v[72:75], v1, s[8:11], s58 offen offset:2048 sc1
    buffer_load_dwordx4 v[76:79], v1, s[8:11], s58 offen offset:3072 sc1
    buffer_load_dwordx4 v[80:83], v1, s[8:11], s72 offen offset:0 sc1
    buffer_load_dwordx4 v[84:87], v1, s[8:11], s72 offen offset:1024 sc1
    buffer_load_dwordx4 v[88:91], v1, s[8:11], s72 offen offset:2048 sc1
    buffer_load_dwordx4 v[92:95], v1, s[8:11], s72 offen offset:3072 sc1
L_rspoll_3:
    s_nop 2
    v_mov_b32 v139, v139
    s_nop 2
    v_mov_b32 v139, v139
    s_nop 2
    v_mov_b32 v139, v139
    s_waitcnt vmcnt(8)
    v_or3_b32 v20, v32, v36, v40
    v_or3_b32 v21, v44, v48, v52
    v_or3_b32 v20, v20, v56, v60
    v_or_b32 v20, v20, v21
    v_and_b32 v20, s77, v20
    v_cmp_ne_u32 vcc, 0, v20
    s_cbranch_vccz L_rsokA_3
    buffer_load_dwordx4 v[32:35], v1, s[8:11], s58 offen offset:0 sc1
    buffer_load_dwordx4 v[36:39], v1, s[8:11], s58 offen offset:1024 sc1
    buffer_load_dwordx4 v[40:43], v1, s[8:11], s58 offen offset:2048 sc1
    buffer_load_dwordx4 v[44:47], v1, s[8:11], s58 offen offset:3072 sc1
    buffer_load_dwordx4 v[48:51], v1, s[8:11], s72 offen offset:0 sc1
    buffer_load_dwordx4 v[52:55], v1, s[8:11], s72 offen offset:1024 sc1
    buffer_load_dwordx4 v[56:59], v1, s[8:11], s72 offen offset:2048 sc1
    buffer_load_dwordx4 v[60:63], v1, s[8:11], s72 offen offset:3072 sc1
    s_nop 2
    v_mov_b32 v139, v139
    s_nop 2
    v_mov_b32 v139, v139
    s_nop 2
    v_mov_b32 v139, v139
    s_waitcnt vmcnt(8)
    v_or3_b32 v20, v64, v68, v72
    v_or3_b32 v21, v76, v80, v84
    v_or3_b32 v20, v20, v88, v92
    v_or_b32 v20, v20, v21
    v_and_b32 v20, s77, v20
    v_cmp_ne_u32 vcc, 0, v20
    s_cbranch_vccz L_rsokB_3
    buffer_load_dwordx4 v[64:67], v1, s[8:11], s58 offen offset:0 sc1
    buffer_load_dwordx4 v[68:71], v1, s[8:11], s58 offen offset:1024 sc1
    buffer_load_dwordx4 v[72:75], v1, s[8:11], s58 offen offset:2048 sc1
    buffer_load_dwordx4 v[76:79], v1, s[8:11], s58 offen offset:3072 sc1
    buffer_load_dwordx4 v[80:83], v1, s[8:11], s72 offen offset:0 sc1
    buffer_load_dwordx4 v[84:87], v1, s[8:11], s72 offen offset:1024 sc1
    buffer_load_dwordx4 v[88:91], v1, s[8:11], s72 offen offset:2048 sc1
    buffer_load_dwordx4 v[92:95], v1, s[8:11], s72 offen offset:3072 sc1
    s_cmp_eq_u32 s46, 0
    s_cbranch_scc1 L_rsokB_3
    s_sub_u32 s46, s46, 1
    s_branch L_rspoll_3
L_rsokA_3:
    s_mul_i32 s65, s5, 1280
    s_mul_i32 s66, s6, 64
    s_add_u32 s65, s65, s66
    s_add_u32 s65, s65, s47
    s_add_u32 s65, s65, 1024
    v_mov_b32 v20, s7
    v_mov_b32 v21, 0
    s_mov_b64 exec, 1
    buffer_store_dword v20, v21, s[8:11], s65 offen
    s_mov_b64 exec, -1
    v_pk_add_f32 v[32:33], v[32:33], v[36:37]
    v_pk_add_f32 v[34:35], v[34:35], v[38:39]
    v_pk_add_f32 v[40:41], v[40:41], v[44:45]
    v_pk_add_f32 v[42:43], v[42:43], v[46:47]
    v_pk_add_f32 v[48:49], v[48:49], v[52:53]
    v_pk_add_f32 v[50:51], v[50:51], v[54:55]
    v_pk_add_f32 v[56:57], v[56:57], v[60:61]
    v_pk_add_f32 v[58:59], v[58:59], v[62:63]
    v_pk_add_f32 v[32:33], v[32:33], v[40:41]
    v_pk_add_f32 v[34:35], v[34:35], v[42:43]
    v_pk_add_f32 v[48:49], v[48:49], v[56:57]
    v_pk_add_f32 v[50:51], v[50:51], v[58:59]
    v_pk_add_f32 v[32:33], v[32:33], v[48:49]
    v_pk_add_f32 v[34:35], v[34:35], v[50:51]
    s_nop 0
    v_permlane32_swap_b32 v32, v33
    v_permlane32_swap_b32 v34, v35
    v_add_f32 v32, v32, v33
    v_add_f32 v34, v34, v35
    s_nop 1
    v_permlane16_swap_b32 v32, v34
    v_add_f32 v32, v32, v34
    v_mov_b32 v33, v32
    s_nop 1
    v_permlane32_swap_b32 v32, v33
    v_cvt_pk_bf16_f32 v32, v32, v33
    v_min_u32 v32, -2, v32
    buffer_store_dword v32, v19, s[8:11], s76 offen sc1
    s_waitcnt vmcnt(1)
    s_branch L_nored_3
L_rsokB_3:
    s_mul_i32 s65, s5, 1280
    s_mul_i32 s66, s6, 64
    s_add_u32 s65, s65, s66
    s_add_u32 s65, s65, s47
    s_add_u32 s65, s65, 1024
    v_mov_b32 v20, s7
    v_mov_b32 v21, 0
    s_mov_b64 exec, 1
    buffer_store_dword v20, v21, s[8:11], s65 offen
    s_mov_b64 exec, -1
    v_pk_add_f32 v[64:65], v[64:65], v[68:69]
    v_pk_add_f32 v[66:67], v[66:67], v[70:71]
    v_pk_add_f32 v[72:73], v[72:73], v[76:77]
    v_pk_add_f32 v[74:75], v[74:75], v[78:79]
    v_pk_add_f32 v[80:81], v[80:81], v[84:85]
    v_pk_add_f32 v[82:83], v[82:83], v[86:87]
    v_pk_add_f32 v[88:89], v[88:89], v[92:93]
    v_pk_add_f32 v[90:91], v[90:91], v[94:95]
    v_pk_add_f32 v[64:65], v[64:65], v[72:73]
    v_pk_add_f32 v[66:67], v[66:67], v[74:75]
    v_pk_add_f32 v[80:81], v[80:81], v[88:89]
    v_pk_add_f32 v[82:83], v[82:83], v[90:91]
    v_pk_add_f32 v[64:65], v[64:65], v[80:81]
    v_pk_add_f32 v[66:67], v[66:67], v[82:83]
    s_nop 0
    v_permlane32_swap_b32 v64, v65
    v_permlane32_swap_b32 v66, v67
    v_add_f32 v64, v64, v65
    v_add_f32 v66, v66, v67
    s_nop 1
    v_permlane16_swap_b32 v64, v66
    v_add_f32 v64, v64, v66
    v_mov_b32 v65, v64
    s_nop 1
    v_permlane32_swap_b32 v64, v65
    v_cvt_pk_bf16_f32 v64, v64, v65
    v_min_u32 v64, -2, v64
    buffer_store_dword v64, v19, s[8:11], s76 offen sc1
    s_waitcnt vmcnt(1)
L_nored_3:
    ds_read_b128 v[96:99], v0 offset:28672
    ds_read_b128 v[100:103], v0 offset:29696
    ds_read_b128 v[104:107], v0 offset:30720
    ds_read_b128 v[108:111], v0 offset:31744
    ds_read_b128 v[112:115], v0 offset:32768
    ds_read_b128 v[116:119], v0 offset:33792
    ds_read_b128 v[120:123], v0 offset:34816
    ds_read_b128 v[124:127], v0 offset:35840
    ds_read_b128 v[128:131], v0 offset:43008
    ds_read_b128 v[132:135], v0 offset:44032
    v_mov_b32 v72, 0
    v_mov_b32 v73, 0
    v_mov_b32 v74, 0
    v_mov_b32 v75, 0
    v_mov_b32 v76, 0
    v_mov_b32 v77, 0
    v_mov_b32 v78, 0
    v_mov_b32 v79, 0
    v_mov_b32 v80, 0
    v_mov_b32 v81, 0
    v_mov_b32 v82, 0
    v_mov_b32 v83, 0
    v_mov_b32 v84, 0
    v_mov_b32 v85, 0
    v_mov_b32 v86, 0
    v_mov_b32 v87, 0
    v_mov_b32 v88, 0
    v_mov_b32 v89, 0
    v_mov_b32 v90, 0
    v_mov_b32 v91, 0
    v_mov_b32 v92, 0
    v_mov_b32 v93, 0
    v_mov_b32 v94, 0
    v_mov_b32 v95, 0
    s_cmp_eq_u32 s7, 0
    s_cbranch_scc1 L_first_3
    s_barrier
    s_sleep 1
L_agstart_3:
L_agpoll_3:
    buffer_load_dwordx4 v[20:23], v1, s[8:11], s48 offen sc1
    buffer_load_dwordx4 v[24:27], v1, s[8:11], s49 offen sc1
    s_nop 2
    v_mov_b32 v139, v139
    s_nop 2
    v_mov_b32 v139, v139
    s_nop 2
    v_mov_b32 v139, v139
    s_nop 2
    v_mov_b32 v139, v139
    s_nop 2
    v_mov_b32 v139, v139
    s_nop 2
    v_mov_b32 v139, v139
    s_nop 2
    v_mov_b32 v139, v139
    s_nop 2
    v_mov_b32 v139, v139
    s_nop 2
    v_mov_b32 v139, v139
    s_waitcnt vmcnt(0)
    v_max3_u32 v32, v20, v21, v22
    v_max3_u32 v33, v23, v24, v25
    v_max3_u32 v32, v32, v26, v27
    v_max_u32 v32, v32, v33
    v_cmp_eq_u32 vcc, -1, v32
    s_cbranch_vccz L_agokA_3
    s_cmp_eq_u32 s46, 0
    s_cbranch_scc1 L_agokA_3
    s_sub_u32 s46, s46, 1
    s_branch L_agpoll_3
    buffer_load_dwordx4 v[20:23], v1, s[8:11], s48 offen sc1
    buffer_load_dwordx4 v[24:27], v1, s[8:11], s49 offen sc1
    s_nop 2
    v_mov_b32 v139, v139
    s_nop 2
    v_mov_b32 v139, v139
    s_nop 2
    v_mov_b32 v139, v139
    s_nop 2
    v_mov_b32 v139, v139
    s_nop 2
    v_mov_b32 v139, v139
    s_nop 2
    v_mov_b32 v139, v139
    buffer_load_dwordx4 v[44:47], v1, s[8:11], s48 offen sc1
    buffer_load_dwordx4 v[60:63], v1, s[8:11], s49 offen sc1
L_agpoll_3x:
    s_nop 2
    v_mov_b32 v139, v139
    s_nop 2
    v_mov_b32 v139, v139
    s_nop 2
    v_mov_b32 v139, v139
    s_nop 2
    v_mov_b32 v139, v139
    s_nop 2
    v_mov_b32 v139, v139
    s_nop 2
    v_mov_b32 v139, v139
    s_nop 2
    v_mov_b32 v139, v139
    s_nop 2
    v_mov_b32 v139, v139
    s_nop 2
    v_mov_b32 v139, v139
    s_waitcnt vmcnt(2)
    v_max3_u32 v32, v20, v21, v22
    v_max3_u32 v33, v23, v24, v25
    v_max3_u32 v32, v32, v26, v27
    v_max_u32 v32, v32, v33
    v_cmp_eq_u32 vcc, -1, v32
    s_cbranch_vccz L_agokA_3
    buffer_load_dwordx4 v[20:23], v1, s[8:11], s48 offen sc1
    buffer_load_dwordx4 v[24:27], v1, s[8:11], s49 offen sc1
    s_nop 2
    v_mov_b32 v139, v139
    s_nop 2
    v_mov_b32 v139, v139
    s_nop 2
    v_mov_b32 v139, v139
    s_nop 2
    v_mov_b32 v139, v139
    s_nop 2
    v_mov_b32 v139, v139
    s_nop 2
    v_mov_b32 v139, v139
    s_nop 2
    v_mov_b32 v139, v139
    s_nop 2
    v_mov_b32 v139, v139
    s_nop 2
    v_mov_b32 v139, v139
    s_waitcnt vmcnt(2)
    v_max3_u32 v32, v44, v45, v46
    v_max3_u32 v33, v47, v60, v61
    v_max3_u32 v32, v32, v62, v63
    v_max_u32 v32, v32, v33
    v_cmp_eq_u32 vcc, -1, v32
    s_cbranch_vccz L_agokB_3
    buffer_load_dwordx4 v[44:47], v1, s[8:11], s48 offen sc1
    buffer_load_dwordx4 v[60:63], v1, s[8:11], s49 offen sc1
    s_cmp_eq_u32 s46, 0
    s_cbranch_scc1 L_agokB_3
    s_sub_u32 s46, s46, 1
    s_branch L_agpoll_3x
L_first_3:
    s_mov_b32 s12, s26
    s_and_b32 s13, s27, 0xffff
    s_mov_b32 s14, 0x2800
    s_mov_b32 s15, 0x20000
    v_bfe_u32 v32, v1, 4, 3
    v_mul_u32_u24 v32, 1280, v32
    v_lshrrev_b32 v33, 7, v1
    v_lshl_add_u32 v32, v33, 4, v32
    buffer_load_dwordx4 v[20:23], v32, s[12:15], 0 offen offset:384
    buffer_load_dwordx4 v[24:27], v32, s[12:15], 0 offen offset:896
    s_waitcnt vmcnt(0)
L_agokA_3:
    v_smfmac_f32_16x16x64_bf16 v[88:91], v[20:23], v[144:151], v5
    v_smfmac_f32_16x16x64_bf16 v[92:95], v[20:23], v[152:159], v5
    v_smfmac_f32_16x16x64_bf16 v[88:91], v[24:27], v[160:167], v5
    v_smfmac_f32_16x16x64_bf16 v[92:95], v[24:27], v[168:175], v5
    ds_write_b128 v1, v[20:23] offset:3072
    v_smfmac_f32_16x16x64_bf16 v[72:75], v[20:23], v[216:223], v5
    ds_write_b128 v1, v[24:27] offset:7168
    v_smfmac_f32_16x16x64_bf16 v[76:79], v[20:23], a[120:127], v5
    v_smfmac_f32_16x16x64_bf16 v[80:83], v[20:23], a[40:47], v5
    v_permlane32_swap_b32 v88, v92
    v_permlane32_swap_b32 v89, v93
    v_smfmac_f32_16x16x64_bf16 v[84:87], v[20:23], a[200:207], v5
    v_permlane32_swap_b32 v90, v94
    v_permlane32_swap_b32 v91, v95
    v_smfmac_f32_16x16x64_bf16 v[72:75], v[24:27], v[248:255], v5
    v_add_f32 v88, v88, v92
    v_add_f32 v89, v89, v93
    v_smfmac_f32_16x16x64_bf16 v[76:79], v[24:27], a[152:159], v5
    v_add_f32 v90, v90, v94
    v_add_f32 v91, v91, v95
    v_smfmac_f32_16x16x64_bf16 v[80:83], v[24:27], a[72:79], v5
    ds_write_b128 v9, v[88:91] offset:24576
    v_smfmac_f32_16x16x64_bf16 v[84:87], v[24:27], a[232:239], v5
    s_add_u32 s65, s59, 16384
    s_add_u32 m0, s74, 36864
    s_nop 0
    buffer_load_dwordx4 v141, s[8:11], s65 offen sc1 lds
    s_add_u32 s65, s59, 16640
    s_add_u32 m0, s74, 37888
    s_nop 0
    buffer_load_dwordx4 v141, s[8:11], s65 offen sc1 lds
    s_add_u32 s65, s59, 18432
    s_add_u32 m0, s74, 38912
    s_nop 0
    buffer_load_dwordx4 v141, s[8:11], s65 offen sc1 lds
    s_add_u32 s65, s59, 18688
    s_add_u32 m0, s74, 39936
    s_nop 0
    buffer_load_dwordx4 v141, s[8:11], s65 offen sc1 lds
    s_waitcnt vmcnt(4) lgkmcnt(0)
    s_barrier
    ds_read_b128 v[32:35], v1 offset:0
    ds_read_b128 v[36:39], v1 offset:1024
    ds_read_b128 v[40:43], v1 offset:2048
    ds_read_b128 v[48:51], v1 offset:4096
    ds_read_b128 v[52:55], v1 offset:5120
    ds_read_b128 v[56:59], v1 offset:6144
    ds_read_b128 v[64:67], v1 offset:8192
    ds_read_b128 v[68:71], v1 offset:9216
    s_branch L_join_3
L_agokB_3:
    v_smfmac_f32_16x16x64_bf16 v[88:91], v[44:47], v[144:151], v5
    v_smfmac_f32_16x16x64_bf16 v[92:95], v[44:47], v[152:159], v5
    v_smfmac_f32_16x16x64_bf16 v[88:91], v[60:63], v[160:167], v5
    v_smfmac_f32_16x16x64_bf16 v[92:95], v[60:63], v[168:175], v5
    ds_write_b128 v1, v[44:47] offset:3072
    v_smfmac_f32_16x16x64_bf16 v[72:75], v[44:47], v[216:223], v5
    ds_write_b128 v1, v[60:63] offset:7168
    v_smfmac_f32_16x16x64_bf16 v[76:79], v[44:47], a[120:127], v5
    v_smfmac_f32_16x16x64_bf16 v[80:83], v[44:47], a[40:47], v5
    v_permlane32_swap_b32 v88, v92
    v_permlane32_swap_b32 v89, v93
    v_smfmac_f32_16x16x64_bf16 v[84:87], v[44:47], a[200:207], v5
    v_permlane32_swap_b32 v90, v94
    v_permlane32_swap_b32 v91, v95
    v_smfmac_f32_16x16x64_bf16 v[72:75], v[60:63], v[248:255], v5
    v_add_f32 v88, v88, v92
    v_add_f32 v89, v89, v93
    v_smfmac_f32_16x16x64_bf16 v[76:79], v[60:63], a[152:159], v5
    v_add_f32 v90, v90, v94
    v_add_f32 v91, v91, v95
    v_smfmac_f32_16x16x64_bf16 v[80:83], v[60:63], a[72:79], v5
    ds_write_b128 v9, v[88:91] offset:24576
    v_smfmac_f32_16x16x64_bf16 v[84:87], v[60:63], a[232:239], v5
    s_add_u32 s65, s59, 16384
    s_add_u32 m0, s74, 36864
    s_nop 0
    buffer_load_dwordx4 v141, s[8:11], s65 offen sc1 lds
    s_add_u32 s65, s59, 16640
    s_add_u32 m0, s74, 37888
    s_nop 0
    buffer_load_dwordx4 v141, s[8:11], s65 offen sc1 lds
    s_add_u32 s65, s59, 18432
    s_add_u32 m0, s74, 38912
    s_nop 0
    buffer_load_dwordx4 v141, s[8:11], s65 offen sc1 lds
    s_add_u32 s65, s59, 18688
    s_add_u32 m0, s74, 39936
    s_nop 0
    buffer_load_dwordx4 v141, s[8:11], s65 offen sc1 lds
    s_waitcnt vmcnt(4) lgkmcnt(0)
    s_barrier
    ds_read_b128 v[32:35], v1 offset:0
    ds_read_b128 v[36:39], v1 offset:1024
    ds_read_b128 v[40:43], v1 offset:2048
    ds_read_b128 v[48:51], v1 offset:4096
    ds_read_b128 v[52:55], v1 offset:5120
    ds_read_b128 v[56:59], v1 offset:6144
    ds_read_b128 v[64:67], v1 offset:8192
    ds_read_b128 v[68:71], v1 offset:9216
L_join_3:
    s_add_u32 s65, s59, 20480
    s_add_u32 m0, s74, 40960
    s_nop 0
    buffer_load_dwordx4 v141, s[8:11], s65 offen sc1 lds
    s_add_u32 s65, s59, 20736
    s_add_u32 m0, s74, 41984
    s_nop 0
    buffer_load_dwordx4 v141, s[8:11], s65 offen sc1 lds
    s_add_u32 s65, s59, 22528
    s_add_u32 m0, s74, 43008
    s_nop 0
    buffer_load_dwordx4 v141, s[8:11], s65 offen sc1 lds
    s_add_u32 s65, s59, 22784
    s_add_u32 m0, s74, 44032
    s_nop 0
    buffer_load_dwordx4 v141, s[8:11], s65 offen sc1 lds
    s_waitcnt lgkmcnt(7)
    v_smfmac_f32_16x16x64_bf16 v[72:75], v[32:35], v[192:199], v5
    v_smfmac_f32_16x16x64_bf16 v[76:79], v[32:35], a[96:103], v5
    s_waitcnt lgkmcnt(6)
    v_smfmac_f32_16x16x64_bf16 v[72:75], v[36:39], v[200:207], v5
    v_smfmac_f32_16x16x64_bf16 v[76:79], v[36:39], a[104:111], v5
    s_waitcnt lgkmcnt(5)
    v_smfmac_f32_16x16x64_bf16 v[72:75], v[40:43], v[208:215], v5
    v_smfmac_f32_16x16x64_bf16 v[76:79], v[40:43], a[112:119], v5
    s_waitcnt lgkmcnt(4)
    v_smfmac_f32_16x16x64_bf16 v[72:75], v[48:51], v[224:231], v5
    v_smfmac_f32_16x16x64_bf16 v[76:79], v[48:51], a[128:135], v5
    s_waitcnt lgkmcnt(3)
    v_smfmac_f32_16x16x64_bf16 v[72:75], v[52:55], v[232:239], v5
    v_smfmac_f32_16x16x64_bf16 v[76:79], v[52:55], a[136:143], v5
    s_waitcnt lgkmcnt(2)
    v_smfmac_f32_16x16x64_bf16 v[72:75], v[56:59], v[240:247], v5
    v_smfmac_f32_16x16x64_bf16 v[76:79], v[56:59], a[144:151], v5
    s_waitcnt lgkmcnt(1)
    v_smfmac_f32_16x16x64_bf16 v[72:75], v[64:67], a[0:7], v5
    v_smfmac_f32_16x16x64_bf16 v[76:79], v[64:67], a[160:167], v5
    s_waitcnt lgkmcnt(0)
    v_smfmac_f32_16x16x64_bf16 v[72:75], v[68:71], a[8:15], v5
    v_smfmac_f32_16x16x64_bf16 v[76:79], v[68:71], a[168:175], v5
    v_smfmac_f32_16x16x64_bf16 v[80:83], v[32:35], a[16:23], v5
    v_smfmac_f32_16x16x64_bf16 v[84:87], v[32:35], a[176:183], v5
    s_nop 0
    v_permlane32_swap_b32 v72, v76
    v_smfmac_f32_16x16x64_bf16 v[80:83], v[36:39], a[24:31], v5
    v_permlane32_swap_b32 v73, v77
    v_smfmac_f32_16x16x64_bf16 v[84:87], v[36:39], a[184:191], v5
    v_permlane32_swap_b32 v74, v78
    v_smfmac_f32_16x16x64_bf16 v[80:83], v[40:43], a[32:39], v5
    v_permlane32_swap_b32 v75, v79
    v_smfmac_f32_16x16x64_bf16 v[84:87], v[40:43], a[192:199], v5
    v_add_f32 v72, v72, v76
    v_smfmac_f32_16x16x64_bf16 v[80:83], v[48:51], a[48:55], v5
    v_add_f32 v73, v73, v77
    v_smfmac_f32_16x16x64_bf16 v[84:87], v[48:51], a[208:215], v5
    v_add_f32 v74, v74, v78
    v_smfmac_f32_16x16x64_bf16 v[80:83], v[52:55], a[56:63], v5
    v_add_f32 v75, v75, v79
    v_smfmac_f32_16x16x64_bf16 v[84:87], v[52:55], a[216:223], v5
    v_cvt_pk_bf16_f32 v76, v72, v73
    v_smfmac_f32_16x16x64_bf16 v[80:83], v[56:59], a[64:71], v5
    v_cvt_pk_bf16_f32 v77, v74, v75
    v_smfmac_f32_16x16x64_bf16 v[84:87], v[56:59], a[224:231], v5
    ds_write_b32 v3, v76 offset:0
    v_smfmac_f32_16x16x64_bf16 v[80:83], v[64:67], a[80:87], v5
    ds_write_b32 v143, v77 offset:0
    v_smfmac_f32_16x16x64_bf16 v[84:87], v[64:67], a[240:247], v5
    v_smfmac_f32_16x16x64_bf16 v[80:83], v[68:71], a[88:95], v5
    v_smfmac_f32_16x16x64_bf16 v[84:87], v[68:71], a[248:255], v5
    s_nop 7
    v_permlane32_swap_b32 v80, v84
    v_permlane32_swap_b32 v81, v85
    v_permlane32_swap_b32 v82, v86
    v_permlane32_swap_b32 v83, v87
    v_add_f32 v80, v80, v84
    v_add_f32 v81, v81, v85
    v_add_f32 v82, v82, v86
    v_add_f32 v83, v83, v87
    v_cvt_pk_bf16_f32 v84, v80, v81
    v_cvt_pk_bf16_f32 v85, v82, v83
    ds_write_b32 v3, v84 offset:512
    ds_write_b32 v143, v85 offset:512
    v_mov_b32 v136, -1
    v_mov_b32 v138, -1
    buffer_load_dword v136, v8, s[8:11], s53 offen sc1
    buffer_load_dword v138, v8, s[8:11], s53 offen offset:256 sc1
    s_waitcnt lgkmcnt(0)
    s_barrier
    ds_read_b64_tr_b16 v[32:33], v2 offset:0
    ds_read_b64_tr_b16 v[34:35], v2 offset:256
    ds_read_b64_tr_b16 v[48:49], v2 offset:4096
    ds_read_b64_tr_b16 v[50:51], v2 offset:4352
    ds_read_b64_tr_b16 v[36:37], v2 offset:1024
    ds_read_b64_tr_b16 v[38:39], v2 offset:1280
    ds_read_b64_tr_b16 v[52:53], v2 offset:5120
    ds_read_b64_tr_b16 v[54:55], v2 offset:5376
    ds_read_b64_tr_b16 v[40:41], v2 offset:2048
    ds_read_b64_tr_b16 v[42:43], v2 offset:2304
    ds_read_b64_tr_b16 v[56:57], v2 offset:6144
    ds_read_b64_tr_b16 v[58:59], v2 offset:6400
    ds_read_b64_tr_b16 v[44:45], v2 offset:3072
    ds_read_b64_tr_b16 v[46:47], v2 offset:3328
    ds_read_b64_tr_b16 v[60:61], v2 offset:7168
    ds_read_b64_tr_b16 v[62:63], v2 offset:7424
    s_waitcnt lgkmcnt(12)
    v_mfma_f32_16x16x32_bf16 v[68:71], v[96:99], v[32:35], 0
    ds_read_b128 v[20:23], v9 offset:20480
    v_mfma_f32_16x16x32_bf16 v[72:75], v[112:115], v[32:35], 0
    v_mfma_f32_16x16x32_bf16 v[64:67], v[48:51], v[32:35], 0
    s_waitcnt lgkmcnt(9)
    v_mfma_f32_16x16x32_bf16 v[68:71], v[100:103], v[36:39], v[68:71]
    v_mfma_f32_16x16x32_bf16 v[72:75], v[116:119], v[36:39], v[72:75]
    v_mfma_f32_16x16x32_bf16 v[64:67], v[52:55], v[36:39], v[64:67]
    s_waitcnt lgkmcnt(5)
    v_mfma_f32_16x16x32_bf16 v[68:71], v[104:107], v[40:43], v[68:71]
    v_mfma_f32_16x16x32_bf16 v[72:75], v[120:123], v[40:43], v[72:75]
    v_mfma_f32_16x16x32_bf16 v[64:67], v[56:59], v[40:43], v[64:67]
    s_waitcnt lgkmcnt(1)
    v_mfma_f32_16x16x32_bf16 v[68:71], v[108:111], v[44:47], v[68:71]
    v_mfma_f32_16x16x32_bf16 v[72:75], v[124:127], v[44:47], v[72:75]
    v_mfma_f32_16x16x32_bf16 v[64:67], v[60:63], v[44:47], v[64:67]
    s_waitcnt lgkmcnt(0)
    buffer_store_dwordx4 v[20:23], v7, s[8:11], s99 offen sc1
    s_nop 0
    v_pk_fma_f32 v[68:69], v[68:69], s[70:71], v[10:11]
    s_nop 0
    v_pk_fma_f32 v[70:71], v[70:71], s[70:71], v[12:13]
    s_nop 0
    v_pk_fma_f32 v[72:73], v[72:73], s[70:71], v[14:15]
    v_pk_fma_f32 v[74:75], v[74:75], s[70:71], v[16:17]
    v_pk_mul_f32 v[64:65], v[64:65], s[70:71]
    v_max3_f32 v76, v68, v69, v70
    v_max3_f32 v77, v71, v72, v73
    v_max3_f32 v76, v76, v74, v75
    v_max3_f32 v77, v77, v64, v65
    v_max_f32 v76, v76, v77
    v_mov_b32 v77, v76
    ds_read_b128 v[96:99], v4 offset:0
    ds_read_b128 v[100:103], v4 offset:1024
    v_permlane32_swap_b32 v76, v77
    v_max_f32 v76, v76, v77
    v_mov_b32 v77, v76
    ds_read_b128 v[104:107], v4 offset:2048
    ds_read_b128 v[108:111], v4 offset:3072
    v_permlane16_swap_b32 v76, v77
    v_max_f32 v76, v76, v77
    v_pk_add_f32 v[68:69], v[68:69], v[76:77] op_sel_hi:[1,0] neg_lo:[0,1] neg_hi:[0,1]
    v_pk_add_f32 v[70:71], v[70:71], v[76:77] op_sel_hi:[1,0] neg_lo:[0,1] neg_hi:[0,1]
    v_pk_add_f32 v[72:73], v[72:73], v[76:77] op_sel_hi:[1,0] neg_lo:[0,1] neg_hi:[0,1]
    v_pk_add_f32 v[74:75], v[74:75], v[76:77] op_sel_hi:[1,0] neg_lo:[0,1] neg_hi:[0,1]
    v_pk_add_f32 v[64:65], v[64:65], v[76:77] op_sel_hi:[1,0] neg_lo:[0,1] neg_hi:[0,1]
    v_exp_f32 v68, v68
    ds_read_b128 v[112:115], v4 offset:4096
    v_exp_f32 v69, v69
    ds_read_b128 v[116:119], v4 offset:5120
    v_exp_f32 v70, v70
    ds_read_b128 v[120:123], v4 offset:6144
    v_exp_f32 v71, v71
    ds_read_b128 v[124:127], v4 offset:7168
    v_exp_f32 v72, v72
    v_exp_f32 v73, v73
    v_exp_f32 v74, v74
    v_exp_f32 v75, v75
    v_cvt_pk_bf16_f32 v88, v68, v69
    v_cvt_pk_bf16_f32 v89, v70, v71
    v_exp_f32 v64, v64
    v_cvt_pk_bf16_f32 v90, v72, v73
    v_exp_f32 v65, v65
    v_cvt_pk_bf16_f32 v91, v74, v75
    v_mov_b32 v93, 0
    v_cvt_pk_bf16_f32 v92, v64, v65
    v_mfma_f32_16x16x32_bf16 v[76:79], v[128:131], v[88:91], 0
    v_mfma_f32_16x16x32_bf16 v[80:83], v[132:135], v[88:91], 0
    s_waitcnt vmcnt(1)
L_vmchk_3:
    v_max_u32 v94, v136, v138
    v_cmp_eq_u32 vcc, -1, v94
    s_cbranch_vccnz L_vmretry_3
L_vmok_3:
    v_mfma_f32_16x16x16_bf16 v[76:79], v[136:137], v[92:93], v[76:79]
    v_mfma_f32_16x16x16_bf16 v[80:83], v[138:139], v[92:93], v[80:83]
    v_add_f32 v68, v68, v69
    v_add_f32 v70, v70, v71
    v_add_f32 v72, v72, v73
    v_add_f32 v74, v74, v75
    v_add_f32 v64, v64, v65
    v_add_f32 v68, v68, v70
    v_add_f32 v72, v72, v74
    v_add_f32 v68, v68, v64
    v_add_f32 v68, v68, v72
    v_mov_b32 v69, v68
    s_nop 1
    v_permlane32_swap_b32 v68, v69
    v_add_f32 v68, v68, v69
    v_mov_b32 v69, v68
    s_nop 1
    v_permlane16_swap_b32 v68, v69
    v_add_f32 v68, v68, v69
    v_rcp_f32 v68, v68
    s_nop 0
    v_pk_mul_f32 v[76:77], v[76:77], v[68:69] op_sel_hi:[1,0]
    v_pk_mul_f32 v[78:79], v[78:79], v[68:69] op_sel_hi:[1,0]
    v_pk_mul_f32 v[80:81], v[80:81], v[68:69] op_sel_hi:[1,0]
    v_pk_mul_f32 v[82:83], v[82:83], v[68:69] op_sel_hi:[1,0]
    v_cvt_pk_bf16_f32 v84, v76, v77
    v_cvt_pk_bf16_f32 v85, v78, v79
    v_cvt_pk_bf16_f32 v86, v80, v81
    v_cvt_pk_bf16_f32 v87, v82, v83
    s_cmp_eq_u32 s7, 63
    s_cbranch_scc1 L_last_3
    ds_write_b128 v9, v[84:87] offset:20480
    s_waitcnt lgkmcnt(0)
    s_barrier
    ds_read_b128 v[32:35], v1 offset:20480
    ds_read_b128 v[36:39], v1 offset:21504
    ds_read_b128 v[40:43], v1 offset:22528
    ds_read_b128 v[44:47], v1 offset:23552
    s_waitcnt lgkmcnt(3)
    v_mfma_f32_16x16x32_bf16 v[64:67], v[96:99], v[32:35], 0
    v_mfma_f32_16x16x32_bf16 v[68:71], v[112:115], v[32:35], 0
    s_waitcnt lgkmcnt(2)
    v_mfma_f32_16x16x32_bf16 v[64:67], v[100:103], v[36:39], v[64:67]
    v_mfma_f32_16x16x32_bf16 v[68:71], v[116:119], v[36:39], v[68:71]
    s_waitcnt lgkmcnt(1)
    v_mfma_f32_16x16x32_bf16 v[64:67], v[104:107], v[40:43], v[64:67]
    v_mfma_f32_16x16x32_bf16 v[68:71], v[120:123], v[40:43], v[68:71]
    s_waitcnt lgkmcnt(0)
    v_mfma_f32_16x16x32_bf16 v[64:67], v[108:111], v[44:47], v[64:67]
    v_mfma_f32_16x16x32_bf16 v[68:71], v[124:127], v[44:47], v[68:71]
    s_nop 6
    v_bfi_b32 v64, 3, s61, v64
    buffer_store_dwordx4 v[64:67], v6, s[8:11], s55 offen
    v_bfi_b32 v68, 3, s61, v68
    buffer_store_dwordx4 v[68:71], v6, s[8:11], s56 offen
    s_mov_b32 s76, s51
    s_mov_b32 s77, s62
L_next_3:
    s_add_u32 s99, s60, 6144
    v_xor_b32 v0, 0x10000, v0
    v_xor_b32 v2, 0x10000, v2
    v_xor_b32 v3, 0x10000, v3
    v_xor_b32 v143, 0x10000, v143
    s_add_u32 s7, s7, 1
    s_branch L_step_3
L_vmretry_3:
    s_cmp_eq_u32 s46, 0
    s_cbranch_scc1 L_vmok_3
    s_sub_u32 s46, s46, 1
    buffer_load_dword v136, v8, s[8:11], s53 offen sc1
    buffer_load_dword v138, v8, s[8:11], s53 offen offset:256 sc1
    s_waitcnt vmcnt(0)
    s_branch L_vmchk_3
L_last_3:
    s_add_u32 s65, s60, 6144
    buffer_store_dwordx4 v[84:87], v7, s[8:11], s65 offen sc1
    s_waitcnt vmcnt(0)
    s_barrier
    s_branch L_chain_end
L_chain_end:
    s_branch L_end
L_gemm:
    s_sub_u32 s5, s5, 4
    s_lshl_b32 s5, s5, 5
    s_add_u32 s5, s5, s6
    v_lshlrev_b32 v1, 4, v0
    s_cmp_lg_u32 s4, 0
    s_cbranch_scc1 L_ga_done
    s_cmp_ge_u32 s5, 96
    s_cbranch_scc1 L_ga_cnt
    s_lshr_b32 s65, s5, 5
    s_and_b32 s66, s5, 31
    s_lshl_b32 s66, s66, 9
    s_lshl_b32 s65, s65, 7
    s_add_u32 s65, s65, s66
    s_add_u32 s55, s65, 72220672
    v_mov_b32 v144, 0
    v_mov_b32 v145, 0
    v_mov_b32 v146, 0
    v_mov_b32 v147, 0
    s_mov_b64 exec, 0xff
    buffer_store_dwordx4 v[144:147], v1, s[8:11], s55 offen sc1
    s_mov_b64 exec, -1
    s_branch L_ga_arr
L_ga_cnt:
    s_cmp_lg_u32 s5, 96
    s_cbranch_scc1 L_ga_arr
    v_mov_b32 v132, 0
    v_mov_b32 v133, 0
    v_mov_b32 v134, 0
    v_mov_b32 v135, 0
    v_and_b32 v128, 63, v0
    v_lshlrev_b32 v128, 4, v128
    s_mov_b32 s65, 72286208
    buffer_store_dwordx4 v[132:135], v128, s[8:11], s65 offen sc1
    s_add_u32 s65, s65, 1024
    buffer_store_dwordx4 v[132:135], v128, s[8:11], s65 offen sc1
    s_add_u32 s65, s65, 1024
    buffer_store_dwordx4 v[132:135], v128, s[8:11], s65 offen sc1
    s_add_u32 s65, s65, 1024
    buffer_store_dwordx4 v[132:135], v128, s[8:11], s65 offen sc1
    s_add_u32 s65, s65, 1024
    buffer_store_dwordx4 v[132:135], v128, s[8:11], s65 offen sc1
    s_add_u32 s65, s65, 1024
    buffer_store_dwordx4 v[132:135], v128, s[8:11], s65 offen sc1
    s_add_u32 s65, s65, 1024
    buffer_store_dwordx4 v[132:135], v128, s[8:11], s65 offen sc1
    s_add_u32 s65, s65, 1024
    buffer_store_dwordx4 v[132:135], v128, s[8:11], s65 offen sc1
    s_add_u32 s65, s65, 1024
    buffer_store_dwordx4 v[132:135], v128, s[8:11], s65 offen sc1
    s_add_u32 s65, s65, 1024
    buffer_store_dwordx4 v[132:135], v128, s[8:11], s65 offen sc1
    s_add_u32 s65, s65, 1024
    buffer_store_dwordx4 v[132:135], v128, s[8:11], s65 offen sc1
    s_add_u32 s65, s65, 1024
    buffer_store_dwordx4 v[132:135], v128, s[8:11], s65 offen sc1
    s_add_u32 s65, s65, 1024
    buffer_store_dwordx4 v[132:135], v128, s[8:11], s65 offen sc1
    s_add_u32 s65, s65, 1024
    buffer_store_dwordx4 v[132:135], v128, s[8:11], s65 offen sc1
    s_add_u32 s65, s65, 1024
    buffer_store_dwordx4 v[132:135], v128, s[8:11], s65 offen sc1
    s_add_u32 s65, s65, 1024
    buffer_store_dwordx4 v[132:135], v128, s[8:11], s65 offen sc1
    s_add_u32 s65, s65, 1024
    buffer_store_dwordx4 v[132:135], v128, s[8:11], s65 offen sc1
    s_add_u32 s65, s65, 1024
    buffer_store_dwordx4 v[132:135], v128, s[8:11], s65 offen sc1
    s_add_u32 s65, s65, 1024
    buffer_store_dwordx4 v[132:135], v128, s[8:11], s65 offen sc1
    s_add_u32 s65, s65, 1024
    buffer_store_dwordx4 v[132:135], v128, s[8:11], s65 offen sc1
    s_add_u32 s65, s65, 1024
    buffer_store_dwordx4 v[132:135], v128, s[8:11], s65 offen sc1
    s_add_u32 s65, s65, 1024
    buffer_store_dwordx4 v[132:135], v128, s[8:11], s65 offen sc1
    s_add_u32 s65, s65, 1024
    buffer_store_dwordx4 v[132:135], v128, s[8:11], s65 offen sc1
    s_add_u32 s65, s65, 1024
    buffer_store_dwordx4 v[132:135], v128, s[8:11], s65 offen sc1
    s_add_u32 s65, s65, 1024
    buffer_store_dwordx4 v[132:135], v128, s[8:11], s65 offen sc1
    s_add_u32 s65, s65, 1024
    buffer_store_dwordx4 v[132:135], v128, s[8:11], s65 offen sc1
    s_add_u32 s65, s65, 1024
    buffer_store_dwordx4 v[132:135], v128, s[8:11], s65 offen sc1
    s_add_u32 s65, s65, 1024
    buffer_store_dwordx4 v[132:135], v128, s[8:11], s65 offen sc1
    s_add_u32 s65, s65, 1024
    buffer_store_dwordx4 v[132:135], v128, s[8:11], s65 offen sc1
    s_add_u32 s65, s65, 1024
    buffer_store_dwordx4 v[132:135], v128, s[8:11], s65 offen sc1
    s_add_u32 s65, s65, 1024
    buffer_store_dwordx4 v[132:135], v128, s[8:11], s65 offen sc1
    s_add_u32 s65, s65, 1024
    buffer_store_dwordx4 v[132:135], v128, s[8:11], s65 offen sc1
    s_add_u32 s65, s65, 1024
    buffer_store_dwordx4 v[132:135], v128, s[8:11], s65 offen sc1
    s_add_u32 s65, s65, 1024
    buffer_store_dwordx4 v[132:135], v128, s[8:11], s65 offen sc1
    s_add_u32 s65, s65, 1024
    buffer_store_dwordx4 v[132:135], v128, s[8:11], s65 offen sc1
    s_add_u32 s65, s65, 1024
    buffer_store_dwordx4 v[132:135], v128, s[8:11], s65 offen sc1
    s_add_u32 s65, s65, 1024
    buffer_store_dwordx4 v[132:135], v128, s[8:11], s65 offen sc1
    s_add_u32 s65, s65, 1024
    buffer_store_dwordx4 v[132:135], v128, s[8:11], s65 offen sc1
    s_add_u32 s65, s65, 1024
    buffer_store_dwordx4 v[132:135], v128, s[8:11], s65 offen sc1
    s_add_u32 s65, s65, 1024
    buffer_store_dwordx4 v[132:135], v128, s[8:11], s65 offen sc1
    s_add_u32 s65, s65, 1024
    buffer_store_dwordx4 v[132:135], v128, s[8:11], s65 offen sc1
    s_add_u32 s65, s65, 1024
    buffer_store_dwordx4 v[132:135], v128, s[8:11], s65 offen sc1
    s_add_u32 s65, s65, 1024
    buffer_store_dwordx4 v[132:135], v128, s[8:11], s65 offen sc1
    s_add_u32 s65, s65, 1024
L_ga_arr:
    s_waitcnt vmcnt(0)
    v_mov_b32 v128, 96
    v_mov_b32 v129, 1
    s_mov_b64 exec, 1
    global_atomic_add v128, v129, s[42:43] sc1
    s_mov_b64 exec, -1
L_ga_done:
    s_mov_b32 s100, s5
    s_cmp_ge_u32 s5, 96
    s_cbranch_scc1 L_abranch
    s_lshr_b32 s6, s5, 5
    s_and_b32 s7, s5, 31
    s_lshl_b32 s55, s7, 9
    s_lshl_b32 s65, s6, 7
    s_add_u32 s55, s55, s65
    s_add_u32 s55, s55, 72220672
    s_cmp_eq_u32 s6, 0
    s_cselect_b32 s12, s28, s30
    s_cselect_b32 s13, s29, s31
    s_cmp_eq_u32 s6, 2
    s_cselect_b32 s12, s32, s12
    s_cselect_b32 s13, s33, s13
    s_and_b32 s13, s13, 0xffff
    s_mov_b32 s14, 0x500000
    s_mov_b32 s15, 0x20000
    s_lshl_b32 s78, s7, 8
    s_mov_b32 s48, s16
    s_and_b32 s49, s17, 0xffff
    s_mov_b32 s50, 0x280000
    s_mov_b32 s51, 0x20000
    s_mul_i32 s53, s4, 20480
    s_mul_i32 s54, s7, 1572864
    s_lshl_b32 s65, s6, 13
    s_add_u32 s54, s54, s65
    s_and_b32 s65, s4, 1
    s_lshl_b32 s65, s65, 12
    s_add_u32 s54, s54, s65
    s_lshr_b32 s65, s4, 1
    s_mul_i32 s65, s65, 24576
    s_add_u32 s54, s54, s65
    s_add_u32 s54, s54, 0
    s_cmp_eq_u32 s6, 1
    s_cbranch_scc1 L_g1role_k
    v_lshrrev_b32 v128, 4, v0
    v_mul_u32_u24 v128, 8192, v128
    v_and_b32 v129, 15, v0
    v_lshl_add_u32 v128, v129, 4, v128
    v_add_u32 v131, s78, v128
    s_mul_i32 s76, s4, 131072
    s_lshl_b32 s77, s4, 12
    s_add_u32 s65, s76, 0
    s_add_u32 s66, s77, 0
    s_mov_b32 m0, s66
    s_nop 0
    buffer_load_dwordx4 v131, s[12:15], s65 offen lds
    s_add_u32 s65, s76, 32768
    s_add_u32 s66, s77, 1024
    s_mov_b32 m0, s66
    s_nop 0
    buffer_load_dwordx4 v131, s[12:15], s65 offen lds
    s_add_u32 s65, s76, 65536
    s_add_u32 s66, s77, 2048
    s_mov_b32 m0, s66
    s_nop 0
    buffer_load_dwordx4 v131, s[12:15], s65 offen lds
    s_add_u32 s65, s76, 98304
    s_add_u32 s66, s77, 3072
    s_mov_b32 m0, s66
    s_nop 0
    buffer_load_dwordx4 v131, s[12:15], s65 offen lds
    s_add_u32 s65, s76, 524288
    s_add_u32 s66, s77, 16384
    s_mov_b32 m0, s66
    s_nop 0
    buffer_load_dwordx4 v131, s[12:15], s65 offen lds
    s_add_u32 s65, s76, 557056
    s_add_u32 s66, s77, 17408
    s_mov_b32 m0, s66
    s_nop 0
    buffer_load_dwordx4 v131, s[12:15], s65 offen lds
    s_add_u32 s65, s76, 589824
    s_add_u32 s66, s77, 18432
    s_mov_b32 m0, s66
    s_nop 0
    buffer_load_dwordx4 v131, s[12:15], s65 offen lds
    s_add_u32 s65, s76, 622592
    s_add_u32 s66, s77, 19456
    s_mov_b32 m0, s66
    s_nop 0
    buffer_load_dwordx4 v131, s[12:15], s65 offen lds
    s_add_u32 s65, s76, 1048576
    s_add_u32 s66, s77, 32768
    s_mov_b32 m0, s66
    s_nop 0
    buffer_load_dwordx4 v131, s[12:15], s65 offen lds
    s_add_u32 s65, s76, 1081344
    s_add_u32 s66, s77, 33792
    s_mov_b32 m0, s66
    s_nop 0
    buffer_load_dwordx4 v131, s[12:15], s65 offen lds
    s_add_u32 s65, s76, 1114112
    s_add_u32 s66, s77, 34816
    s_mov_b32 m0, s66
    s_nop 0
    buffer_load_dwordx4 v131, s[12:15], s65 offen lds
    s_add_u32 s65, s76, 1146880
    s_add_u32 s66, s77, 35840
    s_mov_b32 m0, s66
    s_nop 0
    buffer_load_dwordx4 v131, s[12:15], s65 offen lds
    s_add_u32 s65, s76, 1572864
    s_add_u32 s66, s77, 49152
    s_mov_b32 m0, s66
    s_nop 0
    buffer_load_dwordx4 v131, s[12:15], s65 offen lds
    s_add_u32 s65, s76, 1605632
    s_add_u32 s66, s77, 50176
    s_mov_b32 m0, s66
    s_nop 0
    buffer_load_dwordx4 v131, s[12:15], s65 offen lds
    s_add_u32 s65, s76, 1638400
    s_add_u32 s66, s77, 51200
    s_mov_b32 m0, s66
    s_nop 0
    buffer_load_dwordx4 v131, s[12:15], s65 offen lds
    s_add_u32 s65, s76, 1671168
    s_add_u32 s66, s77, 52224
    s_mov_b32 m0, s66
    s_nop 0
    buffer_load_dwordx4 v131, s[12:15], s65 offen lds
    s_add_u32 s65, s76, 2097152
    s_add_u32 s66, s77, 65536
    s_mov_b32 m0, s66
    s_nop 0
    buffer_load_dwordx4 v131, s[12:15], s65 offen lds
    s_add_u32 s65, s76, 2129920
    s_add_u32 s66, s77, 66560
    s_mov_b32 m0, s66
    s_nop 0
    buffer_load_dwordx4 v131, s[12:15], s65 offen lds
    s_add_u32 s65, s76, 2162688
    s_add_u32 s66, s77, 67584
    s_mov_b32 m0, s66
    s_nop 0
    buffer_load_dwordx4 v131, s[12:15], s65 offen lds
    s_add_u32 s65, s76, 2195456
    s_add_u32 s66, s77, 68608
    s_mov_b32 m0, s66
    s_nop 0
    buffer_load_dwordx4 v131, s[12:15], s65 offen lds
    s_add_u32 s65, s76, 2621440
    s_add_u32 s66, s77, 81920
    s_mov_b32 m0, s66
    s_nop 0
    buffer_load_dwordx4 v131, s[12:15], s65 offen lds
    s_add_u32 s65, s76, 2654208
    s_add_u32 s66, s77, 82944
    s_mov_b32 m0, s66
    s_nop 0
    buffer_load_dwordx4 v131, s[12:15], s65 offen lds
    s_add_u32 s65, s76, 2686976
    s_add_u32 s66, s77, 83968
    s_mov_b32 m0, s66
    s_nop 0
    buffer_load_dwordx4 v131, s[12:15], s65 offen lds
    s_add_u32 s65, s76, 2719744
    s_add_u32 s66, s77, 84992
    s_mov_b32 m0, s66
    s_nop 0
    buffer_load_dwordx4 v131, s[12:15], s65 offen lds
    s_add_u32 s65, s76, 3145728
    s_add_u32 s66, s77, 98304
    s_mov_b32 m0, s66
    s_nop 0
    buffer_load_dwordx4 v131, s[12:15], s65 offen lds
    s_add_u32 s65, s76, 3178496
    s_add_u32 s66, s77, 99328
    s_mov_b32 m0, s66
    s_nop 0
    buffer_load_dwordx4 v131, s[12:15], s65 offen lds
    s_add_u32 s65, s76, 3211264
    s_add_u32 s66, s77, 100352
    s_mov_b32 m0, s66
    s_nop 0
    buffer_load_dwordx4 v131, s[12:15], s65 offen lds
    s_add_u32 s65, s76, 3244032
    s_add_u32 s66, s77, 101376
    s_mov_b32 m0, s66
    s_nop 0
    buffer_load_dwordx4 v131, s[12:15], s65 offen lds
    s_add_u32 s65, s76, 3670016
    s_add_u32 s66, s77, 114688
    s_mov_b32 m0, s66
    s_nop 0
    buffer_load_dwordx4 v131, s[12:15], s65 offen lds
    s_add_u32 s65, s76, 3702784
    s_add_u32 s66, s77, 115712
    s_mov_b32 m0, s66
    s_nop 0
    buffer_load_dwordx4 v131, s[12:15], s65 offen lds
    s_add_u32 s65, s76, 3735552
    s_add_u32 s66, s77, 116736
    s_mov_b32 m0, s66
    s_nop 0
    buffer_load_dwordx4 v131, s[12:15], s65 offen lds
    s_add_u32 s65, s76, 3768320
    s_add_u32 s66, s77, 117760
    s_mov_b32 m0, s66
    s_nop 0
    buffer_load_dwordx4 v131, s[12:15], s65 offen lds
    s_add_u32 s65, s76, 4194304
    s_add_u32 s66, s77, 131072
    s_mov_b32 m0, s66
    s_nop 0
    buffer_load_dwordx4 v131, s[12:15], s65 offen lds
    s_add_u32 s65, s76, 4227072
    s_add_u32 s66, s77, 132096
    s_mov_b32 m0, s66
    s_nop 0
    buffer_load_dwordx4 v131, s[12:15], s65 offen lds
    s_add_u32 s65, s76, 4259840
    s_add_u32 s66, s77, 133120
    s_mov_b32 m0, s66
    s_nop 0
    buffer_load_dwordx4 v131, s[12:15], s65 offen lds
    s_add_u32 s65, s76, 4292608
    s_add_u32 s66, s77, 134144
    s_mov_b32 m0, s66
    s_nop 0
    buffer_load_dwordx4 v131, s[12:15], s65 offen lds
    s_add_u32 s65, s76, 4718592
    s_add_u32 s66, s77, 147456
    s_mov_b32 m0, s66
    s_nop 0
    buffer_load_dwordx4 v131, s[12:15], s65 offen lds
    s_add_u32 s65, s76, 4751360
    s_add_u32 s66, s77, 148480
    s_mov_b32 m0, s66
    s_nop 0
    buffer_load_dwordx4 v131, s[12:15], s65 offen lds
    s_add_u32 s65, s76, 4784128
    s_add_u32 s66, s77, 149504
    s_mov_b32 m0, s66
    s_nop 0
    buffer_load_dwordx4 v131, s[12:15], s65 offen lds
    s_add_u32 s65, s76, 4816896
    s_add_u32 s66, s77, 150528
    s_mov_b32 m0, s66
    s_nop 0
    buffer_load_dwordx4 v131, s[12:15], s65 offen lds
    v_lshrrev_b32 v128, 5, v0
    v_lshlrev_b32 v128, 3, v128
    v_bfe_u32 v129, v0, 2, 2
    v_add_u32 v128, v128, v129
    v_lshlrev_b32 v128, 8, v128
    v_bfe_u32 v129, v0, 4, 1
    v_lshl_add_u32 v128, v129, 5, v128
    v_and_b32 v129, 3, v0
    v_lshl_add_u32 v128, v129, 3, v128
    s_and_b32 s65, s4, 1
    s_lshl_b32 s65, s65, 7
    v_add_u32 v132, s65, v128
    v_add_u32 v133, 0x10000, v132
    v_add_u32 v134, 0x20000, v132
    s_waitcnt vmcnt(36)
    s_barrier
    ds_read_b64_tr_b16 v[192:193], v132 offset:0
    ds_read_b64_tr_b16 v[194:195], v132 offset:1024
    ds_read_b64_tr_b16 a[96:97], v132 offset:64
    ds_read_b64_tr_b16 a[98:99], v132 offset:1088
    ds_read_b64_tr_b16 v[196:197], v132 offset:4096
    ds_read_b64_tr_b16 v[198:199], v132 offset:5120
    ds_read_b64_tr_b16 a[100:101], v132 offset:4160
    ds_read_b64_tr_b16 a[102:103], v132 offset:5184
    ds_read_b64_tr_b16 v[200:201], v132 offset:8192
    ds_read_b64_tr_b16 v[202:203], v132 offset:9216
    ds_read_b64_tr_b16 a[104:105], v132 offset:8256
    ds_read_b64_tr_b16 a[106:107], v132 offset:9280
    ds_read_b64_tr_b16 v[204:205], v132 offset:12288
    ds_read_b64_tr_b16 v[206:207], v132 offset:13312
    ds_read_b64_tr_b16 a[108:109], v132 offset:12352
    ds_read_b64_tr_b16 a[110:111], v132 offset:13376
    s_waitcnt vmcnt(32)
    s_barrier
    ds_read_b64_tr_b16 v[208:209], v132 offset:16384
    ds_read_b64_tr_b16 v[210:211], v132 offset:17408
    ds_read_b64_tr_b16 a[112:113], v132 offset:16448
    ds_read_b64_tr_b16 a[114:115], v132 offset:17472
    ds_read_b64_tr_b16 v[212:213], v132 offset:20480
    ds_read_b64_tr_b16 v[214:215], v132 offset:21504
    ds_read_b64_tr_b16 a[116:117], v132 offset:20544
    ds_read_b64_tr_b16 a[118:119], v132 offset:21568
    ds_read_b64_tr_b16 v[216:217], v132 offset:24576
    ds_read_b64_tr_b16 v[218:219], v132 offset:25600
    ds_read_b64_tr_b16 a[120:121], v132 offset:24640
    ds_read_b64_tr_b16 a[122:123], v132 offset:25664
    ds_read_b64_tr_b16 v[220:221], v132 offset:28672
    ds_read_b64_tr_b16 v[222:223], v132 offset:29696
    ds_read_b64_tr_b16 a[124:125], v132 offset:28736
    ds_read_b64_tr_b16 a[126:127], v132 offset:29760
    s_waitcnt lgkmcnt(0)
    s_waitcnt vmcnt(28)
    s_barrier
    ds_read_b64_tr_b16 v[224:225], v132 offset:32768
    ds_read_b64_tr_b16 v[226:227], v132 offset:33792
    ds_read_b64_tr_b16 a[128:129], v132 offset:32832
    ds_read_b64_tr_b16 a[130:131], v132 offset:33856
    ds_read_b64_tr_b16 v[228:229], v132 offset:36864
    ds_read_b64_tr_b16 v[230:231], v132 offset:37888
    ds_read_b64_tr_b16 a[132:133], v132 offset:36928
    ds_read_b64_tr_b16 a[134:135], v132 offset:37952
    ds_read_b64_tr_b16 v[232:233], v132 offset:40960
    ds_read_b64_tr_b16 v[234:235], v132 offset:41984
    ds_read_b64_tr_b16 a[136:137], v132 offset:41024
    ds_read_b64_tr_b16 a[138:139], v132 offset:42048
    ds_read_b64_tr_b16 v[236:237], v132 offset:45056
    ds_read_b64_tr_b16 v[238:239], v132 offset:46080
    ds_read_b64_tr_b16 a[140:141], v132 offset:45120
    ds_read_b64_tr_b16 a[142:143], v132 offset:46144
    s_waitcnt vmcnt(24)
    s_barrier
    ds_read_b64_tr_b16 v[240:241], v132 offset:49152
    ds_read_b64_tr_b16 v[242:243], v132 offset:50176
    ds_read_b64_tr_b16 a[144:145], v132 offset:49216
    ds_read_b64_tr_b16 a[146:147], v132 offset:50240
    ds_read_b64_tr_b16 v[244:245], v132 offset:53248
    ds_read_b64_tr_b16 v[246:247], v132 offset:54272
    ds_read_b64_tr_b16 a[148:149], v132 offset:53312
    ds_read_b64_tr_b16 a[150:151], v132 offset:54336
    ds_read_b64_tr_b16 v[248:249], v132 offset:57344
    ds_read_b64_tr_b16 v[250:251], v132 offset:58368
    ds_read_b64_tr_b16 a[152:153], v132 offset:57408
    ds_read_b64_tr_b16 a[154:155], v132 offset:58432
    ds_read_b64_tr_b16 v[252:253], v132 offset:61440
    ds_read_b64_tr_b16 v[254:255], v132 offset:62464
    ds_read_b64_tr_b16 a[156:157], v132 offset:61504
    ds_read_b64_tr_b16 a[158:159], v132 offset:62528
    s_waitcnt lgkmcnt(0)
    s_waitcnt vmcnt(20)
    s_barrier
    ds_read_b64_tr_b16 a[0:1], v133 offset:0
    ds_read_b64_tr_b16 a[2:3], v133 offset:1024
    ds_read_b64_tr_b16 a[160:161], v133 offset:64
    ds_read_b64_tr_b16 a[162:163], v133 offset:1088
    ds_read_b64_tr_b16 a[4:5], v133 offset:4096
    ds_read_b64_tr_b16 a[6:7], v133 offset:5120
    ds_read_b64_tr_b16 a[164:165], v133 offset:4160
    ds_read_b64_tr_b16 a[166:167], v133 offset:5184
    ds_read_b64_tr_b16 a[8:9], v133 offset:8192
    ds_read_b64_tr_b16 a[10:11], v133 offset:9216
    ds_read_b64_tr_b16 a[168:169], v133 offset:8256
    ds_read_b64_tr_b16 a[170:171], v133 offset:9280
    ds_read_b64_tr_b16 a[12:13], v133 offset:12288
    ds_read_b64_tr_b16 a[14:15], v133 offset:13312
    ds_read_b64_tr_b16 a[172:173], v133 offset:12352
    ds_read_b64_tr_b16 a[174:175], v133 offset:13376
    s_waitcnt vmcnt(16)
    s_barrier
    ds_read_b64_tr_b16 a[16:17], v133 offset:16384
    ds_read_b64_tr_b16 a[18:19], v133 offset:17408
    ds_read_b64_tr_b16 a[176:177], v133 offset:16448
    ds_read_b64_tr_b16 a[178:179], v133 offset:17472
    ds_read_b64_tr_b16 a[20:21], v133 offset:20480
    ds_read_b64_tr_b16 a[22:23], v133 offset:21504
    ds_read_b64_tr_b16 a[180:181], v133 offset:20544
    ds_read_b64_tr_b16 a[182:183], v133 offset:21568
    ds_read_b64_tr_b16 a[24:25], v133 offset:24576
    ds_read_b64_tr_b16 a[26:27], v133 offset:25600
    ds_read_b64_tr_b16 a[184:185], v133 offset:24640
    ds_read_b64_tr_b16 a[186:187], v133 offset:25664
    ds_read_b64_tr_b16 a[28:29], v133 offset:28672
    ds_read_b64_tr_b16 a[30:31], v133 offset:29696
    ds_read_b64_tr_b16 a[188:189], v133 offset:28736
    ds_read_b64_tr_b16 a[190:191], v133 offset:29760
    s_waitcnt lgkmcnt(0)
    s_waitcnt vmcnt(12)
    s_barrier
    ds_read_b64_tr_b16 a[32:33], v133 offset:32768
    ds_read_b64_tr_b16 a[34:35], v133 offset:33792
    ds_read_b64_tr_b16 a[192:193], v133 offset:32832
    ds_read_b64_tr_b16 a[194:195], v133 offset:33856
    ds_read_b64_tr_b16 a[36:37], v133 offset:36864
    ds_read_b64_tr_b16 a[38:39], v133 offset:37888
    ds_read_b64_tr_b16 a[196:197], v133 offset:36928
    ds_read_b64_tr_b16 a[198:199], v133 offset:37952
    ds_read_b64_tr_b16 a[40:41], v133 offset:40960
    ds_read_b64_tr_b16 a[42:43], v133 offset:41984
    ds_read_b64_tr_b16 a[200:201], v133 offset:41024
    ds_read_b64_tr_b16 a[202:203], v133 offset:42048
    ds_read_b64_tr_b16 a[44:45], v133 offset:45056
    ds_read_b64_tr_b16 a[46:47], v133 offset:46080
    ds_read_b64_tr_b16 a[204:205], v133 offset:45120
    ds_read_b64_tr_b16 a[206:207], v133 offset:46144
    s_waitcnt vmcnt(8)
    s_barrier
    ds_read_b64_tr_b16 a[48:49], v133 offset:49152
    ds_read_b64_tr_b16 a[50:51], v133 offset:50176
    ds_read_b64_tr_b16 a[208:209], v133 offset:49216
    ds_read_b64_tr_b16 a[210:211], v133 offset:50240
    ds_read_b64_tr_b16 a[52:53], v133 offset:53248
    ds_read_b64_tr_b16 a[54:55], v133 offset:54272
    ds_read_b64_tr_b16 a[212:213], v133 offset:53312
    ds_read_b64_tr_b16 a[214:215], v133 offset:54336
    ds_read_b64_tr_b16 a[56:57], v133 offset:57344
    ds_read_b64_tr_b16 a[58:59], v133 offset:58368
    ds_read_b64_tr_b16 a[216:217], v133 offset:57408
    ds_read_b64_tr_b16 a[218:219], v133 offset:58432
    ds_read_b64_tr_b16 a[60:61], v133 offset:61440
    ds_read_b64_tr_b16 a[62:63], v133 offset:62464
    ds_read_b64_tr_b16 a[220:221], v133 offset:61504
    ds_read_b64_tr_b16 a[222:223], v133 offset:62528
    s_waitcnt lgkmcnt(0)
    s_waitcnt vmcnt(4)
    s_barrier
    ds_read_b64_tr_b16 a[64:65], v134 offset:0
    ds_read_b64_tr_b16 a[66:67], v134 offset:1024
    ds_read_b64_tr_b16 a[224:225], v134 offset:64
    ds_read_b64_tr_b16 a[226:227], v134 offset:1088
    ds_read_b64_tr_b16 a[68:69], v134 offset:4096
    ds_read_b64_tr_b16 a[70:71], v134 offset:5120
    ds_read_b64_tr_b16 a[228:229], v134 offset:4160
    ds_read_b64_tr_b16 a[230:231], v134 offset:5184
    ds_read_b64_tr_b16 a[72:73], v134 offset:8192
    ds_read_b64_tr_b16 a[74:75], v134 offset:9216
    ds_read_b64_tr_b16 a[232:233], v134 offset:8256
    ds_read_b64_tr_b16 a[234:235], v134 offset:9280
    ds_read_b64_tr_b16 a[76:77], v134 offset:12288
    ds_read_b64_tr_b16 a[78:79], v134 offset:13312
    ds_read_b64_tr_b16 a[236:237], v134 offset:12352
    ds_read_b64_tr_b16 a[238:239], v134 offset:13376
    s_waitcnt vmcnt(0)
    s_barrier
    ds_read_b64_tr_b16 a[80:81], v134 offset:16384
    ds_read_b64_tr_b16 a[82:83], v134 offset:17408
    ds_read_b64_tr_b16 a[240:241], v134 offset:16448
    ds_read_b64_tr_b16 a[242:243], v134 offset:17472
    ds_read_b64_tr_b16 a[84:85], v134 offset:20480
    ds_read_b64_tr_b16 a[86:87], v134 offset:21504
    ds_read_b64_tr_b16 a[244:245], v134 offset:20544
    ds_read_b64_tr_b16 a[246:247], v134 offset:21568
    ds_read_b64_tr_b16 a[88:89], v134 offset:24576
    ds_read_b64_tr_b16 a[90:91], v134 offset:25600
    ds_read_b64_tr_b16 a[248:249], v134 offset:24640
    ds_read_b64_tr_b16 a[250:251], v134 offset:25664
    ds_read_b64_tr_b16 a[92:93], v134 offset:28672
    ds_read_b64_tr_b16 a[94:95], v134 offset:29696
    ds_read_b64_tr_b16 a[252:253], v134 offset:28736
    ds_read_b64_tr_b16 a[254:255], v134 offset:29760
    s_waitcnt lgkmcnt(0)
    s_waitcnt lgkmcnt(0)
    s_barrier
    v_lshrrev_b32 v128, 4, v0
    v_add_u32 v128, 0, v128
    v_and_b32 v129, 15, v0
    v_xor_b32 v129, v129, v128
    v_mul_u32_u24 v128, 1280, v128
    v_lshl_add_u32 v26, v129, 4, v128
    v_lshrrev_b32 v128, 4, v0
    v_add_u32 v128, 4, v128
    v_and_b32 v129, 15, v0
    v_xor_b32 v129, v129, v128
    v_mul_u32_u24 v128, 1280, v128
    v_lshl_add_u32 v27, v129, 4, v128
    v_lshrrev_b32 v128, 4, v0
    v_add_u32 v128, 8, v128
    v_and_b32 v129, 15, v0
    v_xor_b32 v129, v129, v128
    v_mul_u32_u24 v128, 1280, v128
    v_lshl_add_u32 v28, v129, 4, v128
    v_lshrrev_b32 v128, 4, v0
    v_add_u32 v128, 12, v128
    v_and_b32 v129, 15, v0
    v_xor_b32 v129, v129, v128
    v_mul_u32_u24 v128, 1280, v128
    v_lshl_add_u32 v29, v129, 4, v128
    v_and_b32 v128, 31, v0
    v_and_b32 v129, 19, v128
    v_bfe_u32 v130, v128, 2, 1
    v_lshl_add_u32 v129, v130, 3, v129
    v_bfe_u32 v130, v128, 3, 1
    v_lshl_add_u32 v129, v130, 2, v129
    v_mov_b32 v128, v129
    v_and_b32 v129, 15, v128
    v_lshrrev_b32 v130, 5, v0
    v_xor_b32 v129, v129, v130
    s_lshr_b32 s65, s4, 1
    s_lshl_b32 s65, s65, 13
    v_lshlrev_b32 v128, 8, v128
    v_add_u32 v128, s65, v128
    v_xor_b32 v130, 0, v129
    v_lshl_add_u32 v2, v130, 4, v128
    v_add_u32 v10, 0x10000, v2
    v_add_u32 v18, 0x20000, v2
    v_xor_b32 v130, 2, v129
    v_lshl_add_u32 v3, v130, 4, v128
    v_add_u32 v11, 0x10000, v3
    v_add_u32 v19, 0x20000, v3
    v_xor_b32 v130, 4, v129
    v_lshl_add_u32 v4, v130, 4, v128
    v_add_u32 v12, 0x10000, v4
    v_add_u32 v20, 0x20000, v4
    v_xor_b32 v130, 6, v129
    v_lshl_add_u32 v5, v130, 4, v128
    v_add_u32 v13, 0x10000, v5
    v_add_u32 v21, 0x20000, v5
    v_xor_b32 v130, 8, v129
    v_lshl_add_u32 v6, v130, 4, v128
    v_add_u32 v14, 0x10000, v6
    v_add_u32 v22, 0x20000, v6
    v_xor_b32 v130, 10, v129
    v_lshl_add_u32 v7, v130, 4, v128
    v_add_u32 v15, 0x10000, v7
    v_add_u32 v23, 0x20000, v7
    v_xor_b32 v130, 12, v129
    v_lshl_add_u32 v8, v130, 4, v128
    v_add_u32 v16, 0x10000, v8
    v_add_u32 v24, 0x20000, v8
    v_xor_b32 v130, 14, v129
    v_lshl_add_u32 v9, v130, 4, v128
    v_add_u32 v17, 0x10000, v9
    v_add_u32 v25, 0x20000, v9
    v_mov_b32 v136, 0x80000000
    s_lshl_b32 s79, s4, 12
    s_waitcnt vmcnt(0)
    s_mov_b32 s52, 0
    s_mov_b32 s57, 0
    s_add_u32 s65, s53, 0
    s_add_u32 s66, s79, 0
    s_mov_b32 m0, s66
    s_nop 0
    buffer_load_dwordx4 v26, s[48:51], s65 offen lds
    s_add_u32 s66, s79, 1024
    s_mov_b32 m0, s66
    s_nop 0
    buffer_load_dwordx4 v27, s[48:51], s65 offen lds
    s_add_u32 s66, s79, 2048
    s_mov_b32 m0, s66
    s_nop 0
    buffer_load_dwordx4 v28, s[48:51], s65 offen lds
    s_add_u32 s66, s79, 3072
    s_mov_b32 m0, s66
    s_nop 0
    buffer_load_dwordx4 v29, s[48:51], s65 offen lds
    s_add_u32 s65, s53, 256
    s_add_u32 s66, s79, 16384
    s_mov_b32 m0, s66
    s_nop 0
    buffer_load_dwordx4 v26, s[48:51], s65 offen lds
    s_add_u32 s66, s79, 17408
    s_mov_b32 m0, s66
    s_nop 0
    buffer_load_dwordx4 v27, s[48:51], s65 offen lds
    s_add_u32 s66, s79, 18432
    s_mov_b32 m0, s66
    s_nop 0
    buffer_load_dwordx4 v28, s[48:51], s65 offen lds
    s_add_u32 s66, s79, 19456
    s_mov_b32 m0, s66
    s_nop 0
    buffer_load_dwordx4 v29, s[48:51], s65 offen lds
    s_add_u32 s65, s53, 512
    s_add_u32 s66, s79, 32768
    s_mov_b32 m0, s66
    s_nop 0
    buffer_load_dwordx4 v26, s[48:51], s65 offen lds
    s_add_u32 s66, s79, 33792
    s_mov_b32 m0, s66
    s_nop 0
    buffer_load_dwordx4 v27, s[48:51], s65 offen lds
    s_add_u32 s66, s79, 34816
    s_mov_b32 m0, s66
    s_nop 0
    buffer_load_dwordx4 v28, s[48:51], s65 offen lds
    s_add_u32 s66, s79, 35840
    s_mov_b32 m0, s66
    s_nop 0
    buffer_load_dwordx4 v29, s[48:51], s65 offen lds
    s_add_u32 s65, s53, 768
    s_add_u32 s66, s79, 49152
    s_mov_b32 m0, s66
    s_nop 0
    buffer_load_dwordx4 v26, s[48:51], s65 offen lds
    s_add_u32 s66, s79, 50176
    s_mov_b32 m0, s66
    s_nop 0
    buffer_load_dwordx4 v27, s[48:51], s65 offen lds
    s_add_u32 s66, s79, 51200
    s_mov_b32 m0, s66
    s_nop 0
    buffer_load_dwordx4 v28, s[48:51], s65 offen lds
    s_add_u32 s66, s79, 52224
    s_mov_b32 m0, s66
    s_nop 0
    buffer_load_dwordx4 v29, s[48:51], s65 offen lds
    s_add_u32 s65, s53, 1024
    s_add_u32 s66, s79, 65536
    s_mov_b32 m0, s66
    s_nop 0
    buffer_load_dwordx4 v26, s[48:51], s65 offen lds
    s_add_u32 s66, s79, 66560
    s_mov_b32 m0, s66
    s_nop 0
    buffer_load_dwordx4 v27, s[48:51], s65 offen lds
    s_add_u32 s66, s79, 67584
    s_mov_b32 m0, s66
    s_nop 0
    buffer_load_dwordx4 v28, s[48:51], s65 offen lds
    s_add_u32 s66, s79, 68608
    s_mov_b32 m0, s66
    s_nop 0
    buffer_load_dwordx4 v29, s[48:51], s65 offen lds
    s_add_u32 s65, s53, 81920
    s_add_u32 s66, s79, 81920
    s_mov_b32 m0, s66
    s_nop 0
    buffer_load_dwordx4 v26, s[48:51], s65 offen lds
    s_add_u32 s66, s79, 82944
    s_mov_b32 m0, s66
    s_nop 0
    buffer_load_dwordx4 v27, s[48:51], s65 offen lds
    s_add_u32 s66, s79, 83968
    s_mov_b32 m0, s66
    s_nop 0
    buffer_load_dwordx4 v28, s[48:51], s65 offen lds
    s_add_u32 s66, s79, 84992
    s_mov_b32 m0, s66
    s_nop 0
    buffer_load_dwordx4 v29, s[48:51], s65 offen lds
    s_add_u32 s65, s53, 82176
    s_add_u32 s66, s79, 98304
    s_mov_b32 m0, s66
    s_nop 0
    buffer_load_dwordx4 v26, s[48:51], s65 offen lds
    s_add_u32 s66, s79, 99328
    s_mov_b32 m0, s66
    s_nop 0
    buffer_load_dwordx4 v27, s[48:51], s65 offen lds
    s_add_u32 s66, s79, 100352
    s_mov_b32 m0, s66
    s_nop 0
    buffer_load_dwordx4 v28, s[48:51], s65 offen lds
    s_add_u32 s66, s79, 101376
    s_mov_b32 m0, s66
    s_nop 0
    buffer_load_dwordx4 v29, s[48:51], s65 offen lds
    s_add_u32 s65, s53, 82432
    s_add_u32 s66, s79, 114688
    s_mov_b32 m0, s66
    s_nop 0
    buffer_load_dwordx4 v26, s[48:51], s65 offen lds
    s_add_u32 s66, s79, 115712
    s_mov_b32 m0, s66
    s_nop 0
    buffer_load_dwordx4 v27, s[48:51], s65 offen lds
    s_add_u32 s66, s79, 116736
    s_mov_b32 m0, s66
    s_nop 0
    buffer_load_dwordx4 v28, s[48:51], s65 offen lds
    s_add_u32 s66, s79, 117760
    s_mov_b32 m0, s66
    s_nop 0
    buffer_load_dwordx4 v29, s[48:51], s65 offen lds
    s_waitcnt vmcnt(28)
    s_barrier
    ds_read_b128 v[32:35], v2 offset:0
    ds_read_b128 v[36:39], v3 offset:0
    ds_read_b128 v[40:43], v4 offset:0
L_g1_v:
    s_add_u32 s65, s53, 82688
    s_waitcnt lgkmcnt(2)
    v_mfma_f32_32x32x16_bf16 v[64:79], v[32:35], v[192:195], 0
    ds_read_b128 v[44:47], v5 offset:0
    v_mfma_f32_32x32x16_bf16 v[80:95], v[32:35], a[96:99], 0
    s_add_u32 s66, s79, 131072
    s_mov_b32 m0, s66
    s_nop 0
    buffer_load_dwordx4 v26, s[48:51], s65 offen lds
    s_waitcnt lgkmcnt(2)
    v_mfma_f32_32x32x16_bf16 v[64:79], v[36:39], v[196:199], v[64:79]
    ds_read_b128 v[32:35], v6 offset:0
    v_cvt_pk_bf16_f32 v48, v96, v97
    v_cvt_pk_bf16_f32 v49, v98, v99
    v_mfma_f32_32x32x16_bf16 v[80:95], v[36:39], a[100:103], v[80:95]
    s_add_u32 s66, s79, 132096
    s_mov_b32 m0, s66
    s_nop 0
    buffer_load_dwordx4 v27, s[48:51], s65 offen lds
    v_cvt_pk_bf16_f32 v50, v100, v101
    v_cvt_pk_bf16_f32 v51, v102, v103
    s_waitcnt lgkmcnt(2)
    v_mfma_f32_32x32x16_bf16 v[64:79], v[40:43], v[200:203], v[64:79]
    ds_read_b128 v[36:39], v7 offset:0
    buffer_store_dwordx4 v[48:51], v136, s[8:11], s54 offen offset:0 sc1
    v_cvt_pk_bf16_f32 v52, v104, v105
    v_mfma_f32_32x32x16_bf16 v[80:95], v[40:43], a[104:107], v[80:95]
    s_add_u32 s66, s79, 133120
    s_mov_b32 m0, s66
    s_nop 0
    buffer_load_dwordx4 v28, s[48:51], s65 offen lds
    v_cvt_pk_bf16_f32 v53, v106, v107
    v_cvt_pk_bf16_f32 v54, v108, v109
    s_waitcnt lgkmcnt(2)
    v_mfma_f32_32x32x16_bf16 v[64:79], v[44:47], v[204:207], v[64:79]
    ds_read_b128 v[40:43], v8 offset:0
    v_cvt_pk_bf16_f32 v55, v110, v111
    buffer_store_dwordx4 v[52:55], v136, s[8:11], s54 offen offset:1024 sc1
    v_mfma_f32_32x32x16_bf16 v[80:95], v[44:47], a[108:111], v[80:95]
    s_add_u32 s66, s79, 134144
    s_mov_b32 m0, s66
    s_nop 0
    buffer_load_dwordx4 v29, s[48:51], s65 offen lds
    v_cvt_pk_bf16_f32 v56, v112, v113
    v_cvt_pk_bf16_f32 v57, v114, v115
    s_waitcnt lgkmcnt(2)
    v_mfma_f32_32x32x16_bf16 v[64:79], v[32:35], v[208:211], v[64:79]
    ds_read_b128 v[44:47], v9 offset:0
    v_cvt_pk_bf16_f32 v58, v116, v117
    v_cvt_pk_bf16_f32 v59, v118, v119
    v_mfma_f32_32x32x16_bf16 v[80:95], v[32:35], a[112:115], v[80:95]
    buffer_store_dwordx4 v[56:59], v136, s[8:11], s54 offen offset:2048 sc1
    v_cvt_pk_bf16_f32 v60, v120, v121
    s_waitcnt vmcnt(28)
    s_barrier
    s_waitcnt lgkmcnt(2)
    v_mfma_f32_32x32x16_bf16 v[64:79], v[36:39], v[212:215], v[64:79]
    ds_read_b128 v[32:35], v2 offset:16384
    v_cvt_pk_bf16_f32 v61, v122, v123
    v_cvt_pk_bf16_f32 v62, v124, v125
    v_mfma_f32_32x32x16_bf16 v[80:95], v[36:39], a[116:119], v[80:95]
    v_cvt_pk_bf16_f32 v63, v126, v127
    buffer_store_dwordx4 v[60:63], v136, s[8:11], s54 offen offset:3072 sc1
    s_waitcnt lgkmcnt(2)
    v_mfma_f32_32x32x16_bf16 v[64:79], v[40:43], v[216:219], v[64:79]
    ds_read_b128 v[36:39], v3 offset:16384
    v_mfma_f32_32x32x16_bf16 v[80:95], v[40:43], a[120:123], v[80:95]
    s_waitcnt lgkmcnt(2)
    v_mfma_f32_32x32x16_bf16 v[64:79], v[44:47], v[220:223], v[64:79]
    ds_read_b128 v[40:43], v4 offset:16384
    v_mfma_f32_32x32x16_bf16 v[80:95], v[44:47], a[124:127], v[80:95]
    s_add_u32 s54, s54, s57
    s_mov_b32 s57, 49152
    v_mov_b32 v136, v1
    s_add_u32 s65, s53, 82944
    s_waitcnt lgkmcnt(2)
    v_mfma_f32_32x32x16_bf16 v[64:79], v[32:35], v[224:227], v[64:79]
    ds_read_b128 v[44:47], v5 offset:16384
    v_mfma_f32_32x32x16_bf16 v[80:95], v[32:35], a[128:131], v[80:95]
    s_add_u32 s66, s79, 147456
    s_mov_b32 m0, s66
    s_nop 0
    buffer_load_dwordx4 v26, s[48:51], s65 offen lds
    s_waitcnt lgkmcnt(2)
    v_mfma_f32_32x32x16_bf16 v[64:79], v[36:39], v[228:231], v[64:79]
    ds_read_b128 v[32:35], v6 offset:16384
    v_mfma_f32_32x32x16_bf16 v[80:95], v[36:39], a[132:135], v[80:95]
    s_add_u32 s66, s79, 148480
    s_mov_b32 m0, s66
    s_nop 0
    buffer_load_dwordx4 v27, s[48:51], s65 offen lds
    s_waitcnt lgkmcnt(2)
    v_mfma_f32_32x32x16_bf16 v[64:79], v[40:43], v[232:235], v[64:79]
    ds_read_b128 v[36:39], v7 offset:16384
    v_mfma_f32_32x32x16_bf16 v[80:95], v[40:43], a[136:139], v[80:95]
    s_add_u32 s66, s79, 149504
    s_mov_b32 m0, s66
    s_nop 0
    buffer_load_dwordx4 v28, s[48:51], s65 offen lds
    s_waitcnt lgkmcnt(2)
    v_mfma_f32_32x32x16_bf16 v[64:79], v[44:47], v[236:239], v[64:79]
    ds_read_b128 v[40:43], v8 offset:16384
    v_mfma_f32_32x32x16_bf16 v[80:95], v[44:47], a[140:143], v[80:95]
    s_add_u32 s66, s79, 150528
    s_mov_b32 m0, s66
    s_nop 0
    buffer_load_dwordx4 v29, s[48:51], s65 offen lds
    s_waitcnt lgkmcnt(2)
    v_mfma_f32_32x32x16_bf16 v[64:79], v[32:35], v[240:243], v[64:79]
    ds_read_b128 v[44:47], v9 offset:16384
    v_mfma_f32_32x32x16_bf16 v[80:95], v[32:35], a[144:147], v[80:95]
    s_waitcnt vmcnt(28)
    s_barrier
    s_waitcnt lgkmcnt(2)
    v_mfma_f32_32x32x16_bf16 v[64:79], v[36:39], v[244:247], v[64:79]
    ds_read_b128 v[32:35], v2 offset:32768
    v_mfma_f32_32x32x16_bf16 v[80:95], v[36:39], a[148:151], v[80:95]
    s_waitcnt lgkmcnt(2)
    v_mfma_f32_32x32x16_bf16 v[64:79], v[40:43], v[248:251], v[64:79]
    ds_read_b128 v[36:39], v3 offset:32768
    v_mfma_f32_32x32x16_bf16 v[80:95], v[40:43], a[152:155], v[80:95]
    s_waitcnt lgkmcnt(2)
    v_mfma_f32_32x32x16_bf16 v[64:79], v[44:47], v[252:255], v[64:79]
    ds_read_b128 v[40:43], v4 offset:32768
    v_mfma_f32_32x32x16_bf16 v[80:95], v[44:47], a[156:159], v[80:95]
    s_add_u32 s65, s53, 163840
    s_waitcnt lgkmcnt(2)
    v_mfma_f32_32x32x16_bf16 v[64:79], v[32:35], a[0:3], v[64:79]
    ds_read_b128 v[44:47], v5 offset:32768
    v_mfma_f32_32x32x16_bf16 v[80:95], v[32:35], a[160:163], v[80:95]
    s_add_u32 s66, s79, 0
    s_mov_b32 m0, s66
    s_nop 0
    buffer_load_dwordx4 v26, s[48:51], s65 offen lds
    s_waitcnt lgkmcnt(2)
    v_mfma_f32_32x32x16_bf16 v[64:79], v[36:39], a[4:7], v[64:79]
    ds_read_b128 v[32:35], v6 offset:32768
    v_mfma_f32_32x32x16_bf16 v[80:95], v[36:39], a[164:167], v[80:95]
    s_add_u32 s66, s79, 1024
    s_mov_b32 m0, s66
    s_nop 0
    buffer_load_dwordx4 v27, s[48:51], s65 offen lds
    s_waitcnt lgkmcnt(2)
    v_mfma_f32_32x32x16_bf16 v[64:79], v[40:43], a[8:11], v[64:79]
    ds_read_b128 v[36:39], v7 offset:32768
    v_mfma_f32_32x32x16_bf16 v[80:95], v[40:43], a[168:171], v[80:95]
    s_add_u32 s66, s79, 2048
    s_mov_b32 m0, s66
    s_nop 0
    buffer_load_dwordx4 v28, s[48:51], s65 offen lds
    s_waitcnt lgkmcnt(2)
    v_mfma_f32_32x32x16_bf16 v[64:79], v[44:47], a[12:15], v[64:79]
    ds_read_b128 v[40:43], v8 offset:32768
    v_mfma_f32_32x32x16_bf16 v[80:95], v[44:47], a[172:175], v[80:95]
    s_add_u32 s66, s79, 3072
    s_mov_b32 m0, s66
    s_nop 0
    buffer_load_dwordx4 v29, s[48:51], s65 offen lds
    s_waitcnt lgkmcnt(2)
    v_mfma_f32_32x32x16_bf16 v[64:79], v[32:35], a[16:19], v[64:79]
    ds_read_b128 v[44:47], v9 offset:32768
    v_mfma_f32_32x32x16_bf16 v[80:95], v[32:35], a[176:179], v[80:95]
    s_waitcnt vmcnt(28)
    s_barrier
    s_waitcnt lgkmcnt(2)
    v_mfma_f32_32x32x16_bf16 v[64:79], v[36:39], a[20:23], v[64:79]
    ds_read_b128 v[32:35], v2 offset:49152
    v_mfma_f32_32x32x16_bf16 v[80:95], v[36:39], a[180:183], v[80:95]
    s_waitcnt lgkmcnt(2)
    v_mfma_f32_32x32x16_bf16 v[64:79], v[40:43], a[24:27], v[64:79]
    ds_read_b128 v[36:39], v3 offset:49152
    v_mfma_f32_32x32x16_bf16 v[80:95], v[40:43], a[184:187], v[80:95]
    s_waitcnt lgkmcnt(2)
    v_mfma_f32_32x32x16_bf16 v[64:79], v[44:47], a[28:31], v[64:79]
    ds_read_b128 v[40:43], v4 offset:49152
    v_mfma_f32_32x32x16_bf16 v[80:95], v[44:47], a[188:191], v[80:95]
    s_add_u32 s65, s53, 164096
    s_waitcnt lgkmcnt(2)
    v_mfma_f32_32x32x16_bf16 v[64:79], v[32:35], a[32:35], v[64:79]
    ds_read_b128 v[44:47], v5 offset:49152
    v_mfma_f32_32x32x16_bf16 v[80:95], v[32:35], a[192:195], v[80:95]
    s_add_u32 s66, s79, 16384
    s_mov_b32 m0, s66
    s_nop 0
    buffer_load_dwordx4 v26, s[48:51], s65 offen lds
    s_waitcnt lgkmcnt(2)
    v_mfma_f32_32x32x16_bf16 v[64:79], v[36:39], a[36:39], v[64:79]
    ds_read_b128 v[32:35], v6 offset:49152
    v_mfma_f32_32x32x16_bf16 v[80:95], v[36:39], a[196:199], v[80:95]
    s_add_u32 s66, s79, 17408
    s_mov_b32 m0, s66
    s_nop 0
    buffer_load_dwordx4 v27, s[48:51], s65 offen lds
    s_waitcnt lgkmcnt(2)
    v_mfma_f32_32x32x16_bf16 v[64:79], v[40:43], a[40:43], v[64:79]
    ds_read_b128 v[36:39], v7 offset:49152
    v_mfma_f32_32x32x16_bf16 v[80:95], v[40:43], a[200:203], v[80:95]
    s_add_u32 s66, s79, 18432
    s_mov_b32 m0, s66
    s_nop 0
    buffer_load_dwordx4 v28, s[48:51], s65 offen lds
    s_waitcnt lgkmcnt(2)
    v_mfma_f32_32x32x16_bf16 v[64:79], v[44:47], a[44:47], v[64:79]
    ds_read_b128 v[40:43], v8 offset:49152
    v_mfma_f32_32x32x16_bf16 v[80:95], v[44:47], a[204:207], v[80:95]
    s_add_u32 s66, s79, 19456
    s_mov_b32 m0, s66
    s_nop 0
    buffer_load_dwordx4 v29, s[48:51], s65 offen lds
    s_waitcnt lgkmcnt(2)
    v_mfma_f32_32x32x16_bf16 v[64:79], v[32:35], a[48:51], v[64:79]
    ds_read_b128 v[44:47], v9 offset:49152
    v_mfma_f32_32x32x16_bf16 v[80:95], v[32:35], a[208:211], v[80:95]
    s_waitcnt vmcnt(28)
    s_barrier
    s_cmp_lg_u32 s4, 0
    s_cbranch_scc1 L_np0_v
    s_add_u32 s56, s52, 0
    s_cmp_lt_u32 s56, 2
    s_cbranch_scc1 L_np0_v
    s_sub_u32 s56, s56, 1
    s_lshl_b32 s56, s56, 1
    v_mov_b32 v144, s56
    v_mov_b32 v145, s56
    v_mov_b32 v146, s56
    v_mov_b32 v147, s56
    s_mov_b64 exec, 0xff
    buffer_store_dwordx4 v[144:147], v1, s[8:11], s55 offen sc1
    s_mov_b64 exec, -1
L_np0_v:
    s_waitcnt lgkmcnt(2)
    v_mfma_f32_32x32x16_bf16 v[64:79], v[36:39], a[52:55], v[64:79]
    ds_read_b128 v[32:35], v10 offset:0
    v_mfma_f32_32x32x16_bf16 v[80:95], v[36:39], a[212:215], v[80:95]
    s_waitcnt lgkmcnt(2)
    v_mfma_f32_32x32x16_bf16 v[64:79], v[40:43], a[56:59], v[64:79]
    ds_read_b128 v[36:39], v11 offset:0
    v_mfma_f32_32x32x16_bf16 v[80:95], v[40:43], a[216:219], v[80:95]
    s_waitcnt lgkmcnt(2)
    v_mfma_f32_32x32x16_bf16 v[64:79], v[44:47], a[60:63], v[64:79]
    ds_read_b128 v[40:43], v12 offset:0
    v_mfma_f32_32x32x16_bf16 v[80:95], v[44:47], a[220:223], v[80:95]
    s_add_u32 s65, s53, 164352
    s_waitcnt lgkmcnt(2)
    v_mfma_f32_32x32x16_bf16 v[64:79], v[32:35], a[64:67], v[64:79]
    ds_read_b128 v[44:47], v13 offset:0
    v_mfma_f32_32x32x16_bf16 v[80:95], v[32:35], a[224:227], v[80:95]
    s_add_u32 s66, s79, 32768
    s_mov_b32 m0, s66
    s_nop 0
    buffer_load_dwordx4 v26, s[48:51], s65 offen lds
    s_waitcnt lgkmcnt(2)
    v_mfma_f32_32x32x16_bf16 v[64:79], v[36:39], a[68:71], v[64:79]
    ds_read_b128 v[32:35], v14 offset:0
    v_mfma_f32_32x32x16_bf16 v[80:95], v[36:39], a[228:231], v[80:95]
    s_add_u32 s66, s79, 33792
    s_mov_b32 m0, s66
    s_nop 0
    buffer_load_dwordx4 v27, s[48:51], s65 offen lds
    s_waitcnt lgkmcnt(2)
    v_mfma_f32_32x32x16_bf16 v[64:79], v[40:43], a[72:75], v[64:79]
    ds_read_b128 v[36:39], v15 offset:0
    v_mfma_f32_32x32x16_bf16 v[80:95], v[40:43], a[232:235], v[80:95]
    s_add_u32 s66, s79, 34816
    s_mov_b32 m0, s66
    s_nop 0
    buffer_load_dwordx4 v28, s[48:51], s65 offen lds
    s_waitcnt lgkmcnt(2)
    v_mfma_f32_32x32x16_bf16 v[64:79], v[44:47], a[76:79], v[64:79]
    ds_read_b128 v[40:43], v16 offset:0
    v_mfma_f32_32x32x16_bf16 v[80:95], v[44:47], a[236:239], v[80:95]
    s_add_u32 s66, s79, 35840
    s_mov_b32 m0, s66
    s_nop 0
    buffer_load_dwordx4 v29, s[48:51], s65 offen lds
    s_waitcnt lgkmcnt(2)
    v_mfma_f32_32x32x16_bf16 v[64:79], v[32:35], a[80:83], v[64:79]
    ds_read_b128 v[44:47], v17 offset:0
    v_mfma_f32_32x32x16_bf16 v[80:95], v[32:35], a[240:243], v[80:95]
    s_waitcnt vmcnt(28)
    s_barrier
    s_waitcnt lgkmcnt(2)
    v_mfma_f32_32x32x16_bf16 v[64:79], v[36:39], a[84:87], v[64:79]
    ds_read_b128 v[32:35], v10 offset:16384
    v_mfma_f32_32x32x16_bf16 v[80:95], v[36:39], a[244:247], v[80:95]
    s_waitcnt lgkmcnt(2)
    v_mfma_f32_32x32x16_bf16 v[64:79], v[40:43], a[88:91], v[64:79]
    ds_read_b128 v[36:39], v11 offset:16384
    v_mfma_f32_32x32x16_bf16 v[80:95], v[40:43], a[248:251], v[80:95]
    s_waitcnt lgkmcnt(2)
    v_mfma_f32_32x32x16_bf16 v[64:79], v[44:47], a[92:95], v[64:79]
    ds_read_b128 v[40:43], v12 offset:16384
    v_mfma_f32_32x32x16_bf16 v[80:95], v[44:47], a[252:255], v[80:95]
    s_add_u32 s65, s53, 164608
    s_waitcnt lgkmcnt(2)
    v_mfma_f32_32x32x16_bf16 v[96:111], v[32:35], v[192:195], 0
    ds_read_b128 v[44:47], v13 offset:16384
    v_mfma_f32_32x32x16_bf16 v[112:127], v[32:35], a[96:99], 0
    s_add_u32 s66, s79, 49152
    s_mov_b32 m0, s66
    s_nop 0
    buffer_load_dwordx4 v26, s[48:51], s65 offen lds
    s_waitcnt lgkmcnt(2)
    v_mfma_f32_32x32x16_bf16 v[96:111], v[36:39], v[196:199], v[96:111]
    ds_read_b128 v[32:35], v14 offset:16384
    v_cvt_pk_bf16_f32 v48, v64, v65
    v_cvt_pk_bf16_f32 v49, v66, v67
    v_mfma_f32_32x32x16_bf16 v[112:127], v[36:39], a[100:103], v[112:127]
    s_add_u32 s66, s79, 50176
    s_mov_b32 m0, s66
    s_nop 0
    buffer_load_dwordx4 v27, s[48:51], s65 offen lds
    v_cvt_pk_bf16_f32 v50, v68, v69
    v_cvt_pk_bf16_f32 v51, v70, v71
    s_waitcnt lgkmcnt(2)
    v_mfma_f32_32x32x16_bf16 v[96:111], v[40:43], v[200:203], v[96:111]
    ds_read_b128 v[36:39], v15 offset:16384
    buffer_store_dwordx4 v[48:51], v136, s[8:11], s54 offen offset:0 sc1
    v_cvt_pk_bf16_f32 v52, v72, v73
    v_mfma_f32_32x32x16_bf16 v[112:127], v[40:43], a[104:107], v[112:127]
    s_add_u32 s66, s79, 51200
    s_mov_b32 m0, s66
    s_nop 0
    buffer_load_dwordx4 v28, s[48:51], s65 offen lds
    v_cvt_pk_bf16_f32 v53, v74, v75
    v_cvt_pk_bf16_f32 v54, v76, v77
    s_waitcnt lgkmcnt(2)
    v_mfma_f32_32x32x16_bf16 v[96:111], v[44:47], v[204:207], v[96:111]
    ds_read_b128 v[40:43], v16 offset:16384
    v_cvt_pk_bf16_f32 v55, v78, v79
    buffer_store_dwordx4 v[52:55], v136, s[8:11], s54 offen offset:1024 sc1
    v_mfma_f32_32x32x16_bf16 v[112:127], v[44:47], a[108:111], v[112:127]
    s_add_u32 s66, s79, 52224
    s_mov_b32 m0, s66
    s_nop 0
    buffer_load_dwordx4 v29, s[48:51], s65 offen lds
    v_cvt_pk_bf16_f32 v56, v80, v81
    v_cvt_pk_bf16_f32 v57, v82, v83
    s_waitcnt lgkmcnt(2)
    v_mfma_f32_32x32x16_bf16 v[96:111], v[32:35], v[208:211], v[96:111]
    ds_read_b128 v[44:47], v17 offset:16384
    v_cvt_pk_bf16_f32 v58, v84, v85
    v_cvt_pk_bf16_f32 v59, v86, v87
    v_mfma_f32_32x32x16_bf16 v[112:127], v[32:35], a[112:115], v[112:127]
    buffer_store_dwordx4 v[56:59], v136, s[8:11], s54 offen offset:2048 sc1
    v_cvt_pk_bf16_f32 v60, v88, v89
    s_waitcnt vmcnt(28)
    s_barrier
    s_waitcnt lgkmcnt(2)
    v_mfma_f32_32x32x16_bf16 v[96:111], v[36:39], v[212:215], v[96:111]
    ds_read_b128 v[32:35], v10 offset:32768
    v_cvt_pk_bf16_f32 v61, v90, v91
    v_cvt_pk_bf16_f32 v62, v92, v93
    v_mfma_f32_32x32x16_bf16 v[112:127], v[36:39], a[116:119], v[112:127]
    v_cvt_pk_bf16_f32 v63, v94, v95
    buffer_store_dwordx4 v[60:63], v136, s[8:11], s54 offen offset:3072 sc1
    s_waitcnt lgkmcnt(2)
    v_mfma_f32_32x32x16_bf16 v[96:111], v[40:43], v[216:219], v[96:111]
    ds_read_b128 v[36:39], v11 offset:32768
    v_mfma_f32_32x32x16_bf16 v[112:127], v[40:43], a[120:123], v[112:127]
    s_waitcnt lgkmcnt(2)
    v_mfma_f32_32x32x16_bf16 v[96:111], v[44:47], v[220:223], v[96:111]
    ds_read_b128 v[40:43], v12 offset:32768
    v_mfma_f32_32x32x16_bf16 v[112:127], v[44:47], a[124:127], v[112:127]
    s_add_u32 s54, s54, s57
    s_mov_b32 s57, 49152
    v_mov_b32 v136, v1
    s_add_u32 s65, s53, 164864
    s_cmp_lg_u32 s52, 0
    s_cbranch_scc1 L_early_v
    s_waitcnt vmcnt(0)
    s_barrier
    s_cmp_lg_u32 s4, 0
    s_cbranch_scc1 L_early_v
    v_mov_b32 v144, 2
    v_mov_b32 v145, 2
    v_mov_b32 v146, 2
    v_mov_b32 v147, 2
    s_mov_b64 exec, 0xff
    buffer_store_dwordx4 v[144:147], v1, s[8:11], s55 offen sc1
    s_mov_b64 exec, -1
L_early_v:
    s_waitcnt lgkmcnt(2)
    v_mfma_f32_32x32x16_bf16 v[96:111], v[32:35], v[224:227], v[96:111]
    ds_read_b128 v[44:47], v13 offset:32768
    v_mfma_f32_32x32x16_bf16 v[112:127], v[32:35], a[128:131], v[112:127]
    s_add_u32 s66, s79, 65536
    s_mov_b32 m0, s66
    s_nop 0
    buffer_load_dwordx4 v26, s[48:51], s65 offen lds
    s_waitcnt lgkmcnt(2)
    v_mfma_f32_32x32x16_bf16 v[96:111], v[36:39], v[228:231], v[96:111]
    ds_read_b128 v[32:35], v14 offset:32768
    v_mfma_f32_32x32x16_bf16 v[112:127], v[36:39], a[132:135], v[112:127]
    s_add_u32 s66, s79, 66560
    s_mov_b32 m0, s66
    s_nop 0
    buffer_load_dwordx4 v27, s[48:51], s65 offen lds
    s_waitcnt lgkmcnt(2)
    v_mfma_f32_32x32x16_bf16 v[96:111], v[40:43], v[232:235], v[96:111]
    ds_read_b128 v[36:39], v15 offset:32768
    v_mfma_f32_32x32x16_bf16 v[112:127], v[40:43], a[136:139], v[112:127]
    s_add_u32 s66, s79, 67584
    s_mov_b32 m0, s66
    s_nop 0
    buffer_load_dwordx4 v28, s[48:51], s65 offen lds
    s_waitcnt lgkmcnt(2)
    v_mfma_f32_32x32x16_bf16 v[96:111], v[44:47], v[236:239], v[96:111]
    ds_read_b128 v[40:43], v16 offset:32768
    v_mfma_f32_32x32x16_bf16 v[112:127], v[44:47], a[140:143], v[112:127]
    s_add_u32 s66, s79, 68608
    s_mov_b32 m0, s66
    s_nop 0
    buffer_load_dwordx4 v29, s[48:51], s65 offen lds
    s_waitcnt lgkmcnt(2)
    v_mfma_f32_32x32x16_bf16 v[96:111], v[32:35], v[240:243], v[96:111]
    ds_read_b128 v[44:47], v17 offset:32768
    v_mfma_f32_32x32x16_bf16 v[112:127], v[32:35], a[144:147], v[112:127]
    s_waitcnt vmcnt(28)
    s_barrier
    s_waitcnt lgkmcnt(2)
    v_mfma_f32_32x32x16_bf16 v[96:111], v[36:39], v[244:247], v[96:111]
    ds_read_b128 v[32:35], v10 offset:49152
    v_mfma_f32_32x32x16_bf16 v[112:127], v[36:39], a[148:151], v[112:127]
    s_waitcnt lgkmcnt(2)
    v_mfma_f32_32x32x16_bf16 v[96:111], v[40:43], v[248:251], v[96:111]
    ds_read_b128 v[36:39], v11 offset:49152
    v_mfma_f32_32x32x16_bf16 v[112:127], v[40:43], a[152:155], v[112:127]
    s_waitcnt lgkmcnt(2)
    v_mfma_f32_32x32x16_bf16 v[96:111], v[44:47], v[252:255], v[96:111]
    ds_read_b128 v[40:43], v12 offset:49152
    v_mfma_f32_32x32x16_bf16 v[112:127], v[44:47], a[156:159], v[112:127]
    s_add_u32 s65, s53, 245760
    s_waitcnt lgkmcnt(2)
    v_mfma_f32_32x32x16_bf16 v[96:111], v[32:35], a[0:3], v[96:111]
    ds_read_b128 v[44:47], v13 offset:49152
    v_mfma_f32_32x32x16_bf16 v[112:127], v[32:35], a[160:163], v[112:127]
    s_add_u32 s66, s79, 81920
    s_mov_b32 m0, s66
    s_nop 0
    buffer_load_dwordx4 v26, s[48:51], s65 offen lds
    s_waitcnt lgkmcnt(2)
    v_mfma_f32_32x32x16_bf16 v[96:111], v[36:39], a[4:7], v[96:111]
    ds_read_b128 v[32:35], v14 offset:49152
    v_mfma_f32_32x32x16_bf16 v[112:127], v[36:39], a[164:167], v[112:127]
    s_add_u32 s66, s79, 82944
    s_mov_b32 m0, s66
    s_nop 0
    buffer_load_dwordx4 v27, s[48:51], s65 offen lds
    s_waitcnt lgkmcnt(2)
    v_mfma_f32_32x32x16_bf16 v[96:111], v[40:43], a[8:11], v[96:111]
    ds_read_b128 v[36:39], v15 offset:49152
    v_mfma_f32_32x32x16_bf16 v[112:127], v[40:43], a[168:171], v[112:127]
    s_add_u32 s66, s79, 83968
    s_mov_b32 m0, s66
    s_nop 0
    buffer_load_dwordx4 v28, s[48:51], s65 offen lds
    s_waitcnt lgkmcnt(2)
    v_mfma_f32_32x32x16_bf16 v[96:111], v[44:47], a[12:15], v[96:111]
    ds_read_b128 v[40:43], v16 offset:49152
    v_mfma_f32_32x32x16_bf16 v[112:127], v[44:47], a[172:175], v[112:127]
    s_add_u32 s66, s79, 84992
    s_mov_b32 m0, s66
    s_nop 0
    buffer_load_dwordx4 v29, s[48:51], s65 offen lds
    s_waitcnt lgkmcnt(2)
    v_mfma_f32_32x32x16_bf16 v[96:111], v[32:35], a[16:19], v[96:111]
    ds_read_b128 v[44:47], v17 offset:49152
    v_mfma_f32_32x32x16_bf16 v[112:127], v[32:35], a[176:179], v[112:127]
    s_waitcnt vmcnt(28)
    s_barrier
    s_waitcnt lgkmcnt(2)
    v_mfma_f32_32x32x16_bf16 v[96:111], v[36:39], a[20:23], v[96:111]
    ds_read_b128 v[32:35], v18 offset:0
    v_mfma_f32_32x32x16_bf16 v[112:127], v[36:39], a[180:183], v[112:127]
    s_waitcnt lgkmcnt(2)
    v_mfma_f32_32x32x16_bf16 v[96:111], v[40:43], a[24:27], v[96:111]
    ds_read_b128 v[36:39], v19 offset:0
    v_mfma_f32_32x32x16_bf16 v[112:127], v[40:43], a[184:187], v[112:127]
    s_waitcnt lgkmcnt(2)
    v_mfma_f32_32x32x16_bf16 v[96:111], v[44:47], a[28:31], v[96:111]
    ds_read_b128 v[40:43], v20 offset:0
    v_mfma_f32_32x32x16_bf16 v[112:127], v[44:47], a[188:191], v[112:127]
    s_add_u32 s65, s53, 246016
    s_waitcnt lgkmcnt(2)
    v_mfma_f32_32x32x16_bf16 v[96:111], v[32:35], a[32:35], v[96:111]
    ds_read_b128 v[44:47], v21 offset:0
    v_mfma_f32_32x32x16_bf16 v[112:127], v[32:35], a[192:195], v[112:127]
    s_add_u32 s66, s79, 98304
    s_mov_b32 m0, s66
    s_nop 0
    buffer_load_dwordx4 v26, s[48:51], s65 offen lds
    s_waitcnt lgkmcnt(2)
    v_mfma_f32_32x32x16_bf16 v[96:111], v[36:39], a[36:39], v[96:111]
    ds_read_b128 v[32:35], v22 offset:0
    v_mfma_f32_32x32x16_bf16 v[112:127], v[36:39], a[196:199], v[112:127]
    s_add_u32 s66, s79, 99328
    s_mov_b32 m0, s66
    s_nop 0
    buffer_load_dwordx4 v27, s[48:51], s65 offen lds
    s_waitcnt lgkmcnt(2)
    v_mfma_f32_32x32x16_bf16 v[96:111], v[40:43], a[40:43], v[96:111]
    ds_read_b128 v[36:39], v23 offset:0
    v_mfma_f32_32x32x16_bf16 v[112:127], v[40:43], a[200:203], v[112:127]
    s_add_u32 s66, s79, 100352
    s_mov_b32 m0, s66
    s_nop 0
    buffer_load_dwordx4 v28, s[48:51], s65 offen lds
    s_waitcnt lgkmcnt(2)
    v_mfma_f32_32x32x16_bf16 v[96:111], v[44:47], a[44:47], v[96:111]
    ds_read_b128 v[40:43], v24 offset:0
    v_mfma_f32_32x32x16_bf16 v[112:127], v[44:47], a[204:207], v[112:127]
    s_add_u32 s66, s79, 101376
    s_mov_b32 m0, s66
    s_nop 0
    buffer_load_dwordx4 v29, s[48:51], s65 offen lds
    s_waitcnt lgkmcnt(2)
    v_mfma_f32_32x32x16_bf16 v[96:111], v[32:35], a[48:51], v[96:111]
    ds_read_b128 v[44:47], v25 offset:0
    v_mfma_f32_32x32x16_bf16 v[112:127], v[32:35], a[208:211], v[112:127]
    s_waitcnt vmcnt(28)
    s_barrier
    s_cmp_lg_u32 s4, 0
    s_cbranch_scc1 L_np1_v
    s_add_u32 s56, s52, 1
    s_cmp_lt_u32 s56, 2
    s_cbranch_scc1 L_np1_v
    s_sub_u32 s56, s56, 1
    s_lshl_b32 s56, s56, 1
    v_mov_b32 v144, s56
    v_mov_b32 v145, s56
    v_mov_b32 v146, s56
    v_mov_b32 v147, s56
    s_mov_b64 exec, 0xff
    buffer_store_dwordx4 v[144:147], v1, s[8:11], s55 offen sc1
    s_mov_b64 exec, -1
L_np1_v:
    s_waitcnt lgkmcnt(2)
    v_mfma_f32_32x32x16_bf16 v[96:111], v[36:39], a[52:55], v[96:111]
    ds_read_b128 v[32:35], v18 offset:16384
    v_mfma_f32_32x32x16_bf16 v[112:127], v[36:39], a[212:215], v[112:127]
    s_waitcnt lgkmcnt(2)
    v_mfma_f32_32x32x16_bf16 v[96:111], v[40:43], a[56:59], v[96:111]
    ds_read_b128 v[36:39], v19 offset:16384
    v_mfma_f32_32x32x16_bf16 v[112:127], v[40:43], a[216:219], v[112:127]
    s_waitcnt lgkmcnt(2)
    v_mfma_f32_32x32x16_bf16 v[96:111], v[44:47], a[60:63], v[96:111]
    ds_read_b128 v[40:43], v20 offset:16384
    v_mfma_f32_32x32x16_bf16 v[112:127], v[44:47], a[220:223], v[112:127]
    s_add_u32 s65, s53, 246272
    s_waitcnt lgkmcnt(2)
    v_mfma_f32_32x32x16_bf16 v[96:111], v[32:35], a[64:67], v[96:111]
    ds_read_b128 v[44:47], v21 offset:16384
    v_mfma_f32_32x32x16_bf16 v[112:127], v[32:35], a[224:227], v[112:127]
    s_add_u32 s66, s79, 114688
    s_mov_b32 m0, s66
    s_nop 0
    buffer_load_dwordx4 v26, s[48:51], s65 offen lds
    s_waitcnt lgkmcnt(2)
    v_mfma_f32_32x32x16_bf16 v[96:111], v[36:39], a[68:71], v[96:111]
    ds_read_b128 v[32:35], v22 offset:16384
    v_mfma_f32_32x32x16_bf16 v[112:127], v[36:39], a[228:231], v[112:127]
    s_add_u32 s66, s79, 115712
    s_mov_b32 m0, s66
    s_nop 0
    buffer_load_dwordx4 v27, s[48:51], s65 offen lds
    s_waitcnt lgkmcnt(2)
    v_mfma_f32_32x32x16_bf16 v[96:111], v[40:43], a[72:75], v[96:111]
    ds_read_b128 v[36:39], v23 offset:16384
    v_mfma_f32_32x32x16_bf16 v[112:127], v[40:43], a[232:235], v[112:127]
    s_add_u32 s66, s79, 116736
    s_mov_b32 m0, s66
    s_nop 0
    buffer_load_dwordx4 v28, s[48:51], s65 offen lds
    s_waitcnt lgkmcnt(2)
    v_mfma_f32_32x32x16_bf16 v[96:111], v[44:47], a[76:79], v[96:111]
    ds_read_b128 v[40:43], v24 offset:16384
    v_mfma_f32_32x32x16_bf16 v[112:127], v[44:47], a[236:239], v[112:127]
    s_add_u32 s66, s79, 117760
    s_mov_b32 m0, s66
    s_nop 0
    buffer_load_dwordx4 v29, s[48:51], s65 offen lds
    s_waitcnt lgkmcnt(2)
    v_mfma_f32_32x32x16_bf16 v[96:111], v[32:35], a[80:83], v[96:111]
    ds_read_b128 v[44:47], v25 offset:16384
    v_mfma_f32_32x32x16_bf16 v[112:127], v[32:35], a[240:243], v[112:127]
    s_waitcnt vmcnt(28)
    s_barrier
    s_waitcnt lgkmcnt(2)
    v_mfma_f32_32x32x16_bf16 v[96:111], v[36:39], a[84:87], v[96:111]
    ds_read_b128 v[32:35], v2 offset:0
    v_mfma_f32_32x32x16_bf16 v[112:127], v[36:39], a[244:247], v[112:127]
    s_waitcnt lgkmcnt(2)
    v_mfma_f32_32x32x16_bf16 v[96:111], v[40:43], a[88:91], v[96:111]
    ds_read_b128 v[36:39], v3 offset:0
    v_mfma_f32_32x32x16_bf16 v[112:127], v[40:43], a[248:251], v[112:127]
    s_waitcnt lgkmcnt(2)
    v_mfma_f32_32x32x16_bf16 v[96:111], v[44:47], a[92:95], v[96:111]
    ds_read_b128 v[40:43], v4 offset:0
    v_mfma_f32_32x32x16_bf16 v[112:127], v[44:47], a[252:255], v[112:127]
    s_add_u32 s52, s52, 2
    s_add_u32 s53, s53, 163840
    s_cmp_lt_u32 s52, 32
    s_cbranch_scc1 L_g1_v
    s_waitcnt lgkmcnt(0)
    s_nop 4
    v_cvt_pk_bf16_f32 v48, v96, v97
    v_cvt_pk_bf16_f32 v49, v98, v99
    v_cvt_pk_bf16_f32 v50, v100, v101
    v_cvt_pk_bf16_f32 v51, v102, v103
    buffer_store_dwordx4 v[48:51], v136, s[8:11], s54 offen offset:0 sc1
    v_cvt_pk_bf16_f32 v52, v104, v105
    v_cvt_pk_bf16_f32 v53, v106, v107
    v_cvt_pk_bf16_f32 v54, v108, v109
    v_cvt_pk_bf16_f32 v55, v110, v111
    buffer_store_dwordx4 v[52:55], v136, s[8:11], s54 offen offset:1024 sc1
    v_cvt_pk_bf16_f32 v56, v112, v113
    v_cvt_pk_bf16_f32 v57, v114, v115
    v_cvt_pk_bf16_f32 v58, v116, v117
    v_cvt_pk_bf16_f32 v59, v118, v119
    buffer_store_dwordx4 v[56:59], v136, s[8:11], s54 offen offset:2048 sc1
    v_cvt_pk_bf16_f32 v60, v120, v121
    v_cvt_pk_bf16_f32 v61, v122, v123
    v_cvt_pk_bf16_f32 v62, v124, v125
    v_cvt_pk_bf16_f32 v63, v126, v127
    buffer_store_dwordx4 v[60:63], v136, s[8:11], s54 offen offset:3072 sc1
    s_waitcnt vmcnt(0)
    s_barrier
    s_cmp_lg_u32 s4, 0
    s_cbranch_scc1 L_g1end_v
    v_mov_b32 v144, 64
    v_mov_b32 v145, 64
    v_mov_b32 v146, 64
    v_mov_b32 v147, 64
    s_mov_b64 exec, 0xff
    buffer_store_dwordx4 v[144:147], v1, s[8:11], s55 offen sc1
    s_mov_b64 exec, -1
L_g1end_v:
    s_branch L_g1_done
L_g1role_k:
    v_lshrrev_b32 v128, 4, v0
    v_mul_u32_u24 v128, 8192, v128
    v_and_b32 v129, 15, v0
    v_lshl_add_u32 v128, v129, 4, v128
    v_add_u32 v131, s78, v128
    s_mul_i32 s76, s4, 131072
    s_lshl_b32 s77, s4, 12
    s_add_u32 s65, s76, 0
    s_add_u32 s66, s77, 0
    s_mov_b32 m0, s66
    s_nop 0
    buffer_load_dwordx4 v131, s[12:15], s65 offen lds
    s_add_u32 s65, s76, 32768
    s_add_u32 s66, s77, 1024
    s_mov_b32 m0, s66
    s_nop 0
    buffer_load_dwordx4 v131, s[12:15], s65 offen lds
    s_add_u32 s65, s76, 65536
    s_add_u32 s66, s77, 2048
    s_mov_b32 m0, s66
    s_nop 0
    buffer_load_dwordx4 v131, s[12:15], s65 offen lds
    s_add_u32 s65, s76, 98304
    s_add_u32 s66, s77, 3072
    s_mov_b32 m0, s66
    s_nop 0
    buffer_load_dwordx4 v131, s[12:15], s65 offen lds
    s_add_u32 s65, s76, 524288
    s_add_u32 s66, s77, 16384
    s_mov_b32 m0, s66
    s_nop 0
    buffer_load_dwordx4 v131, s[12:15], s65 offen lds
    s_add_u32 s65, s76, 557056
    s_add_u32 s66, s77, 17408
    s_mov_b32 m0, s66
    s_nop 0
    buffer_load_dwordx4 v131, s[12:15], s65 offen lds
    s_add_u32 s65, s76, 589824
    s_add_u32 s66, s77, 18432
    s_mov_b32 m0, s66
    s_nop 0
    buffer_load_dwordx4 v131, s[12:15], s65 offen lds
    s_add_u32 s65, s76, 622592
    s_add_u32 s66, s77, 19456
    s_mov_b32 m0, s66
    s_nop 0
    buffer_load_dwordx4 v131, s[12:15], s65 offen lds
    s_add_u32 s65, s76, 1048576
    s_add_u32 s66, s77, 32768
    s_mov_b32 m0, s66
    s_nop 0
    buffer_load_dwordx4 v131, s[12:15], s65 offen lds
    s_add_u32 s65, s76, 1081344
    s_add_u32 s66, s77, 33792
    s_mov_b32 m0, s66
    s_nop 0
    buffer_load_dwordx4 v131, s[12:15], s65 offen lds
    s_add_u32 s65, s76, 1114112
    s_add_u32 s66, s77, 34816
    s_mov_b32 m0, s66
    s_nop 0
    buffer_load_dwordx4 v131, s[12:15], s65 offen lds
    s_add_u32 s65, s76, 1146880
    s_add_u32 s66, s77, 35840
    s_mov_b32 m0, s66
    s_nop 0
    buffer_load_dwordx4 v131, s[12:15], s65 offen lds
    s_add_u32 s65, s76, 1572864
    s_add_u32 s66, s77, 49152
    s_mov_b32 m0, s66
    s_nop 0
    buffer_load_dwordx4 v131, s[12:15], s65 offen lds
    s_add_u32 s65, s76, 1605632
    s_add_u32 s66, s77, 50176
    s_mov_b32 m0, s66
    s_nop 0
    buffer_load_dwordx4 v131, s[12:15], s65 offen lds
    s_add_u32 s65, s76, 1638400
    s_add_u32 s66, s77, 51200
    s_mov_b32 m0, s66
    s_nop 0
    buffer_load_dwordx4 v131, s[12:15], s65 offen lds
    s_add_u32 s65, s76, 1671168
    s_add_u32 s66, s77, 52224
    s_mov_b32 m0, s66
    s_nop 0
    buffer_load_dwordx4 v131, s[12:15], s65 offen lds
    s_add_u32 s65, s76, 2097152
    s_add_u32 s66, s77, 65536
    s_mov_b32 m0, s66
    s_nop 0
    buffer_load_dwordx4 v131, s[12:15], s65 offen lds
    s_add_u32 s65, s76, 2129920
    s_add_u32 s66, s77, 66560
    s_mov_b32 m0, s66
    s_nop 0
    buffer_load_dwordx4 v131, s[12:15], s65 offen lds
    s_add_u32 s65, s76, 2162688
    s_add_u32 s66, s77, 67584
    s_mov_b32 m0, s66
    s_nop 0
    buffer_load_dwordx4 v131, s[12:15], s65 offen lds
    s_add_u32 s65, s76, 2195456
    s_add_u32 s66, s77, 68608
    s_mov_b32 m0, s66
    s_nop 0
    buffer_load_dwordx4 v131, s[12:15], s65 offen lds
    s_add_u32 s65, s76, 2621440
    s_add_u32 s66, s77, 81920
    s_mov_b32 m0, s66
    s_nop 0
    buffer_load_dwordx4 v131, s[12:15], s65 offen lds
    s_add_u32 s65, s76, 2654208
    s_add_u32 s66, s77, 82944
    s_mov_b32 m0, s66
    s_nop 0
    buffer_load_dwordx4 v131, s[12:15], s65 offen lds
    s_add_u32 s65, s76, 2686976
    s_add_u32 s66, s77, 83968
    s_mov_b32 m0, s66
    s_nop 0
    buffer_load_dwordx4 v131, s[12:15], s65 offen lds
    s_add_u32 s65, s76, 2719744
    s_add_u32 s66, s77, 84992
    s_mov_b32 m0, s66
    s_nop 0
    buffer_load_dwordx4 v131, s[12:15], s65 offen lds
    s_add_u32 s65, s76, 3145728
    s_add_u32 s66, s77, 98304
    s_mov_b32 m0, s66
    s_nop 0
    buffer_load_dwordx4 v131, s[12:15], s65 offen lds
    s_add_u32 s65, s76, 3178496
    s_add_u32 s66, s77, 99328
    s_mov_b32 m0, s66
    s_nop 0
    buffer_load_dwordx4 v131, s[12:15], s65 offen lds
    s_add_u32 s65, s76, 3211264
    s_add_u32 s66, s77, 100352
    s_mov_b32 m0, s66
    s_nop 0
    buffer_load_dwordx4 v131, s[12:15], s65 offen lds
    s_add_u32 s65, s76, 3244032
    s_add_u32 s66, s77, 101376
    s_mov_b32 m0, s66
    s_nop 0
    buffer_load_dwordx4 v131, s[12:15], s65 offen lds
    s_add_u32 s65, s76, 3670016
    s_add_u32 s66, s77, 114688
    s_mov_b32 m0, s66
    s_nop 0
    buffer_load_dwordx4 v131, s[12:15], s65 offen lds
    s_add_u32 s65, s76, 3702784
    s_add_u32 s66, s77, 115712
    s_mov_b32 m0, s66
    s_nop 0
    buffer_load_dwordx4 v131, s[12:15], s65 offen lds
    s_add_u32 s65, s76, 3735552
    s_add_u32 s66, s77, 116736
    s_mov_b32 m0, s66
    s_nop 0
    buffer_load_dwordx4 v131, s[12:15], s65 offen lds
    s_add_u32 s65, s76, 3768320
    s_add_u32 s66, s77, 117760
    s_mov_b32 m0, s66
    s_nop 0
    buffer_load_dwordx4 v131, s[12:15], s65 offen lds
    s_add_u32 s65, s76, 4194304
    s_add_u32 s66, s77, 131072
    s_mov_b32 m0, s66
    s_nop 0
    buffer_load_dwordx4 v131, s[12:15], s65 offen lds
    s_add_u32 s65, s76, 4227072
    s_add_u32 s66, s77, 132096
    s_mov_b32 m0, s66
    s_nop 0
    buffer_load_dwordx4 v131, s[12:15], s65 offen lds
    s_add_u32 s65, s76, 4259840
    s_add_u32 s66, s77, 133120
    s_mov_b32 m0, s66
    s_nop 0
    buffer_load_dwordx4 v131, s[12:15], s65 offen lds
    s_add_u32 s65, s76, 4292608
    s_add_u32 s66, s77, 134144
    s_mov_b32 m0, s66
    s_nop 0
    buffer_load_dwordx4 v131, s[12:15], s65 offen lds
    s_add_u32 s65, s76, 4718592
    s_add_u32 s66, s77, 147456
    s_mov_b32 m0, s66
    s_nop 0
    buffer_load_dwordx4 v131, s[12:15], s65 offen lds
    s_add_u32 s65, s76, 4751360
    s_add_u32 s66, s77, 148480
    s_mov_b32 m0, s66
    s_nop 0
    buffer_load_dwordx4 v131, s[12:15], s65 offen lds
    s_add_u32 s65, s76, 4784128
    s_add_u32 s66, s77, 149504
    s_mov_b32 m0, s66
    s_nop 0
    buffer_load_dwordx4 v131, s[12:15], s65 offen lds
    s_add_u32 s65, s76, 4816896
    s_add_u32 s66, s77, 150528
    s_mov_b32 m0, s66
    s_nop 0
    buffer_load_dwordx4 v131, s[12:15], s65 offen lds
    v_lshrrev_b32 v128, 5, v0
    v_lshlrev_b32 v128, 3, v128
    v_bfe_u32 v129, v0, 2, 2
    v_add_u32 v128, v128, v129
    v_lshlrev_b32 v128, 8, v128
    v_bfe_u32 v129, v0, 4, 1
    v_lshl_add_u32 v128, v129, 5, v128
    v_and_b32 v129, 1, v0
    v_lshl_add_u32 v128, v129, 4, v128
    v_bfe_u32 v129, v0, 1, 1
    v_lshl_add_u32 v128, v129, 3, v128
    s_and_b32 s65, s4, 1
    s_lshl_b32 s65, s65, 7
    v_add_u32 v132, s65, v128
    v_add_u32 v133, 0x10000, v132
    v_add_u32 v134, 0x20000, v132
    s_waitcnt vmcnt(36)
    s_barrier
    ds_read_b64_tr_b16 v[192:193], v132 offset:0
    ds_read_b64_tr_b16 v[194:195], v132 offset:1024
    ds_read_b64_tr_b16 a[96:97], v132 offset:64
    ds_read_b64_tr_b16 a[98:99], v132 offset:1088
    ds_read_b64_tr_b16 v[196:197], v132 offset:4096
    ds_read_b64_tr_b16 v[198:199], v132 offset:5120
    ds_read_b64_tr_b16 a[100:101], v132 offset:4160
    ds_read_b64_tr_b16 a[102:103], v132 offset:5184
    ds_read_b64_tr_b16 v[200:201], v132 offset:8192
    ds_read_b64_tr_b16 v[202:203], v132 offset:9216
    ds_read_b64_tr_b16 a[104:105], v132 offset:8256
    ds_read_b64_tr_b16 a[106:107], v132 offset:9280
    ds_read_b64_tr_b16 v[204:205], v132 offset:12288
    ds_read_b64_tr_b16 v[206:207], v132 offset:13312
    ds_read_b64_tr_b16 a[108:109], v132 offset:12352
    ds_read_b64_tr_b16 a[110:111], v132 offset:13376
    s_waitcnt vmcnt(32)
    s_barrier
    ds_read_b64_tr_b16 v[208:209], v132 offset:16384
    ds_read_b64_tr_b16 v[210:211], v132 offset:17408
    ds_read_b64_tr_b16 a[112:113], v132 offset:16448
    ds_read_b64_tr_b16 a[114:115], v132 offset:17472
    ds_read_b64_tr_b16 v[212:213], v132 offset:20480
    ds_read_b64_tr_b16 v[214:215], v132 offset:21504
    ds_read_b64_tr_b16 a[116:117], v132 offset:20544
    ds_read_b64_tr_b16 a[118:119], v132 offset:21568
    ds_read_b64_tr_b16 v[216:217], v132 offset:24576
    ds_read_b64_tr_b16 v[218:219], v132 offset:25600
    ds_read_b64_tr_b16 a[120:121], v132 offset:24640
    ds_read_b64_tr_b16 a[122:123], v132 offset:25664
    ds_read_b64_tr_b16 v[220:221], v132 offset:28672
    ds_read_b64_tr_b16 v[222:223], v132 offset:29696
    ds_read_b64_tr_b16 a[124:125], v132 offset:28736
    ds_read_b64_tr_b16 a[126:127], v132 offset:29760
    s_waitcnt lgkmcnt(0)
    s_waitcnt vmcnt(28)
    s_barrier
    ds_read_b64_tr_b16 v[224:225], v132 offset:32768
    ds_read_b64_tr_b16 v[226:227], v132 offset:33792
    ds_read_b64_tr_b16 a[128:129], v132 offset:32832
    ds_read_b64_tr_b16 a[130:131], v132 offset:33856
    ds_read_b64_tr_b16 v[228:229], v132 offset:36864
    ds_read_b64_tr_b16 v[230:231], v132 offset:37888
    ds_read_b64_tr_b16 a[132:133], v132 offset:36928
    ds_read_b64_tr_b16 a[134:135], v132 offset:37952
    ds_read_b64_tr_b16 v[232:233], v132 offset:40960
    ds_read_b64_tr_b16 v[234:235], v132 offset:41984
    ds_read_b64_tr_b16 a[136:137], v132 offset:41024
    ds_read_b64_tr_b16 a[138:139], v132 offset:42048
    ds_read_b64_tr_b16 v[236:237], v132 offset:45056
    ds_read_b64_tr_b16 v[238:239], v132 offset:46080
    ds_read_b64_tr_b16 a[140:141], v132 offset:45120
    ds_read_b64_tr_b16 a[142:143], v132 offset:46144
    s_waitcnt vmcnt(24)
    s_barrier
    ds_read_b64_tr_b16 v[240:241], v132 offset:49152
    ds_read_b64_tr_b16 v[242:243], v132 offset:50176
    ds_read_b64_tr_b16 a[144:145], v132 offset:49216
    ds_read_b64_tr_b16 a[146:147], v132 offset:50240
    ds_read_b64_tr_b16 v[244:245], v132 offset:53248
    ds_read_b64_tr_b16 v[246:247], v132 offset:54272
    ds_read_b64_tr_b16 a[148:149], v132 offset:53312
    ds_read_b64_tr_b16 a[150:151], v132 offset:54336
    ds_read_b64_tr_b16 v[248:249], v132 offset:57344
    ds_read_b64_tr_b16 v[250:251], v132 offset:58368
    ds_read_b64_tr_b16 a[152:153], v132 offset:57408
    ds_read_b64_tr_b16 a[154:155], v132 offset:58432
    ds_read_b64_tr_b16 v[252:253], v132 offset:61440
    ds_read_b64_tr_b16 v[254:255], v132 offset:62464
    ds_read_b64_tr_b16 a[156:157], v132 offset:61504
    ds_read_b64_tr_b16 a[158:159], v132 offset:62528
    s_waitcnt lgkmcnt(0)
    s_waitcnt vmcnt(20)
    s_barrier
    ds_read_b64_tr_b16 a[0:1], v133 offset:0
    ds_read_b64_tr_b16 a[2:3], v133 offset:1024
    ds_read_b64_tr_b16 a[160:161], v133 offset:64
    ds_read_b64_tr_b16 a[162:163], v133 offset:1088
    ds_read_b64_tr_b16 a[4:5], v133 offset:4096
    ds_read_b64_tr_b16 a[6:7], v133 offset:5120
    ds_read_b64_tr_b16 a[164:165], v133 offset:4160
    ds_read_b64_tr_b16 a[166:167], v133 offset:5184
    ds_read_b64_tr_b16 a[8:9], v133 offset:8192
    ds_read_b64_tr_b16 a[10:11], v133 offset:9216
    ds_read_b64_tr_b16 a[168:169], v133 offset:8256
    ds_read_b64_tr_b16 a[170:171], v133 offset:9280
    ds_read_b64_tr_b16 a[12:13], v133 offset:12288
    ds_read_b64_tr_b16 a[14:15], v133 offset:13312
    ds_read_b64_tr_b16 a[172:173], v133 offset:12352
    ds_read_b64_tr_b16 a[174:175], v133 offset:13376
    s_waitcnt vmcnt(16)
    s_barrier
    ds_read_b64_tr_b16 a[16:17], v133 offset:16384
    ds_read_b64_tr_b16 a[18:19], v133 offset:17408
    ds_read_b64_tr_b16 a[176:177], v133 offset:16448
    ds_read_b64_tr_b16 a[178:179], v133 offset:17472
    ds_read_b64_tr_b16 a[20:21], v133 offset:20480
    ds_read_b64_tr_b16 a[22:23], v133 offset:21504
    ds_read_b64_tr_b16 a[180:181], v133 offset:20544
    ds_read_b64_tr_b16 a[182:183], v133 offset:21568
    ds_read_b64_tr_b16 a[24:25], v133 offset:24576
    ds_read_b64_tr_b16 a[26:27], v133 offset:25600
    ds_read_b64_tr_b16 a[184:185], v133 offset:24640
    ds_read_b64_tr_b16 a[186:187], v133 offset:25664
    ds_read_b64_tr_b16 a[28:29], v133 offset:28672
    ds_read_b64_tr_b16 a[30:31], v133 offset:29696
    ds_read_b64_tr_b16 a[188:189], v133 offset:28736
    ds_read_b64_tr_b16 a[190:191], v133 offset:29760
    s_waitcnt lgkmcnt(0)
    s_waitcnt vmcnt(12)
    s_barrier
    ds_read_b64_tr_b16 a[32:33], v133 offset:32768
    ds_read_b64_tr_b16 a[34:35], v133 offset:33792
    ds_read_b64_tr_b16 a[192:193], v133 offset:32832
    ds_read_b64_tr_b16 a[194:195], v133 offset:33856
    ds_read_b64_tr_b16 a[36:37], v133 offset:36864
    ds_read_b64_tr_b16 a[38:39], v133 offset:37888
    ds_read_b64_tr_b16 a[196:197], v133 offset:36928
    ds_read_b64_tr_b16 a[198:199], v133 offset:37952
    ds_read_b64_tr_b16 a[40:41], v133 offset:40960
    ds_read_b64_tr_b16 a[42:43], v133 offset:41984
    ds_read_b64_tr_b16 a[200:201], v133 offset:41024
    ds_read_b64_tr_b16 a[202:203], v133 offset:42048
    ds_read_b64_tr_b16 a[44:45], v133 offset:45056
    ds_read_b64_tr_b16 a[46:47], v133 offset:46080
    ds_read_b64_tr_b16 a[204:205], v133 offset:45120
    ds_read_b64_tr_b16 a[206:207], v133 offset:46144
    s_waitcnt vmcnt(8)
    s_barrier
    ds_read_b64_tr_b16 a[48:49], v133 offset:49152
    ds_read_b64_tr_b16 a[50:51], v133 offset:50176
    ds_read_b64_tr_b16 a[208:209], v133 offset:49216
    ds_read_b64_tr_b16 a[210:211], v133 offset:50240
    ds_read_b64_tr_b16 a[52:53], v133 offset:53248
    ds_read_b64_tr_b16 a[54:55], v133 offset:54272
    ds_read_b64_tr_b16 a[212:213], v133 offset:53312
    ds_read_b64_tr_b16 a[214:215], v133 offset:54336
    ds_read_b64_tr_b16 a[56:57], v133 offset:57344
    ds_read_b64_tr_b16 a[58:59], v133 offset:58368
    ds_read_b64_tr_b16 a[216:217], v133 offset:57408
    ds_read_b64_tr_b16 a[218:219], v133 offset:58432
    ds_read_b64_tr_b16 a[60:61], v133 offset:61440
    ds_read_b64_tr_b16 a[62:63], v133 offset:62464
    ds_read_b64_tr_b16 a[220:221], v133 offset:61504
    ds_read_b64_tr_b16 a[222:223], v133 offset:62528
    s_waitcnt lgkmcnt(0)
    s_waitcnt vmcnt(4)
    s_barrier
    ds_read_b64_tr_b16 a[64:65], v134 offset:0
    ds_read_b64_tr_b16 a[66:67], v134 offset:1024
    ds_read_b64_tr_b16 a[224:225], v134 offset:64
    ds_read_b64_tr_b16 a[226:227], v134 offset:1088
    ds_read_b64_tr_b16 a[68:69], v134 offset:4096
    ds_read_b64_tr_b16 a[70:71], v134 offset:5120
    ds_read_b64_tr_b16 a[228:229], v134 offset:4160
    ds_read_b64_tr_b16 a[230:231], v134 offset:5184
    ds_read_b64_tr_b16 a[72:73], v134 offset:8192
    ds_read_b64_tr_b16 a[74:75], v134 offset:9216
    ds_read_b64_tr_b16 a[232:233], v134 offset:8256
    ds_read_b64_tr_b16 a[234:235], v134 offset:9280
    ds_read_b64_tr_b16 a[76:77], v134 offset:12288
    ds_read_b64_tr_b16 a[78:79], v134 offset:13312
    ds_read_b64_tr_b16 a[236:237], v134 offset:12352
    ds_read_b64_tr_b16 a[238:239], v134 offset:13376
    s_waitcnt vmcnt(0)
    s_barrier
    ds_read_b64_tr_b16 a[80:81], v134 offset:16384
    ds_read_b64_tr_b16 a[82:83], v134 offset:17408
    ds_read_b64_tr_b16 a[240:241], v134 offset:16448
    ds_read_b64_tr_b16 a[242:243], v134 offset:17472
    ds_read_b64_tr_b16 a[84:85], v134 offset:20480
    ds_read_b64_tr_b16 a[86:87], v134 offset:21504
    ds_read_b64_tr_b16 a[244:245], v134 offset:20544
    ds_read_b64_tr_b16 a[246:247], v134 offset:21568
    ds_read_b64_tr_b16 a[88:89], v134 offset:24576
    ds_read_b64_tr_b16 a[90:91], v134 offset:25600
    ds_read_b64_tr_b16 a[248:249], v134 offset:24640
    ds_read_b64_tr_b16 a[250:251], v134 offset:25664
    ds_read_b64_tr_b16 a[92:93], v134 offset:28672
    ds_read_b64_tr_b16 a[94:95], v134 offset:29696
    ds_read_b64_tr_b16 a[252:253], v134 offset:28736
    ds_read_b64_tr_b16 a[254:255], v134 offset:29760
    s_waitcnt lgkmcnt(0)
    s_waitcnt lgkmcnt(0)
    s_barrier
    v_lshrrev_b32 v128, 4, v0
    v_add_u32 v128, 0, v128
    v_and_b32 v129, 15, v0
    v_xor_b32 v129, v129, v128
    v_mul_u32_u24 v128, 1280, v128
    v_lshl_add_u32 v26, v129, 4, v128
    v_lshrrev_b32 v128, 4, v0
    v_add_u32 v128, 4, v128
    v_and_b32 v129, 15, v0
    v_xor_b32 v129, v129, v128
    v_mul_u32_u24 v128, 1280, v128
    v_lshl_add_u32 v27, v129, 4, v128
    v_lshrrev_b32 v128, 4, v0
    v_add_u32 v128, 8, v128
    v_and_b32 v129, 15, v0
    v_xor_b32 v129, v129, v128
    v_mul_u32_u24 v128, 1280, v128
    v_lshl_add_u32 v28, v129, 4, v128
    v_lshrrev_b32 v128, 4, v0
    v_add_u32 v128, 12, v128
    v_and_b32 v129, 15, v0
    v_xor_b32 v129, v129, v128
    v_mul_u32_u24 v128, 1280, v128
    v_lshl_add_u32 v29, v129, 4, v128
    v_and_b32 v128, 31, v0
    v_and_b32 v129, 15, v128
    v_lshrrev_b32 v130, 5, v0
    v_xor_b32 v129, v129, v130
    s_lshr_b32 s65, s4, 1
    s_lshl_b32 s65, s65, 13
    v_lshlrev_b32 v128, 8, v128
    v_add_u32 v128, s65, v128
    v_xor_b32 v130, 0, v129
    v_lshl_add_u32 v2, v130, 4, v128
    v_add_u32 v10, 0x10000, v2
    v_add_u32 v18, 0x20000, v2
    v_xor_b32 v130, 2, v129
    v_lshl_add_u32 v3, v130, 4, v128
    v_add_u32 v11, 0x10000, v3
    v_add_u32 v19, 0x20000, v3
    v_xor_b32 v130, 4, v129
    v_lshl_add_u32 v4, v130, 4, v128
    v_add_u32 v12, 0x10000, v4
    v_add_u32 v20, 0x20000, v4
    v_xor_b32 v130, 6, v129
    v_lshl_add_u32 v5, v130, 4, v128
    v_add_u32 v13, 0x10000, v5
    v_add_u32 v21, 0x20000, v5
    v_xor_b32 v130, 8, v129
    v_lshl_add_u32 v6, v130, 4, v128
    v_add_u32 v14, 0x10000, v6
    v_add_u32 v22, 0x20000, v6
    v_xor_b32 v130, 10, v129
    v_lshl_add_u32 v7, v130, 4, v128
    v_add_u32 v15, 0x10000, v7
    v_add_u32 v23, 0x20000, v7
    v_xor_b32 v130, 12, v129
    v_lshl_add_u32 v8, v130, 4, v128
    v_add_u32 v16, 0x10000, v8
    v_add_u32 v24, 0x20000, v8
    v_xor_b32 v130, 14, v129
    v_lshl_add_u32 v9, v130, 4, v128
    v_add_u32 v17, 0x10000, v9
    v_add_u32 v25, 0x20000, v9
    v_mov_b32 v136, 0x80000000
    s_lshl_b32 s79, s4, 12
    s_waitcnt vmcnt(0)
    s_mov_b32 s52, 0
    s_mov_b32 s57, 0
    s_add_u32 s65, s53, 0
    s_add_u32 s66, s79, 0
    s_mov_b32 m0, s66
    s_nop 0
    buffer_load_dwordx4 v26, s[48:51], s65 offen lds
    s_add_u32 s66, s79, 1024
    s_mov_b32 m0, s66
    s_nop 0
    buffer_load_dwordx4 v27, s[48:51], s65 offen lds
    s_add_u32 s66, s79, 2048
    s_mov_b32 m0, s66
    s_nop 0
    buffer_load_dwordx4 v28, s[48:51], s65 offen lds
    s_add_u32 s66, s79, 3072
    s_mov_b32 m0, s66
    s_nop 0
    buffer_load_dwordx4 v29, s[48:51], s65 offen lds
    s_add_u32 s65, s53, 256
    s_add_u32 s66, s79, 16384
    s_mov_b32 m0, s66
    s_nop 0
    buffer_load_dwordx4 v26, s[48:51], s65 offen lds
    s_add_u32 s66, s79, 17408
    s_mov_b32 m0, s66
    s_nop 0
    buffer_load_dwordx4 v27, s[48:51], s65 offen lds
    s_add_u32 s66, s79, 18432
    s_mov_b32 m0, s66
    s_nop 0
    buffer_load_dwordx4 v28, s[48:51], s65 offen lds
    s_add_u32 s66, s79, 19456
    s_mov_b32 m0, s66
    s_nop 0
    buffer_load_dwordx4 v29, s[48:51], s65 offen lds
    s_add_u32 s65, s53, 512
    s_add_u32 s66, s79, 32768
    s_mov_b32 m0, s66
    s_nop 0
    buffer_load_dwordx4 v26, s[48:51], s65 offen lds
    s_add_u32 s66, s79, 33792
    s_mov_b32 m0, s66
    s_nop 0
    buffer_load_dwordx4 v27, s[48:51], s65 offen lds
    s_add_u32 s66, s79, 34816
    s_mov_b32 m0, s66
    s_nop 0
    buffer_load_dwordx4 v28, s[48:51], s65 offen lds
    s_add_u32 s66, s79, 35840
    s_mov_b32 m0, s66
    s_nop 0
    buffer_load_dwordx4 v29, s[48:51], s65 offen lds
    s_add_u32 s65, s53, 768
    s_add_u32 s66, s79, 49152
    s_mov_b32 m0, s66
    s_nop 0
    buffer_load_dwordx4 v26, s[48:51], s65 offen lds
    s_add_u32 s66, s79, 50176
    s_mov_b32 m0, s66
    s_nop 0
    buffer_load_dwordx4 v27, s[48:51], s65 offen lds
    s_add_u32 s66, s79, 51200
    s_mov_b32 m0, s66
    s_nop 0
    buffer_load_dwordx4 v28, s[48:51], s65 offen lds
    s_add_u32 s66, s79, 52224
    s_mov_b32 m0, s66
    s_nop 0
    buffer_load_dwordx4 v29, s[48:51], s65 offen lds
    s_add_u32 s65, s53, 1024
    s_add_u32 s66, s79, 65536
    s_mov_b32 m0, s66
    s_nop 0
    buffer_load_dwordx4 v26, s[48:51], s65 offen lds
    s_add_u32 s66, s79, 66560
    s_mov_b32 m0, s66
    s_nop 0
    buffer_load_dwordx4 v27, s[48:51], s65 offen lds
    s_add_u32 s66, s79, 67584
    s_mov_b32 m0, s66
    s_nop 0
    buffer_load_dwordx4 v28, s[48:51], s65 offen lds
    s_add_u32 s66, s79, 68608
    s_mov_b32 m0, s66
    s_nop 0
    buffer_load_dwordx4 v29, s[48:51], s65 offen lds
    s_add_u32 s65, s53, 81920
    s_add_u32 s66, s79, 81920
    s_mov_b32 m0, s66
    s_nop 0
    buffer_load_dwordx4 v26, s[48:51], s65 offen lds
    s_add_u32 s66, s79, 82944
    s_mov_b32 m0, s66
    s_nop 0
    buffer_load_dwordx4 v27, s[48:51], s65 offen lds
    s_add_u32 s66, s79, 83968
    s_mov_b32 m0, s66
    s_nop 0
    buffer_load_dwordx4 v28, s[48:51], s65 offen lds
    s_add_u32 s66, s79, 84992
    s_mov_b32 m0, s66
    s_nop 0
    buffer_load_dwordx4 v29, s[48:51], s65 offen lds
    s_add_u32 s65, s53, 82176
    s_add_u32 s66, s79, 98304
    s_mov_b32 m0, s66
    s_nop 0
    buffer_load_dwordx4 v26, s[48:51], s65 offen lds
    s_add_u32 s66, s79, 99328
    s_mov_b32 m0, s66
    s_nop 0
    buffer_load_dwordx4 v27, s[48:51], s65 offen lds
    s_add_u32 s66, s79, 100352
    s_mov_b32 m0, s66
    s_nop 0
    buffer_load_dwordx4 v28, s[48:51], s65 offen lds
    s_add_u32 s66, s79, 101376
    s_mov_b32 m0, s66
    s_nop 0
    buffer_load_dwordx4 v29, s[48:51], s65 offen lds
    s_add_u32 s65, s53, 82432
    s_add_u32 s66, s79, 114688
    s_mov_b32 m0, s66
    s_nop 0
    buffer_load_dwordx4 v26, s[48:51], s65 offen lds
    s_add_u32 s66, s79, 115712
    s_mov_b32 m0, s66
    s_nop 0
    buffer_load_dwordx4 v27, s[48:51], s65 offen lds
    s_add_u32 s66, s79, 116736
    s_mov_b32 m0, s66
    s_nop 0
    buffer_load_dwordx4 v28, s[48:51], s65 offen lds
    s_add_u32 s66, s79, 117760
    s_mov_b32 m0, s66
    s_nop 0
    buffer_load_dwordx4 v29, s[48:51], s65 offen lds
    s_waitcnt vmcnt(28)
    s_barrier
    ds_read_b128 v[32:35], v2 offset:0
    ds_read_b128 v[36:39], v3 offset:0
    ds_read_b128 v[40:43], v4 offset:0
L_g1_k:
    s_add_u32 s65, s53, 82688
    s_waitcnt lgkmcnt(2)
    v_mfma_f32_32x32x16_bf16 v[64:79], v[192:195], v[32:35], 0
    ds_read_b128 v[44:47], v5 offset:0
    v_mfma_f32_32x32x16_bf16 v[80:95], a[96:99], v[32:35], 0
    s_add_u32 s66, s79, 131072
    s_mov_b32 m0, s66
    s_nop 0
    buffer_load_dwordx4 v26, s[48:51], s65 offen lds
    s_waitcnt lgkmcnt(2)
    v_mfma_f32_32x32x16_bf16 v[64:79], v[196:199], v[36:39], v[64:79]
    ds_read_b128 v[32:35], v6 offset:0
    v_cvt_pk_bf16_f32 v48, v96, v97
    v_cvt_pk_bf16_f32 v49, v98, v99
    v_mfma_f32_32x32x16_bf16 v[80:95], a[100:103], v[36:39], v[80:95]
    s_add_u32 s66, s79, 132096
    s_mov_b32 m0, s66
    s_nop 0
    buffer_load_dwordx4 v27, s[48:51], s65 offen lds
    v_cvt_pk_bf16_f32 v50, v100, v101
    v_cvt_pk_bf16_f32 v51, v102, v103
    s_waitcnt lgkmcnt(2)
    v_mfma_f32_32x32x16_bf16 v[64:79], v[200:203], v[40:43], v[64:79]
    ds_read_b128 v[36:39], v7 offset:0
    buffer_store_dwordx4 v[48:51], v136, s[8:11], s54 offen offset:0 sc1
    v_cvt_pk_bf16_f32 v52, v104, v105
    v_mfma_f32_32x32x16_bf16 v[80:95], a[104:107], v[40:43], v[80:95]
    s_add_u32 s66, s79, 133120
    s_mov_b32 m0, s66
    s_nop 0
    buffer_load_dwordx4 v28, s[48:51], s65 offen lds
    v_cvt_pk_bf16_f32 v53, v106, v107
    v_cvt_pk_bf16_f32 v54, v108, v109
    s_waitcnt lgkmcnt(2)
    v_mfma_f32_32x32x16_bf16 v[64:79], v[204:207], v[44:47], v[64:79]
    ds_read_b128 v[40:43], v8 offset:0
    v_cvt_pk_bf16_f32 v55, v110, v111
    buffer_store_dwordx4 v[52:55], v136, s[8:11], s54 offen offset:1024 sc1
    v_mfma_f32_32x32x16_bf16 v[80:95], a[108:111], v[44:47], v[80:95]
    s_add_u32 s66, s79, 134144
    s_mov_b32 m0, s66
    s_nop 0
    buffer_load_dwordx4 v29, s[48:51], s65 offen lds
    v_cvt_pk_bf16_f32 v56, v112, v113
    v_cvt_pk_bf16_f32 v57, v114, v115
    s_waitcnt lgkmcnt(2)
    v_mfma_f32_32x32x16_bf16 v[64:79], v[208:211], v[32:35], v[64:79]
    ds_read_b128 v[44:47], v9 offset:0
    v_cvt_pk_bf16_f32 v58, v116, v117
    v_cvt_pk_bf16_f32 v59, v118, v119
    v_mfma_f32_32x32x16_bf16 v[80:95], a[112:115], v[32:35], v[80:95]
    buffer_store_dwordx4 v[56:59], v136, s[8:11], s54 offen offset:2048 sc1
    v_cvt_pk_bf16_f32 v60, v120, v121
    s_waitcnt vmcnt(28)
    s_barrier
    s_waitcnt lgkmcnt(2)
    v_mfma_f32_32x32x16_bf16 v[64:79], v[212:215], v[36:39], v[64:79]
    ds_read_b128 v[32:35], v2 offset:16384
    v_cvt_pk_bf16_f32 v61, v122, v123
    v_cvt_pk_bf16_f32 v62, v124, v125
    v_mfma_f32_32x32x16_bf16 v[80:95], a[116:119], v[36:39], v[80:95]
    v_cvt_pk_bf16_f32 v63, v126, v127
    buffer_store_dwordx4 v[60:63], v136, s[8:11], s54 offen offset:3072 sc1
    s_waitcnt lgkmcnt(2)
    v_mfma_f32_32x32x16_bf16 v[64:79], v[216:219], v[40:43], v[64:79]
    ds_read_b128 v[36:39], v3 offset:16384
    v_mfma_f32_32x32x16_bf16 v[80:95], a[120:123], v[40:43], v[80:95]
    s_waitcnt lgkmcnt(2)
    v_mfma_f32_32x32x16_bf16 v[64:79], v[220:223], v[44:47], v[64:79]
    ds_read_b128 v[40:43], v4 offset:16384
    v_mfma_f32_32x32x16_bf16 v[80:95], a[124:127], v[44:47], v[80:95]
    s_add_u32 s54, s54, s57
    s_mov_b32 s57, 49152
    v_mov_b32 v136, v1
    s_add_u32 s65, s53, 82944
    s_waitcnt lgkmcnt(2)
    v_mfma_f32_32x32x16_bf16 v[64:79], v[224:227], v[32:35], v[64:79]
    ds_read_b128 v[44:47], v5 offset:16384
    v_mfma_f32_32x32x16_bf16 v[80:95], a[128:131], v[32:35], v[80:95]
    s_add_u32 s66, s79, 147456
    s_mov_b32 m0, s66
    s_nop 0
    buffer_load_dwordx4 v26, s[48:51], s65 offen lds
    s_waitcnt lgkmcnt(2)
    v_mfma_f32_32x32x16_bf16 v[64:79], v[228:231], v[36:39], v[64:79]
    ds_read_b128 v[32:35], v6 offset:16384
    v_mfma_f32_32x32x16_bf16 v[80:95], a[132:135], v[36:39], v[80:95]
    s_add_u32 s66, s79, 148480
    s_mov_b32 m0, s66
    s_nop 0
    buffer_load_dwordx4 v27, s[48:51], s65 offen lds
    s_waitcnt lgkmcnt(2)
    v_mfma_f32_32x32x16_bf16 v[64:79], v[232:235], v[40:43], v[64:79]
    ds_read_b128 v[36:39], v7 offset:16384
    v_mfma_f32_32x32x16_bf16 v[80:95], a[136:139], v[40:43], v[80:95]
    s_add_u32 s66, s79, 149504
    s_mov_b32 m0, s66
    s_nop 0
    buffer_load_dwordx4 v28, s[48:51], s65 offen lds
    s_waitcnt lgkmcnt(2)
    v_mfma_f32_32x32x16_bf16 v[64:79], v[236:239], v[44:47], v[64:79]
    ds_read_b128 v[40:43], v8 offset:16384
    v_mfma_f32_32x32x16_bf16 v[80:95], a[140:143], v[44:47], v[80:95]
    s_add_u32 s66, s79, 150528
    s_mov_b32 m0, s66
    s_nop 0
    buffer_load_dwordx4 v29, s[48:51], s65 offen lds
    s_waitcnt lgkmcnt(2)
    v_mfma_f32_32x32x16_bf16 v[64:79], v[240:243], v[32:35], v[64:79]
    ds_read_b128 v[44:47], v9 offset:16384
    v_mfma_f32_32x32x16_bf16 v[80:95], a[144:147], v[32:35], v[80:95]
    s_waitcnt vmcnt(28)
    s_barrier
    s_waitcnt lgkmcnt(2)
    v_mfma_f32_32x32x16_bf16 v[64:79], v[244:247], v[36:39], v[64:79]
    ds_read_b128 v[32:35], v2 offset:32768
    v_mfma_f32_32x32x16_bf16 v[80:95], a[148:151], v[36:39], v[80:95]
    s_waitcnt lgkmcnt(2)
    v_mfma_f32_32x32x16_bf16 v[64:79], v[248:251], v[40:43], v[64:79]
    ds_read_b128 v[36:39], v3 offset:32768
    v_mfma_f32_32x32x16_bf16 v[80:95], a[152:155], v[40:43], v[80:95]
    s_waitcnt lgkmcnt(2)
    v_mfma_f32_32x32x16_bf16 v[64:79], v[252:255], v[44:47], v[64:79]
    ds_read_b128 v[40:43], v4 offset:32768
    v_mfma_f32_32x32x16_bf16 v[80:95], a[156:159], v[44:47], v[80:95]
    s_add_u32 s65, s53, 163840
    s_waitcnt lgkmcnt(2)
    v_mfma_f32_32x32x16_bf16 v[64:79], a[0:3], v[32:35], v[64:79]
    ds_read_b128 v[44:47], v5 offset:32768
    v_mfma_f32_32x32x16_bf16 v[80:95], a[160:163], v[32:35], v[80:95]
    s_add_u32 s66, s79, 0
    s_mov_b32 m0, s66
    s_nop 0
    buffer_load_dwordx4 v26, s[48:51], s65 offen lds
    s_waitcnt lgkmcnt(2)
    v_mfma_f32_32x32x16_bf16 v[64:79], a[4:7], v[36:39], v[64:79]
    ds_read_b128 v[32:35], v6 offset:32768
    v_mfma_f32_32x32x16_bf16 v[80:95], a[164:167], v[36:39], v[80:95]
    s_add_u32 s66, s79, 1024
    s_mov_b32 m0, s66
    s_nop 0
    buffer_load_dwordx4 v27, s[48:51], s65 offen lds
    s_waitcnt lgkmcnt(2)
    v_mfma_f32_32x32x16_bf16 v[64:79], a[8:11], v[40:43], v[64:79]
    ds_read_b128 v[36:39], v7 offset:32768
    v_mfma_f32_32x32x16_bf16 v[80:95], a[168:171], v[40:43], v[80:95]
    s_add_u32 s66, s79, 2048
    s_mov_b32 m0, s66
    s_nop 0
    buffer_load_dwordx4 v28, s[48:51], s65 offen lds
    s_waitcnt lgkmcnt(2)
    v_mfma_f32_32x32x16_bf16 v[64:79], a[12:15], v[44:47], v[64:79]
    ds_read_b128 v[40:43], v8 offset:32768
    v_mfma_f32_32x32x16_bf16 v[80:95], a[172:175], v[44:47], v[80:95]
    s_add_u32 s66, s79, 3072
    s_mov_b32 m0, s66
    s_nop 0
    buffer_load_dwordx4 v29, s[48:51], s65 offen lds
    s_waitcnt lgkmcnt(2)
    v_mfma_f32_32x32x16_bf16 v[64:79], a[16:19], v[32:35], v[64:79]
    ds_read_b128 v[44:47], v9 offset:32768
    v_mfma_f32_32x32x16_bf16 v[80:95], a[176:179], v[32:35], v[80:95]
    s_waitcnt vmcnt(28)
    s_barrier
    s_waitcnt lgkmcnt(2)
    v_mfma_f32_32x32x16_bf16 v[64:79], a[20:23], v[36:39], v[64:79]
    ds_read_b128 v[32:35], v2 offset:49152
    v_mfma_f32_32x32x16_bf16 v[80:95], a[180:183], v[36:39], v[80:95]
    s_waitcnt lgkmcnt(2)
    v_mfma_f32_32x32x16_bf16 v[64:79], a[24:27], v[40:43], v[64:79]
    ds_read_b128 v[36:39], v3 offset:49152
    v_mfma_f32_32x32x16_bf16 v[80:95], a[184:187], v[40:43], v[80:95]
    s_waitcnt lgkmcnt(2)
    v_mfma_f32_32x32x16_bf16 v[64:79], a[28:31], v[44:47], v[64:79]
    ds_read_b128 v[40:43], v4 offset:49152
    v_mfma_f32_32x32x16_bf16 v[80:95], a[188:191], v[44:47], v[80:95]
    s_add_u32 s65, s53, 164096
    s_waitcnt lgkmcnt(2)
    v_mfma_f32_32x32x16_bf16 v[64:79], a[32:35], v[32:35], v[64:79]
    ds_read_b128 v[44:47], v5 offset:49152
    v_mfma_f32_32x32x16_bf16 v[80:95], a[192:195], v[32:35], v[80:95]
    s_add_u32 s66, s79, 16384
    s_mov_b32 m0, s66
    s_nop 0
    buffer_load_dwordx4 v26, s[48:51], s65 offen lds
    s_waitcnt lgkmcnt(2)
    v_mfma_f32_32x32x16_bf16 v[64:79], a[36:39], v[36:39], v[64:79]
    ds_read_b128 v[32:35], v6 offset:49152
    v_mfma_f32_32x32x16_bf16 v[80:95], a[196:199], v[36:39], v[80:95]
    s_add_u32 s66, s79, 17408
    s_mov_b32 m0, s66
    s_nop 0
    buffer_load_dwordx4 v27, s[48:51], s65 offen lds
    s_waitcnt lgkmcnt(2)
    v_mfma_f32_32x32x16_bf16 v[64:79], a[40:43], v[40:43], v[64:79]
    ds_read_b128 v[36:39], v7 offset:49152
    v_mfma_f32_32x32x16_bf16 v[80:95], a[200:203], v[40:43], v[80:95]
    s_add_u32 s66, s79, 18432
    s_mov_b32 m0, s66
    s_nop 0
    buffer_load_dwordx4 v28, s[48:51], s65 offen lds
    s_waitcnt lgkmcnt(2)
    v_mfma_f32_32x32x16_bf16 v[64:79], a[44:47], v[44:47], v[64:79]
    ds_read_b128 v[40:43], v8 offset:49152
    v_mfma_f32_32x32x16_bf16 v[80:95], a[204:207], v[44:47], v[80:95]
    s_add_u32 s66, s79, 19456
    s_mov_b32 m0, s66
    s_nop 0
    buffer_load_dwordx4 v29, s[48:51], s65 offen lds
    s_waitcnt lgkmcnt(2)
    v_mfma_f32_32x32x16_bf16 v[64:79], a[48:51], v[32:35], v[64:79]
    ds_read_b128 v[44:47], v9 offset:49152
    v_mfma_f32_32x32x16_bf16 v[80:95], a[208:211], v[32:35], v[80:95]
    s_waitcnt vmcnt(28)
    s_barrier
    s_cmp_lg_u32 s4, 0
    s_cbranch_scc1 L_np0_k
    s_add_u32 s56, s52, 0
    s_cmp_lt_u32 s56, 2
    s_cbranch_scc1 L_np0_k
    s_sub_u32 s56, s56, 1
    s_lshl_b32 s56, s56, 1
    v_mov_b32 v144, s56
    v_mov_b32 v145, s56
    v_mov_b32 v146, s56
    v_mov_b32 v147, s56
    s_mov_b64 exec, 0xff
    buffer_store_dwordx4 v[144:147], v1, s[8:11], s55 offen sc1
    s_mov_b64 exec, -1
L_np0_k:
    s_waitcnt lgkmcnt(2)
    v_mfma_f32_32x32x16_bf16 v[64:79], a[52:55], v[36:39], v[64:79]
    ds_read_b128 v[32:35], v10 offset:0
    v_mfma_f32_32x32x16_bf16 v[80:95], a[212:215], v[36:39], v[80:95]
    s_waitcnt lgkmcnt(2)
    v_mfma_f32_32x32x16_bf16 v[64:79], a[56:59], v[40:43], v[64:79]
    ds_read_b128 v[36:39], v11 offset:0
    v_mfma_f32_32x32x16_bf16 v[80:95], a[216:219], v[40:43], v[80:95]
    s_waitcnt lgkmcnt(2)
    v_mfma_f32_32x32x16_bf16 v[64:79], a[60:63], v[44:47], v[64:79]
    ds_read_b128 v[40:43], v12 offset:0
    v_mfma_f32_32x32x16_bf16 v[80:95], a[220:223], v[44:47], v[80:95]
    s_add_u32 s65, s53, 164352
    s_waitcnt lgkmcnt(2)
    v_mfma_f32_32x32x16_bf16 v[64:79], a[64:67], v[32:35], v[64:79]
    ds_read_b128 v[44:47], v13 offset:0
    v_mfma_f32_32x32x16_bf16 v[80:95], a[224:227], v[32:35], v[80:95]
    s_add_u32 s66, s79, 32768
    s_mov_b32 m0, s66
    s_nop 0
    buffer_load_dwordx4 v26, s[48:51], s65 offen lds
    s_waitcnt lgkmcnt(2)
    v_mfma_f32_32x32x16_bf16 v[64:79], a[68:71], v[36:39], v[64:79]
    ds_read_b128 v[32:35], v14 offset:0
    v_mfma_f32_32x32x16_bf16 v[80:95], a[228:231], v[36:39], v[80:95]
    s_add_u32 s66, s79, 33792
    s_mov_b32 m0, s66
    s_nop 0
    buffer_load_dwordx4 v27, s[48:51], s65 offen lds
    s_waitcnt lgkmcnt(2)
    v_mfma_f32_32x32x16_bf16 v[64:79], a[72:75], v[40:43], v[64:79]
    ds_read_b128 v[36:39], v15 offset:0
    v_mfma_f32_32x32x16_bf16 v[80:95], a[232:235], v[40:43], v[80:95]
    s_add_u32 s66, s79, 34816
    s_mov_b32 m0, s66
    s_nop 0
    buffer_load_dwordx4 v28, s[48:51], s65 offen lds
    s_waitcnt lgkmcnt(2)
    v_mfma_f32_32x32x16_bf16 v[64:79], a[76:79], v[44:47], v[64:79]
    ds_read_b128 v[40:43], v16 offset:0
    v_mfma_f32_32x32x16_bf16 v[80:95], a[236:239], v[44:47], v[80:95]
    s_add_u32 s66, s79, 35840
    s_mov_b32 m0, s66
    s_nop 0
    buffer_load_dwordx4 v29, s[48:51], s65 offen lds
    s_waitcnt lgkmcnt(2)
    v_mfma_f32_32x32x16_bf16 v[64:79], a[80:83], v[32:35], v[64:79]
    ds_read_b128 v[44:47], v17 offset:0
    v_mfma_f32_32x32x16_bf16 v[80:95], a[240:243], v[32:35], v[80:95]
    s_waitcnt vmcnt(28)
    s_barrier
    s_waitcnt lgkmcnt(2)
    v_mfma_f32_32x32x16_bf16 v[64:79], a[84:87], v[36:39], v[64:79]
    ds_read_b128 v[32:35], v10 offset:16384
    v_mfma_f32_32x32x16_bf16 v[80:95], a[244:247], v[36:39], v[80:95]
    s_waitcnt lgkmcnt(2)
    v_mfma_f32_32x32x16_bf16 v[64:79], a[88:91], v[40:43], v[64:79]
    ds_read_b128 v[36:39], v11 offset:16384
    v_mfma_f32_32x32x16_bf16 v[80:95], a[248:251], v[40:43], v[80:95]
    s_waitcnt lgkmcnt(2)
    v_mfma_f32_32x32x16_bf16 v[64:79], a[92:95], v[44:47], v[64:79]
    ds_read_b128 v[40:43], v12 offset:16384
    v_mfma_f32_32x32x16_bf16 v[80:95], a[252:255], v[44:47], v[80:95]
    s_add_u32 s65, s53, 164608
    s_waitcnt lgkmcnt(2)
    v_mfma_f32_32x32x16_bf16 v[96:111], v[192:195], v[32:35], 0
    ds_read_b128 v[44:47], v13 offset:16384
    v_mfma_f32_32x32x16_bf16 v[112:127], a[96:99], v[32:35], 0
    s_add_u32 s66, s79, 49152
    s_mov_b32 m0, s66
    s_nop 0
    buffer_load_dwordx4 v26, s[48:51], s65 offen lds
    s_waitcnt lgkmcnt(2)
    v_mfma_f32_32x32x16_bf16 v[96:111], v[196:199], v[36:39], v[96:111]
    ds_read_b128 v[32:35], v14 offset:16384
    v_cvt_pk_bf16_f32 v48, v64, v65
    v_cvt_pk_bf16_f32 v49, v66, v67
    v_mfma_f32_32x32x16_bf16 v[112:127], a[100:103], v[36:39], v[112:127]
    s_add_u32 s66, s79, 50176
    s_mov_b32 m0, s66
    s_nop 0
    buffer_load_dwordx4 v27, s[48:51], s65 offen lds
    v_cvt_pk_bf16_f32 v50, v68, v69
    v_cvt_pk_bf16_f32 v51, v70, v71
    s_waitcnt lgkmcnt(2)
    v_mfma_f32_32x32x16_bf16 v[96:111], v[200:203], v[40:43], v[96:111]
    ds_read_b128 v[36:39], v15 offset:16384
    buffer_store_dwordx4 v[48:51], v136, s[8:11], s54 offen offset:0 sc1
    v_cvt_pk_bf16_f32 v52, v72, v73
    v_mfma_f32_32x32x16_bf16 v[112:127], a[104:107], v[40:43], v[112:127]
    s_add_u32 s66, s79, 51200
    s_mov_b32 m0, s66
    s_nop 0
    buffer_load_dwordx4 v28, s[48:51], s65 offen lds
    v_cvt_pk_bf16_f32 v53, v74, v75
    v_cvt_pk_bf16_f32 v54, v76, v77
    s_waitcnt lgkmcnt(2)
    v_mfma_f32_32x32x16_bf16 v[96:111], v[204:207], v[44:47], v[96:111]
    ds_read_b128 v[40:43], v16 offset:16384
    v_cvt_pk_bf16_f32 v55, v78, v79
    buffer_store_dwordx4 v[52:55], v136, s[8:11], s54 offen offset:1024 sc1
    v_mfma_f32_32x32x16_bf16 v[112:127], a[108:111], v[44:47], v[112:127]
    s_add_u32 s66, s79, 52224
    s_mov_b32 m0, s66
    s_nop 0
    buffer_load_dwordx4 v29, s[48:51], s65 offen lds
    v_cvt_pk_bf16_f32 v56, v80, v81
    v_cvt_pk_bf16_f32 v57, v82, v83
    s_waitcnt lgkmcnt(2)
    v_mfma_f32_32x32x16_bf16 v[96:111], v[208:211], v[32:35], v[96:111]
    ds_read_b128 v[44:47], v17 offset:16384
    v_cvt_pk_bf16_f32 v58, v84, v85
    v_cvt_pk_bf16_f32 v59, v86, v87
    v_mfma_f32_32x32x16_bf16 v[112:127], a[112:115], v[32:35], v[112:127]
    buffer_store_dwordx4 v[56:59], v136, s[8:11], s54 offen offset:2048 sc1
    v_cvt_pk_bf16_f32 v60, v88, v89
    s_waitcnt vmcnt(28)
    s_barrier
    s_waitcnt lgkmcnt(2)
    v_mfma_f32_32x32x16_bf16 v[96:111], v[212:215], v[36:39], v[96:111]
    ds_read_b128 v[32:35], v10 offset:32768
    v_cvt_pk_bf16_f32 v61, v90, v91
    v_cvt_pk_bf16_f32 v62, v92, v93
    v_mfma_f32_32x32x16_bf16 v[112:127], a[116:119], v[36:39], v[112:127]
    v_cvt_pk_bf16_f32 v63, v94, v95
    buffer_store_dwordx4 v[60:63], v136, s[8:11], s54 offen offset:3072 sc1
    s_waitcnt lgkmcnt(2)
    v_mfma_f32_32x32x16_bf16 v[96:111], v[216:219], v[40:43], v[96:111]
    ds_read_b128 v[36:39], v11 offset:32768
    v_mfma_f32_32x32x16_bf16 v[112:127], a[120:123], v[40:43], v[112:127]
    s_waitcnt lgkmcnt(2)
    v_mfma_f32_32x32x16_bf16 v[96:111], v[220:223], v[44:47], v[96:111]
    ds_read_b128 v[40:43], v12 offset:32768
    v_mfma_f32_32x32x16_bf16 v[112:127], a[124:127], v[44:47], v[112:127]
    s_add_u32 s54, s54, s57
    s_mov_b32 s57, 49152
    v_mov_b32 v136, v1
    s_add_u32 s65, s53, 164864
    s_cmp_lg_u32 s52, 0
    s_cbranch_scc1 L_early_k
    s_waitcnt vmcnt(0)
    s_barrier
    s_cmp_lg_u32 s4, 0
    s_cbranch_scc1 L_early_k
    v_mov_b32 v144, 2
    v_mov_b32 v145, 2
    v_mov_b32 v146, 2
    v_mov_b32 v147, 2
    s_mov_b64 exec, 0xff
    buffer_store_dwordx4 v[144:147], v1, s[8:11], s55 offen sc1
    s_mov_b64 exec, -1
L_early_k:
    s_waitcnt lgkmcnt(2)
    v_mfma_f32_32x32x16_bf16 v[96:111], v[224:227], v[32:35], v[96:111]
    ds_read_b128 v[44:47], v13 offset:32768
    v_mfma_f32_32x32x16_bf16 v[112:127], a[128:131], v[32:35], v[112:127]
    s_add_u32 s66, s79, 65536
    s_mov_b32 m0, s66
    s_nop 0
    buffer_load_dwordx4 v26, s[48:51], s65 offen lds
    s_waitcnt lgkmcnt(2)
    v_mfma_f32_32x32x16_bf16 v[96:111], v[228:231], v[36:39], v[96:111]
    ds_read_b128 v[32:35], v14 offset:32768
    v_mfma_f32_32x32x16_bf16 v[112:127], a[132:135], v[36:39], v[112:127]
    s_add_u32 s66, s79, 66560
    s_mov_b32 m0, s66
    s_nop 0
    buffer_load_dwordx4 v27, s[48:51], s65 offen lds
    s_waitcnt lgkmcnt(2)
    v_mfma_f32_32x32x16_bf16 v[96:111], v[232:235], v[40:43], v[96:111]
    ds_read_b128 v[36:39], v15 offset:32768
    v_mfma_f32_32x32x16_bf16 v[112:127], a[136:139], v[40:43], v[112:127]
    s_add_u32 s66, s79, 67584
    s_mov_b32 m0, s66
    s_nop 0
    buffer_load_dwordx4 v28, s[48:51], s65 offen lds
    s_waitcnt lgkmcnt(2)
    v_mfma_f32_32x32x16_bf16 v[96:111], v[236:239], v[44:47], v[96:111]
    ds_read_b128 v[40:43], v16 offset:32768
    v_mfma_f32_32x32x16_bf16 v[112:127], a[140:143], v[44:47], v[112:127]
    s_add_u32 s66, s79, 68608
    s_mov_b32 m0, s66
    s_nop 0
    buffer_load_dwordx4 v29, s[48:51], s65 offen lds
    s_waitcnt lgkmcnt(2)
    v_mfma_f32_32x32x16_bf16 v[96:111], v[240:243], v[32:35], v[96:111]
    ds_read_b128 v[44:47], v17 offset:32768
    v_mfma_f32_32x32x16_bf16 v[112:127], a[144:147], v[32:35], v[112:127]
    s_waitcnt vmcnt(28)
    s_barrier
    s_waitcnt lgkmcnt(2)
    v_mfma_f32_32x32x16_bf16 v[96:111], v[244:247], v[36:39], v[96:111]
    ds_read_b128 v[32:35], v10 offset:49152
    v_mfma_f32_32x32x16_bf16 v[112:127], a[148:151], v[36:39], v[112:127]
    s_waitcnt lgkmcnt(2)
    v_mfma_f32_32x32x16_bf16 v[96:111], v[248:251], v[40:43], v[96:111]
    ds_read_b128 v[36:39], v11 offset:49152
    v_mfma_f32_32x32x16_bf16 v[112:127], a[152:155], v[40:43], v[112:127]
    s_waitcnt lgkmcnt(2)
    v_mfma_f32_32x32x16_bf16 v[96:111], v[252:255], v[44:47], v[96:111]
    ds_read_b128 v[40:43], v12 offset:49152
    v_mfma_f32_32x32x16_bf16 v[112:127], a[156:159], v[44:47], v[112:127]
    s_add_u32 s65, s53, 245760
    s_waitcnt lgkmcnt(2)
    v_mfma_f32_32x32x16_bf16 v[96:111], a[0:3], v[32:35], v[96:111]
    ds_read_b128 v[44:47], v13 offset:49152
    v_mfma_f32_32x32x16_bf16 v[112:127], a[160:163], v[32:35], v[112:127]
    s_add_u32 s66, s79, 81920
    s_mov_b32 m0, s66
    s_nop 0
    buffer_load_dwordx4 v26, s[48:51], s65 offen lds
    s_waitcnt lgkmcnt(2)
    v_mfma_f32_32x32x16_bf16 v[96:111], a[4:7], v[36:39], v[96:111]
    ds_read_b128 v[32:35], v14 offset:49152
    v_mfma_f32_32x32x16_bf16 v[112:127], a[164:167], v[36:39], v[112:127]
    s_add_u32 s66, s79, 82944
    s_mov_b32 m0, s66
    s_nop 0
    buffer_load_dwordx4 v27, s[48:51], s65 offen lds
    s_waitcnt lgkmcnt(2)
    v_mfma_f32_32x32x16_bf16 v[96:111], a[8:11], v[40:43], v[96:111]
    ds_read_b128 v[36:39], v15 offset:49152
    v_mfma_f32_32x32x16_bf16 v[112:127], a[168:171], v[40:43], v[112:127]
    s_add_u32 s66, s79, 83968
    s_mov_b32 m0, s66
    s_nop 0
    buffer_load_dwordx4 v28, s[48:51], s65 offen lds
    s_waitcnt lgkmcnt(2)
    v_mfma_f32_32x32x16_bf16 v[96:111], a[12:15], v[44:47], v[96:111]
    ds_read_b128 v[40:43], v16 offset:49152
    v_mfma_f32_32x32x16_bf16 v[112:127], a[172:175], v[44:47], v[112:127]
    s_add_u32 s66, s79, 84992
    s_mov_b32 m0, s66
    s_nop 0
    buffer_load_dwordx4 v29, s[48:51], s65 offen lds
    s_waitcnt lgkmcnt(2)
    v_mfma_f32_32x32x16_bf16 v[96:111], a[16:19], v[32:35], v[96:111]
    ds_read_b128 v[44:47], v17 offset:49152
    v_mfma_f32_32x32x16_bf16 v[112:127], a[176:179], v[32:35], v[112:127]
    s_waitcnt vmcnt(28)
    s_barrier
    s_waitcnt lgkmcnt(2)
    v_mfma_f32_32x32x16_bf16 v[96:111], a[20:23], v[36:39], v[96:111]
    ds_read_b128 v[32:35], v18 offset:0
    v_mfma_f32_32x32x16_bf16 v[112:127], a[180:183], v[36:39], v[112:127]
    s_waitcnt lgkmcnt(2)
    v_mfma_f32_32x32x16_bf16 v[96:111], a[24:27], v[40:43], v[96:111]
    ds_read_b128 v[36:39], v19 offset:0
    v_mfma_f32_32x32x16_bf16 v[112:127], a[184:187], v[40:43], v[112:127]
    s_waitcnt lgkmcnt(2)
    v_mfma_f32_32x32x16_bf16 v[96:111], a[28:31], v[44:47], v[96:111]
    ds_read_b128 v[40:43], v20 offset:0
    v_mfma_f32_32x32x16_bf16 v[112:127], a[188:191], v[44:47], v[112:127]
    s_add_u32 s65, s53, 246016
    s_waitcnt lgkmcnt(2)
    v_mfma_f32_32x32x16_bf16 v[96:111], a[32:35], v[32:35], v[96:111]
    ds_read_b128 v[44:47], v21 offset:0
    v_mfma_f32_32x32x16_bf16 v[112:127], a[192:195], v[32:35], v[112:127]
    s_add_u32 s66, s79, 98304
    s_mov_b32 m0, s66
    s_nop 0
    buffer_load_dwordx4 v26, s[48:51], s65 offen lds
    s_waitcnt lgkmcnt(2)
    v_mfma_f32_32x32x16_bf16 v[96:111], a[36:39], v[36:39], v[96:111]
    ds_read_b128 v[32:35], v22 offset:0
    v_mfma_f32_32x32x16_bf16 v[112:127], a[196:199], v[36:39], v[112:127]
    s_add_u32 s66, s79, 99328
    s_mov_b32 m0, s66
    s_nop 0
    buffer_load_dwordx4 v27, s[48:51], s65 offen lds
    s_waitcnt lgkmcnt(2)
    v_mfma_f32_32x32x16_bf16 v[96:111], a[40:43], v[40:43], v[96:111]
    ds_read_b128 v[36:39], v23 offset:0
    v_mfma_f32_32x32x16_bf16 v[112:127], a[200:203], v[40:43], v[112:127]
    s_add_u32 s66, s79, 100352
    s_mov_b32 m0, s66
    s_nop 0
    buffer_load_dwordx4 v28, s[48:51], s65 offen lds
    s_waitcnt lgkmcnt(2)
    v_mfma_f32_32x32x16_bf16 v[96:111], a[44:47], v[44:47], v[96:111]
    ds_read_b128 v[40:43], v24 offset:0
    v_mfma_f32_32x32x16_bf16 v[112:127], a[204:207], v[44:47], v[112:127]
    s_add_u32 s66, s79, 101376
    s_mov_b32 m0, s66
    s_nop 0
    buffer_load_dwordx4 v29, s[48:51], s65 offen lds
    s_waitcnt lgkmcnt(2)
    v_mfma_f32_32x32x16_bf16 v[96:111], a[48:51], v[32:35], v[96:111]
    ds_read_b128 v[44:47], v25 offset:0
    v_mfma_f32_32x32x16_bf16 v[112:127], a[208:211], v[32:35], v[112:127]
    s_waitcnt vmcnt(28)
    s_barrier
    s_cmp_lg_u32 s4, 0
    s_cbranch_scc1 L_np1_k
    s_add_u32 s56, s52, 1
    s_cmp_lt_u32 s56, 2
    s_cbranch_scc1 L_np1_k
    s_sub_u32 s56, s56, 1
    s_lshl_b32 s56, s56, 1
    v_mov_b32 v144, s56
    v_mov_b32 v145, s56
    v_mov_b32 v146, s56
    v_mov_b32 v147, s56
    s_mov_b64 exec, 0xff
    buffer_store_dwordx4 v[144:147], v1, s[8:11], s55 offen sc1
    s_mov_b64 exec, -1
L_np1_k:
    s_waitcnt lgkmcnt(2)
    v_mfma_f32_32x32x16_bf16 v[96:111], a[52:55], v[36:39], v[96:111]
    ds_read_b128 v[32:35], v18 offset:16384
    v_mfma_f32_32x32x16_bf16 v[112:127], a[212:215], v[36:39], v[112:127]
    s_waitcnt lgkmcnt(2)
    v_mfma_f32_32x32x16_bf16 v[96:111], a[56:59], v[40:43], v[96:111]
    ds_read_b128 v[36:39], v19 offset:16384
    v_mfma_f32_32x32x16_bf16 v[112:127], a[216:219], v[40:43], v[112:127]
    s_waitcnt lgkmcnt(2)
    v_mfma_f32_32x32x16_bf16 v[96:111], a[60:63], v[44:47], v[96:111]
    ds_read_b128 v[40:43], v20 offset:16384
    v_mfma_f32_32x32x16_bf16 v[112:127], a[220:223], v[44:47], v[112:127]
    s_add_u32 s65, s53, 246272
    s_waitcnt lgkmcnt(2)
    v_mfma_f32_32x32x16_bf16 v[96:111], a[64:67], v[32:35], v[96:111]
    ds_read_b128 v[44:47], v21 offset:16384
    v_mfma_f32_32x32x16_bf16 v[112:127], a[224:227], v[32:35], v[112:127]
    s_add_u32 s66, s79, 114688
    s_mov_b32 m0, s66
    s_nop 0
    buffer_load_dwordx4 v26, s[48:51], s65 offen lds
    s_waitcnt lgkmcnt(2)
    v_mfma_f32_32x32x16_bf16 v[96:111], a[68:71], v[36:39], v[96:111]
    ds_read_b128 v[32:35], v22 offset:16384
    v_mfma_f32_32x32x16_bf16 v[112:127], a[228:231], v[36:39], v[112:127]
    s_add_u32 s66, s79, 115712
    s_mov_b32 m0, s66
    s_nop 0
    buffer_load_dwordx4 v27, s[48:51], s65 offen lds
    s_waitcnt lgkmcnt(2)
    v_mfma_f32_32x32x16_bf16 v[96:111], a[72:75], v[40:43], v[96:111]
    ds_read_b128 v[36:39], v23 offset:16384
    v_mfma_f32_32x32x16_bf16 v[112:127], a[232:235], v[40:43], v[112:127]
    s_add_u32 s66, s79, 116736
    s_mov_b32 m0, s66
    s_nop 0
    buffer_load_dwordx4 v28, s[48:51], s65 offen lds
    s_waitcnt lgkmcnt(2)
    v_mfma_f32_32x32x16_bf16 v[96:111], a[76:79], v[44:47], v[96:111]
    ds_read_b128 v[40:43], v24 offset:16384
    v_mfma_f32_32x32x16_bf16 v[112:127], a[236:239], v[44:47], v[112:127]
    s_add_u32 s66, s79, 117760
    s_mov_b32 m0, s66
    s_nop 0
    buffer_load_dwordx4 v29, s[48:51], s65 offen lds
    s_waitcnt lgkmcnt(2)
    v_mfma_f32_32x32x16_bf16 v[96:111], a[80:83], v[32:35], v[96:111]
    ds_read_b128 v[44:47], v25 offset:16384
    v_mfma_f32_32x32x16_bf16 v[112:127], a[240:243], v[32:35], v[112:127]
    s_waitcnt vmcnt(28)
    s_barrier
    s_waitcnt lgkmcnt(2)
    v_mfma_f32_32x32x16_bf16 v[96:111], a[84:87], v[36:39], v[96:111]
    ds_read_b128 v[32:35], v2 offset:0
    v_mfma_f32_32x32x16_bf16 v[112:127], a[244:247], v[36:39], v[112:127]
    s_waitcnt lgkmcnt(2)
    v_mfma_f32_32x32x16_bf16 v[96:111], a[88:91], v[40:43], v[96:111]
    ds_read_b128 v[36:39], v3 offset:0
    v_mfma_f32_32x32x16_bf16 v[112:127], a[248:251], v[40:43], v[112:127]
    s_waitcnt lgkmcnt(2)
    v_mfma_f32_32x32x16_bf16 v[96:111], a[92:95], v[44:47], v[96:111]
    ds_read_b128 v[40:43], v4 offset:0
    v_mfma_f32_32x32x16_bf16 v[112:127], a[252:255], v[44:47], v[112:127]
    s_add_u32 s52, s52, 2
    s_add_u32 s53, s53, 163840
    s_cmp_lt_u32 s52, 32
    s_cbranch_scc1 L_g1_k
    s_waitcnt lgkmcnt(0)
    s_nop 4
    v_cvt_pk_bf16_f32 v48, v96, v97
    v_cvt_pk_bf16_f32 v49, v98, v99
    v_cvt_pk_bf16_f32 v50, v100, v101
    v_cvt_pk_bf16_f32 v51, v102, v103
    buffer_store_dwordx4 v[48:51], v136, s[8:11], s54 offen offset:0 sc1
    v_cvt_pk_bf16_f32 v52, v104, v105
    v_cvt_pk_bf16_f32 v53, v106, v107
    v_cvt_pk_bf16_f32 v54, v108, v109
    v_cvt_pk_bf16_f32 v55, v110, v111
    buffer_store_dwordx4 v[52:55], v136, s[8:11], s54 offen offset:1024 sc1
    v_cvt_pk_bf16_f32 v56, v112, v113
    v_cvt_pk_bf16_f32 v57, v114, v115
    v_cvt_pk_bf16_f32 v58, v116, v117
    v_cvt_pk_bf16_f32 v59, v118, v119
    buffer_store_dwordx4 v[56:59], v136, s[8:11], s54 offen offset:2048 sc1
    v_cvt_pk_bf16_f32 v60, v120, v121
    v_cvt_pk_bf16_f32 v61, v122, v123
    v_cvt_pk_bf16_f32 v62, v124, v125
    v_cvt_pk_bf16_f32 v63, v126, v127
    buffer_store_dwordx4 v[60:63], v136, s[8:11], s54 offen offset:3072 sc1
    s_waitcnt vmcnt(0)
    s_barrier
    s_cmp_lg_u32 s4, 0
    s_cbranch_scc1 L_g1end_k
    v_mov_b32 v144, 64
    v_mov_b32 v145, 64
    v_mov_b32 v146, 64
    v_mov_b32 v147, 64
    s_mov_b64 exec, 0xff
    buffer_store_dwordx4 v[144:147], v1, s[8:11], s55 offen sc1
    s_mov_b64 exec, -1
L_g1end_k:
    s_branch L_g1_done
L_g1_done:
L_gw_g3:
    v_mov_b32 v128, 96
    global_load_dword v129, v128, s[42:43] sc1
    s_waitcnt vmcnt(0)
    v_readfirstlane_b32 s68, v129
    s_cmp_ge_u32 s68, 128
    s_cbranch_scc1 L_gwok_g3
    s_cmp_eq_u32 s46, 0
    s_cbranch_scc1 L_gwok_g3
    s_sub_u32 s46, s46, 1
    s_branch L_gw_g3
L_gwok_g3:
L_gw_g3c:
    v_mov_b32 v128, 32
    global_load_dword v129, v128, s[42:43] sc1
    s_waitcnt vmcnt(0)
    v_readfirstlane_b32 s68, v129
    s_cmp_ge_u32 s68, 128
    s_cbranch_scc1 L_gwok_g3c
    s_cmp_eq_u32 s46, 0
    s_cbranch_scc1 L_gwok_g3c
    s_sub_u32 s46, s46, 1
    s_branch L_gw_g3c
L_gwok_g3c:
    s_cmp_ge_u32 s100, 90
    s_cbranch_scc1 L_g1_to_red
    s_mov_b32 s5, s100
    s_cmp_ge_u32 s100, 45
    s_cselect_b32 s50, 1, 0
    s_mul_i32 s65, s50, 45
    s_sub_u32 s65, s100, s65
    s_mul_i32 s48, s65, 52
    s_lshr_b32 s48, s48, 8
    s_mul_i32 s66, s48, 5
    s_sub_u32 s49, s65, s66
    s_mul_i32 s65, s49, 9
    s_add_u32 s65, s65, s48
    s_lshl_b32 s65, s65, 2
    s_add_u32 s65, s65, s4
    s_lshl_b32 s65, s65, 12
    s_add_u32 s55, s65, 83886080
    s_lshl_b32 s65, s49, 7
    s_add_u32 s57, s65, 72286208
    s_lshl_b32 s65, s48, 11
    s_add_u32 s56, s65, 72155136
    s_cmp_eq_u32 s48, 8
    s_cbranch_scc1 L_g3role_a
    s_mov_b32 s12, s34
    s_and_b32 s13, s35, 0xffff
    s_mov_b32 s14, 0x500000
    s_mov_b32 s15, 0x20000
    s_mul_i32 s78, s48, 655360
    s_lshl_b32 s65, s49, 8
    s_add_u32 s78, s78, s65
    v_lshrrev_b32 v128, 4, v0
    v_mul_u32_u24 v128, 1280, v128
    v_and_b32 v129, 15, v0
    v_lshl_add_u32 v131, v129, 4, v128
    s_mul_i32 s76, s4, 20480
    s_add_u32 s76, s76, s78
    s_lshl_b32 s77, s4, 12
    s_add_u32 s65, s76, 0
    s_add_u32 s66, s77, 0
    s_mov_b32 m0, s66
    s_nop 0
    buffer_load_dwordx4 v131, s[12:15], s65 offen lds
    s_add_u32 s65, s76, 5120
    s_add_u32 s66, s77, 1024
    s_mov_b32 m0, s66
    s_nop 0
    buffer_load_dwordx4 v131, s[12:15], s65 offen lds
    s_add_u32 s65, s76, 10240
    s_add_u32 s66, s77, 2048
    s_mov_b32 m0, s66
    s_nop 0
    buffer_load_dwordx4 v131, s[12:15], s65 offen lds
    s_add_u32 s65, s76, 15360
    s_add_u32 s66, s77, 3072
    s_mov_b32 m0, s66
    s_nop 0
    buffer_load_dwordx4 v131, s[12:15], s65 offen lds
    s_add_u32 s65, s76, 81920
    s_add_u32 s66, s77, 16384
    s_mov_b32 m0, s66
    s_nop 0
    buffer_load_dwordx4 v131, s[12:15], s65 offen lds
    s_add_u32 s65, s76, 87040
    s_add_u32 s66, s77, 17408
    s_mov_b32 m0, s66
    s_nop 0
    buffer_load_dwordx4 v131, s[12:15], s65 offen lds
    s_add_u32 s65, s76, 92160
    s_add_u32 s66, s77, 18432
    s_mov_b32 m0, s66
    s_nop 0
    buffer_load_dwordx4 v131, s[12:15], s65 offen lds
    s_add_u32 s65, s76, 97280
    s_add_u32 s66, s77, 19456
    s_mov_b32 m0, s66
    s_nop 0
    buffer_load_dwordx4 v131, s[12:15], s65 offen lds
    s_add_u32 s65, s76, 163840
    s_add_u32 s66, s77, 32768
    s_mov_b32 m0, s66
    s_nop 0
    buffer_load_dwordx4 v131, s[12:15], s65 offen lds
    s_add_u32 s65, s76, 168960
    s_add_u32 s66, s77, 33792
    s_mov_b32 m0, s66
    s_nop 0
    buffer_load_dwordx4 v131, s[12:15], s65 offen lds
    s_add_u32 s65, s76, 174080
    s_add_u32 s66, s77, 34816
    s_mov_b32 m0, s66
    s_nop 0
    buffer_load_dwordx4 v131, s[12:15], s65 offen lds
    s_add_u32 s65, s76, 179200
    s_add_u32 s66, s77, 35840
    s_mov_b32 m0, s66
    s_nop 0
    buffer_load_dwordx4 v131, s[12:15], s65 offen lds
    s_add_u32 s65, s76, 245760
    s_add_u32 s66, s77, 49152
    s_mov_b32 m0, s66
    s_nop 0
    buffer_load_dwordx4 v131, s[12:15], s65 offen lds
    s_add_u32 s65, s76, 250880
    s_add_u32 s66, s77, 50176
    s_mov_b32 m0, s66
    s_nop 0
    buffer_load_dwordx4 v131, s[12:15], s65 offen lds
    s_add_u32 s65, s76, 256000
    s_add_u32 s66, s77, 51200
    s_mov_b32 m0, s66
    s_nop 0
    buffer_load_dwordx4 v131, s[12:15], s65 offen lds
    s_add_u32 s65, s76, 261120
    s_add_u32 s66, s77, 52224
    s_mov_b32 m0, s66
    s_nop 0
    buffer_load_dwordx4 v131, s[12:15], s65 offen lds
    s_add_u32 s65, s76, 327680
    s_add_u32 s66, s77, 65536
    s_mov_b32 m0, s66
    s_nop 0
    buffer_load_dwordx4 v131, s[12:15], s65 offen lds
    s_add_u32 s65, s76, 332800
    s_add_u32 s66, s77, 66560
    s_mov_b32 m0, s66
    s_nop 0
    buffer_load_dwordx4 v131, s[12:15], s65 offen lds
    s_add_u32 s65, s76, 337920
    s_add_u32 s66, s77, 67584
    s_mov_b32 m0, s66
    s_nop 0
    buffer_load_dwordx4 v131, s[12:15], s65 offen lds
    s_add_u32 s65, s76, 343040
    s_add_u32 s66, s77, 68608
    s_mov_b32 m0, s66
    s_nop 0
    buffer_load_dwordx4 v131, s[12:15], s65 offen lds
    s_add_u32 s65, s76, 409600
    s_add_u32 s66, s77, 81920
    s_mov_b32 m0, s66
    s_nop 0
    buffer_load_dwordx4 v131, s[12:15], s65 offen lds
    s_add_u32 s65, s76, 414720
    s_add_u32 s66, s77, 82944
    s_mov_b32 m0, s66
    s_nop 0
    buffer_load_dwordx4 v131, s[12:15], s65 offen lds
    s_add_u32 s65, s76, 419840
    s_add_u32 s66, s77, 83968
    s_mov_b32 m0, s66
    s_nop 0
    buffer_load_dwordx4 v131, s[12:15], s65 offen lds
    s_add_u32 s65, s76, 424960
    s_add_u32 s66, s77, 84992
    s_mov_b32 m0, s66
    s_nop 0
    buffer_load_dwordx4 v131, s[12:15], s65 offen lds
    s_add_u32 s65, s76, 491520
    s_add_u32 s66, s77, 98304
    s_mov_b32 m0, s66
    s_nop 0
    buffer_load_dwordx4 v131, s[12:15], s65 offen lds
    s_add_u32 s65, s76, 496640
    s_add_u32 s66, s77, 99328
    s_mov_b32 m0, s66
    s_nop 0
    buffer_load_dwordx4 v131, s[12:15], s65 offen lds
    s_add_u32 s65, s76, 501760
    s_add_u32 s66, s77, 100352
    s_mov_b32 m0, s66
    s_nop 0
    buffer_load_dwordx4 v131, s[12:15], s65 offen lds
    s_add_u32 s65, s76, 506880
    s_add_u32 s66, s77, 101376
    s_mov_b32 m0, s66
    s_nop 0
    buffer_load_dwordx4 v131, s[12:15], s65 offen lds
    s_add_u32 s65, s76, 573440
    s_add_u32 s66, s77, 114688
    s_mov_b32 m0, s66
    s_nop 0
    buffer_load_dwordx4 v131, s[12:15], s65 offen lds
    s_add_u32 s65, s76, 578560
    s_add_u32 s66, s77, 115712
    s_mov_b32 m0, s66
    s_nop 0
    buffer_load_dwordx4 v131, s[12:15], s65 offen lds
    s_add_u32 s65, s76, 583680
    s_add_u32 s66, s77, 116736
    s_mov_b32 m0, s66
    s_nop 0
    buffer_load_dwordx4 v131, s[12:15], s65 offen lds
    s_add_u32 s65, s76, 588800
    s_add_u32 s66, s77, 117760
    s_mov_b32 m0, s66
    s_nop 0
    buffer_load_dwordx4 v131, s[12:15], s65 offen lds
    v_lshrrev_b32 v128, 5, v0
    v_lshlrev_b32 v128, 2, v128
    v_bfe_u32 v129, v0, 2, 2
    v_add_u32 v128, v128, v129
    v_lshlrev_b32 v128, 8, v128
    v_bfe_u32 v129, v0, 4, 1
    v_lshl_add_u32 v128, v129, 5, v128
    v_and_b32 v129, 3, v0
    v_lshl_add_u32 v128, v129, 3, v128
    s_lshl_b32 s65, s4, 6
    v_add_u32 v132, s65, v128
    v_add_u32 v133, 0x10000, v132
    v_add_u32 v134, 0x20000, v132
    s_waitcnt vmcnt(0)
    s_barrier
    ds_read_b64_tr_b16 v[192:193], v132 offset:0
    ds_read_b64_tr_b16 v[194:195], v132 offset:4096
    ds_read_b64_tr_b16 v[196:197], v132 offset:2048
    ds_read_b64_tr_b16 v[198:199], v132 offset:6144
    ds_read_b64_tr_b16 v[200:201], v132 offset:8192
    ds_read_b64_tr_b16 v[202:203], v132 offset:12288
    ds_read_b64_tr_b16 v[204:205], v132 offset:10240
    ds_read_b64_tr_b16 v[206:207], v132 offset:14336
    s_waitcnt lgkmcnt(0)
    ds_read_b64_tr_b16 v[208:209], v132 offset:16384
    ds_read_b64_tr_b16 v[210:211], v132 offset:20480
    ds_read_b64_tr_b16 v[212:213], v132 offset:18432
    ds_read_b64_tr_b16 v[214:215], v132 offset:22528
    ds_read_b64_tr_b16 v[216:217], v132 offset:24576
    ds_read_b64_tr_b16 v[218:219], v132 offset:28672
    ds_read_b64_tr_b16 v[220:221], v132 offset:26624
    ds_read_b64_tr_b16 v[222:223], v132 offset:30720
    s_waitcnt lgkmcnt(0)
    ds_read_b64_tr_b16 v[224:225], v132 offset:32768
    ds_read_b64_tr_b16 v[226:227], v132 offset:36864
    ds_read_b64_tr_b16 v[228:229], v132 offset:34816
    ds_read_b64_tr_b16 v[230:231], v132 offset:38912
    ds_read_b64_tr_b16 v[232:233], v132 offset:40960
    ds_read_b64_tr_b16 v[234:235], v132 offset:45056
    ds_read_b64_tr_b16 v[236:237], v132 offset:43008
    ds_read_b64_tr_b16 v[238:239], v132 offset:47104
    s_waitcnt lgkmcnt(0)
    ds_read_b64_tr_b16 v[240:241], v132 offset:49152
    ds_read_b64_tr_b16 v[242:243], v132 offset:53248
    ds_read_b64_tr_b16 v[244:245], v132 offset:51200
    ds_read_b64_tr_b16 v[246:247], v132 offset:55296
    ds_read_b64_tr_b16 v[248:249], v132 offset:57344
    ds_read_b64_tr_b16 v[250:251], v132 offset:61440
    ds_read_b64_tr_b16 v[252:253], v132 offset:59392
    ds_read_b64_tr_b16 v[254:255], v132 offset:63488
    s_waitcnt lgkmcnt(0)
    ds_read_b64_tr_b16 a[0:1], v133 offset:0
    ds_read_b64_tr_b16 a[2:3], v133 offset:4096
    ds_read_b64_tr_b16 a[4:5], v133 offset:2048
    ds_read_b64_tr_b16 a[6:7], v133 offset:6144
    ds_read_b64_tr_b16 a[8:9], v133 offset:8192
    ds_read_b64_tr_b16 a[10:11], v133 offset:12288
    ds_read_b64_tr_b16 a[12:13], v133 offset:10240
    ds_read_b64_tr_b16 a[14:15], v133 offset:14336
    s_waitcnt lgkmcnt(0)
    ds_read_b64_tr_b16 a[16:17], v133 offset:16384
    ds_read_b64_tr_b16 a[18:19], v133 offset:20480
    ds_read_b64_tr_b16 a[20:21], v133 offset:18432
    ds_read_b64_tr_b16 a[22:23], v133 offset:22528
    ds_read_b64_tr_b16 a[24:25], v133 offset:24576
    ds_read_b64_tr_b16 a[26:27], v133 offset:28672
    ds_read_b64_tr_b16 a[28:29], v133 offset:26624
    ds_read_b64_tr_b16 a[30:31], v133 offset:30720
    s_waitcnt lgkmcnt(0)
    ds_read_b64_tr_b16 a[32:33], v133 offset:32768
    ds_read_b64_tr_b16 a[34:35], v133 offset:36864
    ds_read_b64_tr_b16 a[36:37], v133 offset:34816
    ds_read_b64_tr_b16 a[38:39], v133 offset:38912
    ds_read_b64_tr_b16 a[40:41], v133 offset:40960
    ds_read_b64_tr_b16 a[42:43], v133 offset:45056
    ds_read_b64_tr_b16 a[44:45], v133 offset:43008
    ds_read_b64_tr_b16 a[46:47], v133 offset:47104
    s_waitcnt lgkmcnt(0)
    ds_read_b64_tr_b16 a[48:49], v133 offset:49152
    ds_read_b64_tr_b16 a[50:51], v133 offset:53248
    ds_read_b64_tr_b16 a[52:53], v133 offset:51200
    ds_read_b64_tr_b16 a[54:55], v133 offset:55296
    ds_read_b64_tr_b16 a[56:57], v133 offset:57344
    ds_read_b64_tr_b16 a[58:59], v133 offset:61440
    ds_read_b64_tr_b16 a[60:61], v133 offset:59392
    ds_read_b64_tr_b16 a[62:63], v133 offset:63488
    s_waitcnt lgkmcnt(0)
    s_waitcnt lgkmcnt(0)
    s_barrier
    s_lshl_b32 s65, s48, 2
    s_add_u32 s65, s65, s4
    s_lshl_b32 s65, s65, 19
    s_add_u32 s53, s65, 50331648
    s_mov_b32 s54, 8192
    s_mov_b32 s51, s50
    s_mov_b32 s59, 0
    s_mov_b32 s61, 0
L_g3_b:
    s_cmp_lg_u32 s61, 0
    s_cbranch_scc1 L_g3have_b
    s_mov_b32 s52, s51
    s_add_u32 s76, s52, 1
    s_waitcnt vmcnt(0)
    s_cmp_lg_u32 s4, 0
    s_cbranch_scc1 L_wcok_b0
    v_min_u32 v128, 15, v0
    v_lshlrev_b32 v128, 7, v128
L_wc_b0:
    buffer_load_dword v129, v128, s[8:11], s56 offen sc1
    s_waitcnt vmcnt(0)
    v_cmp_gt_u32 vcc, s76, v129
    s_cbranch_vccz L_wcok_b0
    s_sleep 4
    s_cmp_eq_u32 s46, 0
    s_cbranch_scc1 L_wcok_b0
    s_sub_u32 s46, s46, 1
    s_branch L_wc_b0
L_wcok_b0:
    s_barrier
    s_mul_i32 s65, s52, s54
    s_add_u32 s65, s65, s53
    s_mul_i32 s66, s59, 32768
    s_mul_i32 s67, s4, 8192
    s_add_u32 s66, s66, s67
    s_add_u32 m0, s66, 0
    s_nop 0
    buffer_load_dwordx4 v1, s[8:11], s65 offen sc1 lds
    s_add_u32 s65, s65, 1024
    s_add_u32 m0, s66, 1024
    s_nop 0
    buffer_load_dwordx4 v1, s[8:11], s65 offen sc1 lds
    s_add_u32 s65, s65, 1024
    s_add_u32 m0, s66, 2048
    s_nop 0
    buffer_load_dwordx4 v1, s[8:11], s65 offen sc1 lds
    s_add_u32 s65, s65, 1024
    s_add_u32 m0, s66, 3072
    s_nop 0
    buffer_load_dwordx4 v1, s[8:11], s65 offen sc1 lds
    s_add_u32 s65, s65, 1024
    s_add_u32 m0, s66, 4096
    s_nop 0
    buffer_load_dwordx4 v1, s[8:11], s65 offen sc1 lds
    s_add_u32 s65, s65, 1024
    s_add_u32 m0, s66, 5120
    s_nop 0
    buffer_load_dwordx4 v1, s[8:11], s65 offen sc1 lds
    s_add_u32 s65, s65, 1024
    s_add_u32 m0, s66, 6144
    s_nop 0
    buffer_load_dwordx4 v1, s[8:11], s65 offen sc1 lds
    s_add_u32 s65, s65, 1024
    s_add_u32 m0, s66, 7168
    s_nop 0
    buffer_load_dwordx4 v1, s[8:11], s65 offen sc1 lds
    s_add_u32 s65, s65, 1024
L_g3have_b:
    s_mov_b32 s61, 0
    s_add_u32 s77, s59, 1
    s_cmp_eq_u32 s77, 3
    s_cselect_b32 s77, 0, s77
    s_add_u32 s52, s51, 2
    s_cmp_ge_u32 s52, 64
    s_cbranch_scc1 L_g3nf_b
    s_cmp_lg_u32 s4, 0
    s_cbranch_scc1 L_g3c1_b
    v_min_u32 v128, 15, v0
    v_lshlrev_b32 v128, 7, v128
    buffer_load_dword v129, v128, s[8:11], s56 offen sc1
    s_add_u32 s76, s52, 1
    s_waitcnt vmcnt(0)
    v_cmp_gt_u32 vcc, s76, v129
    s_cmp_eq_u64 vcc, 0
    s_cselect_b32 s76, 1, 0
    v_mov_b32 v128, 159744
    v_mov_b32 v129, s76
    ds_write_b32 v128, v129
    s_waitcnt lgkmcnt(0)
L_g3c1_b:
    s_barrier
    v_mov_b32 v128, 159744
    ds_read_b32 v129, v128
    s_waitcnt lgkmcnt(0)
    v_readfirstlane_b32 s61, v129
    s_cmp_eq_u32 s61, 0
    s_cbranch_scc1 L_g3nf_b
    s_mov_b32 s78, s59
    s_mov_b32 s59, s77
    s_mul_i32 s65, s52, s54
    s_add_u32 s65, s65, s53
    s_mul_i32 s66, s59, 32768
    s_mul_i32 s67, s4, 8192
    s_add_u32 s66, s66, s67
    s_add_u32 m0, s66, 0
    s_nop 0
    buffer_load_dwordx4 v1, s[8:11], s65 offen sc1 lds
    s_add_u32 s65, s65, 1024
    s_add_u32 m0, s66, 1024
    s_nop 0
    buffer_load_dwordx4 v1, s[8:11], s65 offen sc1 lds
    s_add_u32 s65, s65, 1024
    s_add_u32 m0, s66, 2048
    s_nop 0
    buffer_load_dwordx4 v1, s[8:11], s65 offen sc1 lds
    s_add_u32 s65, s65, 1024
    s_add_u32 m0, s66, 3072
    s_nop 0
    buffer_load_dwordx4 v1, s[8:11], s65 offen sc1 lds
    s_add_u32 s65, s65, 1024
    s_add_u32 m0, s66, 4096
    s_nop 0
    buffer_load_dwordx4 v1, s[8:11], s65 offen sc1 lds
    s_add_u32 s65, s65, 1024
    s_add_u32 m0, s66, 5120
    s_nop 0
    buffer_load_dwordx4 v1, s[8:11], s65 offen sc1 lds
    s_add_u32 s65, s65, 1024
    s_add_u32 m0, s66, 6144
    s_nop 0
    buffer_load_dwordx4 v1, s[8:11], s65 offen sc1 lds
    s_add_u32 s65, s65, 1024
    s_add_u32 m0, s66, 7168
    s_nop 0
    buffer_load_dwordx4 v1, s[8:11], s65 offen sc1 lds
    s_add_u32 s65, s65, 1024
    s_mov_b32 s59, s78
    s_waitcnt vmcnt(8)
    s_branch L_g3go_b
L_g3nf_b:
    s_waitcnt vmcnt(0)
L_g3go_b:
    s_barrier
    s_mul_i32 s65, s59, 32768
    v_add_u32 v136, s65, v1
    s_mov_b32 s59, s77
    ds_read_b128 v[32:35], v136 offset:0
    ds_read_b128 v[36:39], v136 offset:1024
    ds_read_b128 v[40:43], v136 offset:2048
    s_waitcnt lgkmcnt(2)
    v_mfma_f32_32x32x16_bf16 v[64:79], v[192:195], v[32:35], 0
    ds_read_b128 v[44:47], v136 offset:3072
    s_waitcnt lgkmcnt(2)
    v_mfma_f32_32x32x16_bf16 v[64:79], v[196:199], v[36:39], v[64:79]
    ds_read_b128 v[32:35], v136 offset:4096
    s_waitcnt lgkmcnt(2)
    v_mfma_f32_32x32x16_bf16 v[64:79], v[200:203], v[40:43], v[64:79]
    ds_read_b128 v[36:39], v136 offset:5120
    s_waitcnt lgkmcnt(2)
    v_mfma_f32_32x32x16_bf16 v[64:79], v[204:207], v[44:47], v[64:79]
    ds_read_b128 v[40:43], v136 offset:6144
    s_waitcnt lgkmcnt(2)
    v_mfma_f32_32x32x16_bf16 v[64:79], v[208:211], v[32:35], v[64:79]
    ds_read_b128 v[44:47], v136 offset:7168
    s_waitcnt lgkmcnt(2)
    v_mfma_f32_32x32x16_bf16 v[64:79], v[212:215], v[36:39], v[64:79]
    ds_read_b128 v[32:35], v136 offset:8192
    s_waitcnt lgkmcnt(2)
    v_mfma_f32_32x32x16_bf16 v[64:79], v[216:219], v[40:43], v[64:79]
    ds_read_b128 v[36:39], v136 offset:9216
    s_waitcnt lgkmcnt(2)
    v_mfma_f32_32x32x16_bf16 v[64:79], v[220:223], v[44:47], v[64:79]
    ds_read_b128 v[40:43], v136 offset:10240
    s_waitcnt lgkmcnt(2)
    v_mfma_f32_32x32x16_bf16 v[64:79], v[224:227], v[32:35], v[64:79]
    ds_read_b128 v[44:47], v136 offset:11264
    s_waitcnt lgkmcnt(2)
    v_mfma_f32_32x32x16_bf16 v[64:79], v[228:231], v[36:39], v[64:79]
    ds_read_b128 v[32:35], v136 offset:12288
    s_waitcnt lgkmcnt(2)
    v_mfma_f32_32x32x16_bf16 v[64:79], v[232:235], v[40:43], v[64:79]
    ds_read_b128 v[36:39], v136 offset:13312
    s_waitcnt lgkmcnt(2)
    v_mfma_f32_32x32x16_bf16 v[64:79], v[236:239], v[44:47], v[64:79]
    ds_read_b128 v[40:43], v136 offset:14336
    s_waitcnt lgkmcnt(2)
    v_mfma_f32_32x32x16_bf16 v[64:79], v[240:243], v[32:35], v[64:79]
    ds_read_b128 v[44:47], v136 offset:15360
    s_waitcnt lgkmcnt(2)
    v_mfma_f32_32x32x16_bf16 v[64:79], v[244:247], v[36:39], v[64:79]
    ds_read_b128 v[32:35], v136 offset:16384
    s_waitcnt lgkmcnt(2)
    v_mfma_f32_32x32x16_bf16 v[64:79], v[248:251], v[40:43], v[64:79]
    ds_read_b128 v[36:39], v136 offset:17408
    s_waitcnt lgkmcnt(2)
    v_mfma_f32_32x32x16_bf16 v[64:79], v[252:255], v[44:47], v[64:79]
    ds_read_b128 v[40:43], v136 offset:18432
    s_waitcnt lgkmcnt(2)
    v_mfma_f32_32x32x16_bf16 v[64:79], a[0:3], v[32:35], v[64:79]
    ds_read_b128 v[44:47], v136 offset:19456
    s_waitcnt lgkmcnt(2)
    v_mfma_f32_32x32x16_bf16 v[64:79], a[4:7], v[36:39], v[64:79]
    ds_read_b128 v[32:35], v136 offset:20480
    s_waitcnt lgkmcnt(2)
    v_mfma_f32_32x32x16_bf16 v[64:79], a[8:11], v[40:43], v[64:79]
    ds_read_b128 v[36:39], v136 offset:21504
    s_waitcnt lgkmcnt(2)
    v_mfma_f32_32x32x16_bf16 v[64:79], a[12:15], v[44:47], v[64:79]
    ds_read_b128 v[40:43], v136 offset:22528
    s_waitcnt lgkmcnt(2)
    v_mfma_f32_32x32x16_bf16 v[64:79], a[16:19], v[32:35], v[64:79]
    ds_read_b128 v[44:47], v136 offset:23552
    s_waitcnt lgkmcnt(2)
    v_mfma_f32_32x32x16_bf16 v[64:79], a[20:23], v[36:39], v[64:79]
    ds_read_b128 v[32:35], v136 offset:24576
    s_waitcnt lgkmcnt(2)
    v_mfma_f32_32x32x16_bf16 v[64:79], a[24:27], v[40:43], v[64:79]
    ds_read_b128 v[36:39], v136 offset:25600
    s_waitcnt lgkmcnt(2)
    v_mfma_f32_32x32x16_bf16 v[64:79], a[28:31], v[44:47], v[64:79]
    ds_read_b128 v[40:43], v136 offset:26624
    s_waitcnt lgkmcnt(2)
    v_mfma_f32_32x32x16_bf16 v[64:79], a[32:35], v[32:35], v[64:79]
    ds_read_b128 v[44:47], v136 offset:27648
    s_waitcnt lgkmcnt(2)
    v_mfma_f32_32x32x16_bf16 v[64:79], a[36:39], v[36:39], v[64:79]
    ds_read_b128 v[32:35], v136 offset:28672
    s_waitcnt lgkmcnt(2)
    v_mfma_f32_32x32x16_bf16 v[64:79], a[40:43], v[40:43], v[64:79]
    ds_read_b128 v[36:39], v136 offset:29696
    s_waitcnt lgkmcnt(2)
    v_mfma_f32_32x32x16_bf16 v[64:79], a[44:47], v[44:47], v[64:79]
    ds_read_b128 v[40:43], v136 offset:30720
    s_waitcnt lgkmcnt(2)
    v_mfma_f32_32x32x16_bf16 v[64:79], a[48:51], v[32:35], v[64:79]
    ds_read_b128 v[44:47], v136 offset:31744
    s_waitcnt lgkmcnt(2)
    v_mfma_f32_32x32x16_bf16 v[64:79], a[52:55], v[36:39], v[64:79]
    s_waitcnt lgkmcnt(1)
    v_mfma_f32_32x32x16_bf16 v[64:79], a[56:59], v[40:43], v[64:79]
    s_waitcnt lgkmcnt(0)
    v_mfma_f32_32x32x16_bf16 v[64:79], a[60:63], v[44:47], v[64:79]
    s_mul_i32 s65, s51, 737280
    s_add_u32 s65, s65, s55
    s_nop 9
    buffer_store_dwordx4 v[64:67], v1, s[8:11], s65 offen offset:0 sc1
    buffer_store_dwordx4 v[68:71], v1, s[8:11], s65 offen offset:1024 sc1
    buffer_store_dwordx4 v[72:75], v1, s[8:11], s65 offen offset:2048 sc1
    buffer_store_dwordx4 v[76:79], v1, s[8:11], s65 offen offset:3072 sc1
    s_waitcnt vmcnt(0)
    s_barrier
    s_mul_i32 s79, s51, 640
    s_add_u32 s79, s79, s57
    s_cmp_lg_u32 s4, 0
    s_cbranch_scc1 L_ai_bo
    v_mov_b32 v128, 0
    v_mov_b32 v129, 1
    s_mov_b64 exec, 1
    buffer_atomic_add v129, v128, s[8:11], s79 offen sc1
    s_mov_b64 exec, -1
L_ai_bo:
    s_add_u32 s51, s51, 2
    s_cmp_lt_u32 s51, 64
    s_cbranch_scc1 L_g3_b
    s_branch L_g3role_done
L_g3role_a:
    s_mov_b32 s12, s22
    s_and_b32 s13, s23, 0xffff
    s_mov_b32 s14, 0xc8000
    s_mov_b32 s15, 0x20000
    s_lshl_b32 s78, s49, 8
    v_lshrrev_b32 v128, 4, v0
    v_mul_u32_u24 v128, 1280, v128
    v_and_b32 v129, 15, v0
    v_lshl_add_u32 v131, v129, 4, v128
    s_mul_i32 s76, s4, 20480
    s_add_u32 s76, s76, s78
    s_lshl_b32 s77, s4, 12
    s_add_u32 s65, s76, 0
    s_add_u32 s66, s77, 0
    s_mov_b32 m0, s66
    s_nop 0
    buffer_load_dwordx4 v131, s[12:15], s65 offen lds
    s_add_u32 s65, s76, 5120
    s_add_u32 s66, s77, 1024
    s_mov_b32 m0, s66
    s_nop 0
    buffer_load_dwordx4 v131, s[12:15], s65 offen lds
    s_add_u32 s65, s76, 10240
    s_add_u32 s66, s77, 2048
    s_mov_b32 m0, s66
    s_nop 0
    buffer_load_dwordx4 v131, s[12:15], s65 offen lds
    s_add_u32 s65, s76, 15360
    s_add_u32 s66, s77, 3072
    s_mov_b32 m0, s66
    s_nop 0
    buffer_load_dwordx4 v131, s[12:15], s65 offen lds
    s_add_u32 s65, s76, 81920
    s_add_u32 s66, s77, 16384
    s_mov_b32 m0, s66
    s_nop 0
    buffer_load_dwordx4 v131, s[12:15], s65 offen lds
    s_add_u32 s65, s76, 87040
    s_add_u32 s66, s77, 17408
    s_mov_b32 m0, s66
    s_nop 0
    buffer_load_dwordx4 v131, s[12:15], s65 offen lds
    s_add_u32 s65, s76, 92160
    s_add_u32 s66, s77, 18432
    s_mov_b32 m0, s66
    s_nop 0
    buffer_load_dwordx4 v131, s[12:15], s65 offen lds
    s_add_u32 s65, s76, 97280
    s_add_u32 s66, s77, 19456
    s_mov_b32 m0, s66
    s_nop 0
    buffer_load_dwordx4 v131, s[12:15], s65 offen lds
    s_add_u32 s65, s76, 163840
    s_add_u32 s66, s77, 32768
    s_mov_b32 m0, s66
    s_nop 0
    buffer_load_dwordx4 v131, s[12:15], s65 offen lds
    s_add_u32 s65, s76, 168960
    s_add_u32 s66, s77, 33792
    s_mov_b32 m0, s66
    s_nop 0
    buffer_load_dwordx4 v131, s[12:15], s65 offen lds
    s_add_u32 s65, s76, 174080
    s_add_u32 s66, s77, 34816
    s_mov_b32 m0, s66
    s_nop 0
    buffer_load_dwordx4 v131, s[12:15], s65 offen lds
    s_add_u32 s65, s76, 179200
    s_add_u32 s66, s77, 35840
    s_mov_b32 m0, s66
    s_nop 0
    buffer_load_dwordx4 v131, s[12:15], s65 offen lds
    s_add_u32 s65, s76, 245760
    s_add_u32 s66, s77, 49152
    s_mov_b32 m0, s66
    s_nop 0
    buffer_load_dwordx4 v131, s[12:15], s65 offen lds
    s_add_u32 s65, s76, 250880
    s_add_u32 s66, s77, 50176
    s_mov_b32 m0, s66
    s_nop 0
    buffer_load_dwordx4 v131, s[12:15], s65 offen lds
    s_add_u32 s65, s76, 256000
    s_add_u32 s66, s77, 51200
    s_mov_b32 m0, s66
    s_nop 0
    buffer_load_dwordx4 v131, s[12:15], s65 offen lds
    s_add_u32 s65, s76, 261120
    s_add_u32 s66, s77, 52224
    s_mov_b32 m0, s66
    s_nop 0
    buffer_load_dwordx4 v131, s[12:15], s65 offen lds
    s_add_u32 s65, s76, 327680
    s_add_u32 s66, s77, 65536
    s_mov_b32 m0, s66
    s_nop 0
    buffer_load_dwordx4 v131, s[12:15], s65 offen lds
    s_add_u32 s65, s76, 332800
    s_add_u32 s66, s77, 66560
    s_mov_b32 m0, s66
    s_nop 0
    buffer_load_dwordx4 v131, s[12:15], s65 offen lds
    s_add_u32 s65, s76, 337920
    s_add_u32 s66, s77, 67584
    s_mov_b32 m0, s66
    s_nop 0
    buffer_load_dwordx4 v131, s[12:15], s65 offen lds
    s_add_u32 s65, s76, 343040
    s_add_u32 s66, s77, 68608
    s_mov_b32 m0, s66
    s_nop 0
    buffer_load_dwordx4 v131, s[12:15], s65 offen lds
    s_add_u32 s65, s76, 409600
    s_add_u32 s66, s77, 81920
    s_mov_b32 m0, s66
    s_nop 0
    buffer_load_dwordx4 v131, s[12:15], s65 offen lds
    s_add_u32 s65, s76, 414720
    s_add_u32 s66, s77, 82944
    s_mov_b32 m0, s66
    s_nop 0
    buffer_load_dwordx4 v131, s[12:15], s65 offen lds
    s_add_u32 s65, s76, 419840
    s_add_u32 s66, s77, 83968
    s_mov_b32 m0, s66
    s_nop 0
    buffer_load_dwordx4 v131, s[12:15], s65 offen lds
    s_add_u32 s65, s76, 424960
    s_add_u32 s66, s77, 84992
    s_mov_b32 m0, s66
    s_nop 0
    buffer_load_dwordx4 v131, s[12:15], s65 offen lds
    s_add_u32 s65, s76, 491520
    s_add_u32 s66, s77, 98304
    s_mov_b32 m0, s66
    s_nop 0
    buffer_load_dwordx4 v131, s[12:15], s65 offen lds
    s_add_u32 s65, s76, 496640
    s_add_u32 s66, s77, 99328
    s_mov_b32 m0, s66
    s_nop 0
    buffer_load_dwordx4 v131, s[12:15], s65 offen lds
    s_add_u32 s65, s76, 501760
    s_add_u32 s66, s77, 100352
    s_mov_b32 m0, s66
    s_nop 0
    buffer_load_dwordx4 v131, s[12:15], s65 offen lds
    s_add_u32 s65, s76, 506880
    s_add_u32 s66, s77, 101376
    s_mov_b32 m0, s66
    s_nop 0
    buffer_load_dwordx4 v131, s[12:15], s65 offen lds
    s_add_u32 s65, s76, 573440
    s_add_u32 s66, s77, 114688
    s_mov_b32 m0, s66
    s_nop 0
    buffer_load_dwordx4 v131, s[12:15], s65 offen lds
    s_add_u32 s65, s76, 578560
    s_add_u32 s66, s77, 115712
    s_mov_b32 m0, s66
    s_nop 0
    buffer_load_dwordx4 v131, s[12:15], s65 offen lds
    s_add_u32 s65, s76, 583680
    s_add_u32 s66, s77, 116736
    s_mov_b32 m0, s66
    s_nop 0
    buffer_load_dwordx4 v131, s[12:15], s65 offen lds
    s_add_u32 s65, s76, 588800
    s_add_u32 s66, s77, 117760
    s_mov_b32 m0, s66
    s_nop 0
    buffer_load_dwordx4 v131, s[12:15], s65 offen lds
    s_add_u32 s65, s76, 655360
    s_add_u32 s66, s77, 131072
    s_mov_b32 m0, s66
    s_nop 0
    buffer_load_dwordx4 v131, s[12:15], s65 offen lds
    s_add_u32 s65, s76, 660480
    s_add_u32 s66, s77, 132096
    s_mov_b32 m0, s66
    s_nop 0
    buffer_load_dwordx4 v131, s[12:15], s65 offen lds
    s_add_u32 s65, s76, 665600
    s_add_u32 s66, s77, 133120
    s_mov_b32 m0, s66
    s_nop 0
    buffer_load_dwordx4 v131, s[12:15], s65 offen lds
    s_add_u32 s65, s76, 670720
    s_add_u32 s66, s77, 134144
    s_mov_b32 m0, s66
    s_nop 0
    buffer_load_dwordx4 v131, s[12:15], s65 offen lds
    s_add_u32 s65, s76, 737280
    s_add_u32 s66, s77, 147456
    s_mov_b32 m0, s66
    s_nop 0
    buffer_load_dwordx4 v131, s[12:15], s65 offen lds
    s_add_u32 s65, s76, 742400
    s_add_u32 s66, s77, 148480
    s_mov_b32 m0, s66
    s_nop 0
    buffer_load_dwordx4 v131, s[12:15], s65 offen lds
    s_add_u32 s65, s76, 747520
    s_add_u32 s66, s77, 149504
    s_mov_b32 m0, s66
    s_nop 0
    buffer_load_dwordx4 v131, s[12:15], s65 offen lds
    s_add_u32 s65, s76, 752640
    s_add_u32 s66, s77, 150528
    s_mov_b32 m0, s66
    s_nop 0
    buffer_load_dwordx4 v131, s[12:15], s65 offen lds
    v_lshrrev_b32 v128, 5, v0
    v_lshlrev_b32 v128, 3, v128
    v_bfe_u32 v129, v0, 2, 2
    v_add_u32 v128, v128, v129
    v_lshlrev_b32 v128, 8, v128
    v_bfe_u32 v129, v0, 4, 1
    v_lshl_add_u32 v128, v129, 5, v128
    v_and_b32 v129, 3, v0
    v_lshl_add_u32 v128, v129, 3, v128
    s_lshl_b32 s65, s4, 6
    v_add_u32 v132, s65, v128
    v_add_u32 v133, 0x10000, v132
    v_add_u32 v134, 0x20000, v132
    s_waitcnt vmcnt(0)
    s_barrier
    ds_read_b64_tr_b16 v[192:193], v132 offset:0
    ds_read_b64_tr_b16 v[194:195], v132 offset:1024
    ds_read_b64_tr_b16 v[196:197], v132 offset:4096
    ds_read_b64_tr_b16 v[198:199], v132 offset:5120
    ds_read_b64_tr_b16 v[200:201], v132 offset:8192
    ds_read_b64_tr_b16 v[202:203], v132 offset:9216
    ds_read_b64_tr_b16 v[204:205], v132 offset:12288
    ds_read_b64_tr_b16 v[206:207], v132 offset:13312
    s_waitcnt lgkmcnt(0)
    ds_read_b64_tr_b16 v[208:209], v132 offset:16384
    ds_read_b64_tr_b16 v[210:211], v132 offset:17408
    ds_read_b64_tr_b16 v[212:213], v132 offset:20480
    ds_read_b64_tr_b16 v[214:215], v132 offset:21504
    ds_read_b64_tr_b16 v[216:217], v132 offset:24576
    ds_read_b64_tr_b16 v[218:219], v132 offset:25600
    ds_read_b64_tr_b16 v[220:221], v132 offset:28672
    ds_read_b64_tr_b16 v[222:223], v132 offset:29696
    s_waitcnt lgkmcnt(0)
    ds_read_b64_tr_b16 v[224:225], v132 offset:32768
    ds_read_b64_tr_b16 v[226:227], v132 offset:33792
    ds_read_b64_tr_b16 v[228:229], v132 offset:36864
    ds_read_b64_tr_b16 v[230:231], v132 offset:37888
    ds_read_b64_tr_b16 v[232:233], v132 offset:40960
    ds_read_b64_tr_b16 v[234:235], v132 offset:41984
    ds_read_b64_tr_b16 v[236:237], v132 offset:45056
    ds_read_b64_tr_b16 v[238:239], v132 offset:46080
    s_waitcnt lgkmcnt(0)
    ds_read_b64_tr_b16 v[240:241], v132 offset:49152
    ds_read_b64_tr_b16 v[242:243], v132 offset:50176
    ds_read_b64_tr_b16 v[244:245], v132 offset:53248
    ds_read_b64_tr_b16 v[246:247], v132 offset:54272
    ds_read_b64_tr_b16 v[248:249], v132 offset:57344
    ds_read_b64_tr_b16 v[250:251], v132 offset:58368
    ds_read_b64_tr_b16 v[252:253], v132 offset:61440
    ds_read_b64_tr_b16 v[254:255], v132 offset:62464
    s_waitcnt lgkmcnt(0)
    ds_read_b64_tr_b16 a[0:1], v133 offset:0
    ds_read_b64_tr_b16 a[2:3], v133 offset:1024
    ds_read_b64_tr_b16 a[4:5], v133 offset:4096
    ds_read_b64_tr_b16 a[6:7], v133 offset:5120
    ds_read_b64_tr_b16 a[8:9], v133 offset:8192
    ds_read_b64_tr_b16 a[10:11], v133 offset:9216
    ds_read_b64_tr_b16 a[12:13], v133 offset:12288
    ds_read_b64_tr_b16 a[14:15], v133 offset:13312
    s_waitcnt lgkmcnt(0)
    ds_read_b64_tr_b16 a[16:17], v133 offset:16384
    ds_read_b64_tr_b16 a[18:19], v133 offset:17408
    ds_read_b64_tr_b16 a[20:21], v133 offset:20480
    ds_read_b64_tr_b16 a[22:23], v133 offset:21504
    ds_read_b64_tr_b16 a[24:25], v133 offset:24576
    ds_read_b64_tr_b16 a[26:27], v133 offset:25600
    ds_read_b64_tr_b16 a[28:29], v133 offset:28672
    ds_read_b64_tr_b16 a[30:31], v133 offset:29696
    s_waitcnt lgkmcnt(0)
    ds_read_b64_tr_b16 a[32:33], v133 offset:32768
    ds_read_b64_tr_b16 a[34:35], v133 offset:33792
    ds_read_b64_tr_b16 a[36:37], v133 offset:36864
    ds_read_b64_tr_b16 a[38:39], v133 offset:37888
    ds_read_b64_tr_b16 a[40:41], v133 offset:40960
    ds_read_b64_tr_b16 a[42:43], v133 offset:41984
    ds_read_b64_tr_b16 a[44:45], v133 offset:45056
    ds_read_b64_tr_b16 a[46:47], v133 offset:46080
    s_waitcnt lgkmcnt(0)
    ds_read_b64_tr_b16 a[48:49], v133 offset:49152
    ds_read_b64_tr_b16 a[50:51], v133 offset:50176
    ds_read_b64_tr_b16 a[52:53], v133 offset:53248
    ds_read_b64_tr_b16 a[54:55], v133 offset:54272
    ds_read_b64_tr_b16 a[56:57], v133 offset:57344
    ds_read_b64_tr_b16 a[58:59], v133 offset:58368
    ds_read_b64_tr_b16 a[60:61], v133 offset:61440
    ds_read_b64_tr_b16 a[62:63], v133 offset:62464
    s_waitcnt lgkmcnt(0)
    ds_read_b64_tr_b16 a[64:65], v134 offset:0
    ds_read_b64_tr_b16 a[66:67], v134 offset:1024
    ds_read_b64_tr_b16 a[68:69], v134 offset:4096
    ds_read_b64_tr_b16 a[70:71], v134 offset:5120
    ds_read_b64_tr_b16 a[72:73], v134 offset:8192
    ds_read_b64_tr_b16 a[74:75], v134 offset:9216
    ds_read_b64_tr_b16 a[76:77], v134 offset:12288
    ds_read_b64_tr_b16 a[78:79], v134 offset:13312
    s_waitcnt lgkmcnt(0)
    ds_read_b64_tr_b16 a[80:81], v134 offset:16384
    ds_read_b64_tr_b16 a[82:83], v134 offset:17408
    ds_read_b64_tr_b16 a[84:85], v134 offset:20480
    ds_read_b64_tr_b16 a[86:87], v134 offset:21504
    ds_read_b64_tr_b16 a[88:89], v134 offset:24576
    ds_read_b64_tr_b16 a[90:91], v134 offset:25600
    ds_read_b64_tr_b16 a[92:93], v134 offset:28672
    ds_read_b64_tr_b16 a[94:95], v134 offset:29696
    s_waitcnt lgkmcnt(0)
    s_waitcnt lgkmcnt(0)
    s_barrier
    s_mul_i32 s65, s4, 10240
    s_add_u32 s53, s65, 134217728
    s_mov_b32 s54, 40960
    s_mov_b32 s52, s50
    s_mov_b32 s59, 0
    s_mov_b32 s79, 72327424
    s_waitcnt vmcnt(0)
    s_cmp_lg_u32 s4, 0
    s_cbranch_scc1 L_wcok_a0
    v_min_u32 v128, 0, v0
    v_lshlrev_b32 v128, 2, v128
L_wc_a0:
    buffer_load_dword v129, v128, s[8:11], s79 offen sc1
    s_waitcnt vmcnt(0)
    v_cmp_gt_u32 vcc, 32, v129
    s_cbranch_vccz L_wcok_a0
    s_sleep 8
    s_cmp_eq_u32 s46, 0
    s_cbranch_scc1 L_wcok_a0
    s_sub_u32 s46, s46, 1
    s_branch L_wc_a0
L_wcok_a0:
    s_barrier
    s_mul_i32 s65, s52, s54
    s_add_u32 s65, s65, s53
    s_mul_i32 s66, s59, 40960
    s_mul_i32 s67, s4, 10240
    s_add_u32 s66, s66, s67
    s_add_u32 m0, s66, 0
    s_nop 0
    buffer_load_dwordx4 v1, s[8:11], s65 offen sc1 lds
    s_add_u32 s65, s65, 1024
    s_add_u32 m0, s66, 1024
    s_nop 0
    buffer_load_dwordx4 v1, s[8:11], s65 offen sc1 lds
    s_add_u32 s65, s65, 1024
    s_add_u32 m0, s66, 2048
    s_nop 0
    buffer_load_dwordx4 v1, s[8:11], s65 offen sc1 lds
    s_add_u32 s65, s65, 1024
    s_add_u32 m0, s66, 3072
    s_nop 0
    buffer_load_dwordx4 v1, s[8:11], s65 offen sc1 lds
    s_add_u32 s65, s65, 1024
    s_add_u32 m0, s66, 4096
    s_nop 0
    buffer_load_dwordx4 v1, s[8:11], s65 offen sc1 lds
    s_add_u32 s65, s65, 1024
    s_add_u32 m0, s66, 5120
    s_nop 0
    buffer_load_dwordx4 v1, s[8:11], s65 offen sc1 lds
    s_add_u32 s65, s65, 1024
    s_add_u32 m0, s66, 6144
    s_nop 0
    buffer_load_dwordx4 v1, s[8:11], s65 offen sc1 lds
    s_add_u32 s65, s65, 1024
    s_add_u32 m0, s66, 7168
    s_nop 0
    buffer_load_dwordx4 v1, s[8:11], s65 offen sc1 lds
    s_add_u32 s65, s65, 1024
    s_add_u32 m0, s66, 8192
    s_nop 0
    buffer_load_dwordx4 v1, s[8:11], s65 offen sc1 lds
    s_add_u32 s65, s65, 1024
    s_add_u32 m0, s66, 9216
    s_nop 0
    buffer_load_dwordx4 v1, s[8:11], s65 offen sc1 lds
    s_add_u32 s65, s65, 1024
    s_mov_b32 s51, s50
L_g3_a:
    s_add_u32 s52, s51, 2
    s_cmp_ge_u32 s52, 64
    s_cbranch_scc1 L_g3nf_a
    s_add_u32 s77, s59, 1
    s_cmp_eq_u32 s77, 3
    s_cselect_b32 s77, 0, s77
    s_mov_b32 s78, s59
    s_mov_b32 s59, s77
    s_mov_b32 s79, 72327424
    s_waitcnt vmcnt(0)
    s_cmp_lg_u32 s4, 0
    s_cbranch_scc1 L_wcok_a1
    v_min_u32 v128, 0, v0
    v_lshlrev_b32 v128, 2, v128
L_wc_a1:
    buffer_load_dword v129, v128, s[8:11], s79 offen sc1
    s_waitcnt vmcnt(0)
    v_cmp_gt_u32 vcc, 32, v129
    s_cbranch_vccz L_wcok_a1
    s_sleep 8
    s_cmp_eq_u32 s46, 0
    s_cbranch_scc1 L_wcok_a1
    s_sub_u32 s46, s46, 1
    s_branch L_wc_a1
L_wcok_a1:
    s_barrier
    s_mul_i32 s65, s52, s54
    s_add_u32 s65, s65, s53
    s_mul_i32 s66, s59, 40960
    s_mul_i32 s67, s4, 10240
    s_add_u32 s66, s66, s67
    s_add_u32 m0, s66, 0
    s_nop 0
    buffer_load_dwordx4 v1, s[8:11], s65 offen sc1 lds
    s_add_u32 s65, s65, 1024
    s_add_u32 m0, s66, 1024
    s_nop 0
    buffer_load_dwordx4 v1, s[8:11], s65 offen sc1 lds
    s_add_u32 s65, s65, 1024
    s_add_u32 m0, s66, 2048
    s_nop 0
    buffer_load_dwordx4 v1, s[8:11], s65 offen sc1 lds
    s_add_u32 s65, s65, 1024
    s_add_u32 m0, s66, 3072
    s_nop 0
    buffer_load_dwordx4 v1, s[8:11], s65 offen sc1 lds
    s_add_u32 s65, s65, 1024
    s_add_u32 m0, s66, 4096
    s_nop 0
    buffer_load_dwordx4 v1, s[8:11], s65 offen sc1 lds
    s_add_u32 s65, s65, 1024
    s_add_u32 m0, s66, 5120
    s_nop 0
    buffer_load_dwordx4 v1, s[8:11], s65 offen sc1 lds
    s_add_u32 s65, s65, 1024
    s_add_u32 m0, s66, 6144
    s_nop 0
    buffer_load_dwordx4 v1, s[8:11], s65 offen sc1 lds
    s_add_u32 s65, s65, 1024
    s_add_u32 m0, s66, 7168
    s_nop 0
    buffer_load_dwordx4 v1, s[8:11], s65 offen sc1 lds
    s_add_u32 s65, s65, 1024
    s_add_u32 m0, s66, 8192
    s_nop 0
    buffer_load_dwordx4 v1, s[8:11], s65 offen sc1 lds
    s_add_u32 s65, s65, 1024
    s_add_u32 m0, s66, 9216
    s_nop 0
    buffer_load_dwordx4 v1, s[8:11], s65 offen sc1 lds
    s_add_u32 s65, s65, 1024
    s_mov_b32 s77, s59
    s_mov_b32 s59, s78
    s_waitcnt vmcnt(10)
    s_branch L_g3go_a
L_g3nf_a:
    s_mov_b32 s77, s59
    s_waitcnt vmcnt(0)
L_g3go_a:
    s_barrier
    s_mul_i32 s65, s59, 40960
    v_add_u32 v136, s65, v1
    s_mov_b32 s59, s77
    ds_read_b128 v[32:35], v136 offset:0
    ds_read_b128 v[36:39], v136 offset:1024
    ds_read_b128 v[40:43], v136 offset:2048
    s_waitcnt lgkmcnt(2)
    v_mfma_f32_32x32x16_bf16 v[64:79], v[192:195], v[32:35], 0
    ds_read_b128 v[44:47], v136 offset:3072
    s_waitcnt lgkmcnt(2)
    v_mfma_f32_32x32x16_bf16 v[64:79], v[196:199], v[36:39], v[64:79]
    ds_read_b128 v[32:35], v136 offset:4096
    s_waitcnt lgkmcnt(2)
    v_mfma_f32_32x32x16_bf16 v[64:79], v[200:203], v[40:43], v[64:79]
    ds_read_b128 v[36:39], v136 offset:5120
    s_waitcnt lgkmcnt(2)
    v_mfma_f32_32x32x16_bf16 v[64:79], v[204:207], v[44:47], v[64:79]
    ds_read_b128 v[40:43], v136 offset:6144
    s_waitcnt lgkmcnt(2)
    v_mfma_f32_32x32x16_bf16 v[64:79], v[208:211], v[32:35], v[64:79]
    ds_read_b128 v[44:47], v136 offset:7168
    s_waitcnt lgkmcnt(2)
    v_mfma_f32_32x32x16_bf16 v[64:79], v[212:215], v[36:39], v[64:79]
    ds_read_b128 v[32:35], v136 offset:8192
    s_waitcnt lgkmcnt(2)
    v_mfma_f32_32x32x16_bf16 v[64:79], v[216:219], v[40:43], v[64:79]
    ds_read_b128 v[36:39], v136 offset:9216
    s_waitcnt lgkmcnt(2)
    v_mfma_f32_32x32x16_bf16 v[64:79], v[220:223], v[44:47], v[64:79]
    ds_read_b128 v[40:43], v136 offset:10240
    s_waitcnt lgkmcnt(2)
    v_mfma_f32_32x32x16_bf16 v[64:79], v[224:227], v[32:35], v[64:79]
    ds_read_b128 v[44:47], v136 offset:11264
    s_waitcnt lgkmcnt(2)
    v_mfma_f32_32x32x16_bf16 v[64:79], v[228:231], v[36:39], v[64:79]
    ds_read_b128 v[32:35], v136 offset:12288
    s_waitcnt lgkmcnt(2)
    v_mfma_f32_32x32x16_bf16 v[64:79], v[232:235], v[40:43], v[64:79]
    ds_read_b128 v[36:39], v136 offset:13312
    s_waitcnt lgkmcnt(2)
    v_mfma_f32_32x32x16_bf16 v[64:79], v[236:239], v[44:47], v[64:79]
    ds_read_b128 v[40:43], v136 offset:14336
    s_waitcnt lgkmcnt(2)
    v_mfma_f32_32x32x16_bf16 v[64:79], v[240:243], v[32:35], v[64:79]
    ds_read_b128 v[44:47], v136 offset:15360
    s_waitcnt lgkmcnt(2)
    v_mfma_f32_32x32x16_bf16 v[64:79], v[244:247], v[36:39], v[64:79]
    ds_read_b128 v[32:35], v136 offset:16384
    s_waitcnt lgkmcnt(2)
    v_mfma_f32_32x32x16_bf16 v[64:79], v[248:251], v[40:43], v[64:79]
    ds_read_b128 v[36:39], v136 offset:17408
    s_waitcnt lgkmcnt(2)
    v_mfma_f32_32x32x16_bf16 v[64:79], v[252:255], v[44:47], v[64:79]
    ds_read_b128 v[40:43], v136 offset:18432
    s_waitcnt lgkmcnt(2)
    v_mfma_f32_32x32x16_bf16 v[64:79], a[0:3], v[32:35], v[64:79]
    ds_read_b128 v[44:47], v136 offset:19456
    s_waitcnt lgkmcnt(2)
    v_mfma_f32_32x32x16_bf16 v[64:79], a[4:7], v[36:39], v[64:79]
    ds_read_b128 v[32:35], v136 offset:20480
    s_waitcnt lgkmcnt(2)
    v_mfma_f32_32x32x16_bf16 v[64:79], a[8:11], v[40:43], v[64:79]
    ds_read_b128 v[36:39], v136 offset:21504
    s_waitcnt lgkmcnt(2)
    v_mfma_f32_32x32x16_bf16 v[64:79], a[12:15], v[44:47], v[64:79]
    ds_read_b128 v[40:43], v136 offset:22528
    s_waitcnt lgkmcnt(2)
    v_mfma_f32_32x32x16_bf16 v[64:79], a[16:19], v[32:35], v[64:79]
    ds_read_b128 v[44:47], v136 offset:23552
    s_waitcnt lgkmcnt(2)
    v_mfma_f32_32x32x16_bf16 v[64:79], a[20:23], v[36:39], v[64:79]
    ds_read_b128 v[32:35], v136 offset:24576
    s_waitcnt lgkmcnt(2)
    v_mfma_f32_32x32x16_bf16 v[64:79], a[24:27], v[40:43], v[64:79]
    ds_read_b128 v[36:39], v136 offset:25600
    s_waitcnt lgkmcnt(2)
    v_mfma_f32_32x32x16_bf16 v[64:79], a[28:31], v[44:47], v[64:79]
    ds_read_b128 v[40:43], v136 offset:26624
    s_waitcnt lgkmcnt(2)
    v_mfma_f32_32x32x16_bf16 v[64:79], a[32:35], v[32:35], v[64:79]
    ds_read_b128 v[44:47], v136 offset:27648
    s_waitcnt lgkmcnt(2)
    v_mfma_f32_32x32x16_bf16 v[64:79], a[36:39], v[36:39], v[64:79]
    ds_read_b128 v[32:35], v136 offset:28672
    s_waitcnt lgkmcnt(2)
    v_mfma_f32_32x32x16_bf16 v[64:79], a[40:43], v[40:43], v[64:79]
    ds_read_b128 v[36:39], v136 offset:29696
    s_waitcnt lgkmcnt(2)
    v_mfma_f32_32x32x16_bf16 v[64:79], a[44:47], v[44:47], v[64:79]
    ds_read_b128 v[40:43], v136 offset:30720
    s_waitcnt lgkmcnt(2)
    v_mfma_f32_32x32x16_bf16 v[64:79], a[48:51], v[32:35], v[64:79]
    ds_read_b128 v[44:47], v136 offset:31744
    s_waitcnt lgkmcnt(2)
    v_mfma_f32_32x32x16_bf16 v[64:79], a[52:55], v[36:39], v[64:79]
    ds_read_b128 v[32:35], v136 offset:32768
    s_waitcnt lgkmcnt(2)
    v_mfma_f32_32x32x16_bf16 v[64:79], a[56:59], v[40:43], v[64:79]
    ds_read_b128 v[36:39], v136 offset:33792
    s_waitcnt lgkmcnt(2)
    v_mfma_f32_32x32x16_bf16 v[64:79], a[60:63], v[44:47], v[64:79]
    ds_read_b128 v[40:43], v136 offset:34816
    s_waitcnt lgkmcnt(2)
    v_mfma_f32_32x32x16_bf16 v[64:79], a[64:67], v[32:35], v[64:79]
    ds_read_b128 v[44:47], v136 offset:35840
    s_waitcnt lgkmcnt(2)
    v_mfma_f32_32x32x16_bf16 v[64:79], a[68:71], v[36:39], v[64:79]
    ds_read_b128 v[32:35], v136 offset:36864
    s_waitcnt lgkmcnt(2)
    v_mfma_f32_32x32x16_bf16 v[64:79], a[72:75], v[40:43], v[64:79]
    ds_read_b128 v[36:39], v136 offset:37888
    s_waitcnt lgkmcnt(2)
    v_mfma_f32_32x32x16_bf16 v[64:79], a[76:79], v[44:47], v[64:79]
    ds_read_b128 v[40:43], v136 offset:38912
    s_waitcnt lgkmcnt(2)
    v_mfma_f32_32x32x16_bf16 v[64:79], a[80:83], v[32:35], v[64:79]
    ds_read_b128 v[44:47], v136 offset:39936
    s_waitcnt lgkmcnt(2)
    v_mfma_f32_32x32x16_bf16 v[64:79], a[84:87], v[36:39], v[64:79]
    s_waitcnt lgkmcnt(1)
    v_mfma_f32_32x32x16_bf16 v[64:79], a[88:91], v[40:43], v[64:79]
    s_waitcnt lgkmcnt(0)
    v_mfma_f32_32x32x16_bf16 v[64:79], a[92:95], v[44:47], v[64:79]
    s_mul_i32 s65, s51, 737280
    s_add_u32 s65, s65, s55
    s_nop 9
    buffer_store_dwordx4 v[64:67], v1, s[8:11], s65 offen offset:0 sc1
    buffer_store_dwordx4 v[68:71], v1, s[8:11], s65 offen offset:1024 sc1
    buffer_store_dwordx4 v[72:75], v1, s[8:11], s65 offen offset:2048 sc1
    buffer_store_dwordx4 v[76:79], v1, s[8:11], s65 offen offset:3072 sc1
    s_waitcnt vmcnt(0)
    s_barrier
    s_mul_i32 s79, s51, 640
    s_add_u32 s79, s79, s57
    s_cmp_lg_u32 s4, 0
    s_cbranch_scc1 L_ai_ao
    v_mov_b32 v128, 0
    v_mov_b32 v129, 1
    s_mov_b64 exec, 1
    buffer_atomic_add v129, v128, s[8:11], s79 offen sc1
    s_mov_b64 exec, -1
L_ai_ao:
    s_add_u32 s51, s51, 2
    s_cmp_lt_u32 s51, 64
    s_cbranch_scc1 L_g3_a
L_g3role_done:
    s_branch L_end
L_g1_to_red:
    s_sub_u32 s101, s100, 90
    s_branch L_reducer
L_abranch:
L_gw_a:
    v_mov_b32 v128, 96
    global_load_dword v129, v128, s[42:43] sc1
    s_waitcnt vmcnt(0)
    v_readfirstlane_b32 s68, v129
    s_cmp_ge_u32 s68, 128
    s_cbranch_scc1 L_gwok_a
    s_cmp_eq_u32 s46, 0
    s_cbranch_scc1 L_gwok_a
    s_sub_u32 s46, s46, 1
    s_branch L_gw_a
L_gwok_a:
    s_sub_u32 s101, s100, 96
    s_cmp_ge_u32 s4, 2
    s_cbranch_scc1 L_gate_done
    s_mov_b32 s52, s16
    s_and_b32 s53, s17, 0xffff
    s_mov_b32 s54, 0x280000
    s_mov_b32 s55, 0x20000
    s_mov_b32 s56, s38
    s_and_b32 s57, s39, 0xffff
    s_mov_b32 s58, 0x500
    s_mov_b32 s59, 0x20000
    v_and_b32 v128, 31, v0
    v_mul_u32_u24 v129, 1280, v128
    v_lshrrev_b32 v130, 5, v0
    v_lshl_add_u32 v129, v130, 4, v129
    v_lshlrev_b32 v131, 4, v130
    v_mov_b32 v132, 0x80000000
    v_cmp_eq_u32 vcc, 0, v128
    s_nop 1
    v_cndmask_b32 v131, v132, v131, vcc
    s_lshl_b32 s65, s101, 1
    s_add_u32 s65, s65, s4
    s_mul_i32 s66, s65, 40960
    buffer_load_dwordx4 v[32:35], v129, s[52:55], s66 offen offset:0
    buffer_load_dwordx4 v[36:39], v129, s[52:55], s66 offen offset:32
    buffer_load_dwordx4 v[40:43], v129, s[52:55], s66 offen offset:64
    buffer_load_dwordx4 v[44:47], v129, s[52:55], s66 offen offset:96
    buffer_load_dwordx4 v[48:51], v129, s[52:55], s66 offen offset:128
    buffer_load_dwordx4 v[52:55], v129, s[52:55], s66 offen offset:160
    buffer_load_dwordx4 v[56:59], v129, s[52:55], s66 offen offset:192
    buffer_load_dwordx4 v[60:63], v129, s[52:55], s66 offen offset:224
    buffer_load_dwordx4 v[64:67], v129, s[52:55], s66 offen offset:256
    buffer_load_dwordx4 v[68:71], v129, s[52:55], s66 offen offset:288
    buffer_load_dwordx4 v[72:75], v129, s[52:55], s66 offen offset:320
    buffer_load_dwordx4 v[76:79], v129, s[52:55], s66 offen offset:352
    buffer_load_dwordx4 v[80:83], v129, s[52:55], s66 offen offset:384
    buffer_load_dwordx4 v[84:87], v129, s[52:55], s66 offen offset:416
    buffer_load_dwordx4 v[88:91], v129, s[52:55], s66 offen offset:448
    buffer_load_dwordx4 v[92:95], v129, s[52:55], s66 offen offset:480
    buffer_load_dwordx4 v[96:99], v129, s[52:55], s66 offen offset:512
    buffer_load_dwordx4 v[100:103], v129, s[52:55], s66 offen offset:544
    buffer_load_dwordx4 v[104:107], v129, s[52:55], s66 offen offset:576
    buffer_load_dwordx4 v[108:111], v129, s[52:55], s66 offen offset:608
    buffer_load_dwordx4 v[192:195], v131, s[56:59], 0 offen offset:0
    buffer_load_dwordx4 v[196:199], v131, s[56:59], 0 offen offset:32
    buffer_load_dwordx4 v[200:203], v131, s[56:59], 0 offen offset:64
    buffer_load_dwordx4 v[204:207], v131, s[56:59], 0 offen offset:96
    buffer_load_dwordx4 v[208:211], v131, s[56:59], 0 offen offset:128
    buffer_load_dwordx4 v[212:215], v131, s[56:59], 0 offen offset:160
    buffer_load_dwordx4 v[216:219], v131, s[56:59], 0 offen offset:192
    buffer_load_dwordx4 v[220:223], v131, s[56:59], 0 offen offset:224
    buffer_load_dwordx4 v[224:227], v131, s[56:59], 0 offen offset:256
    buffer_load_dwordx4 v[228:231], v131, s[56:59], 0 offen offset:288
    buffer_load_dwordx4 v[232:235], v131, s[56:59], 0 offen offset:320
    buffer_load_dwordx4 v[236:239], v131, s[56:59], 0 offen offset:352
    buffer_load_dwordx4 v[240:243], v131, s[56:59], 0 offen offset:384
    buffer_load_dwordx4 v[244:247], v131, s[56:59], 0 offen offset:416
    buffer_load_dwordx4 v[248:251], v131, s[56:59], 0 offen offset:448
    buffer_load_dwordx4 v[252:255], v131, s[56:59], 0 offen offset:480
    buffer_load_dwordx4 v[112:115], v131, s[56:59], 0 offen offset:512
    buffer_load_dwordx4 v[116:119], v131, s[56:59], 0 offen offset:544
    buffer_load_dwordx4 v[120:123], v131, s[56:59], 0 offen offset:576
    buffer_load_dwordx4 v[124:127], v131, s[56:59], 0 offen offset:608
    s_waitcnt vmcnt(0)
    v_mfma_f32_32x32x16_bf16 v[8:23], v[192:195], v[32:35], 0
    v_mfma_f32_32x32x16_bf16 v[8:23], v[196:199], v[36:39], v[8:23]
    v_mfma_f32_32x32x16_bf16 v[8:23], v[200:203], v[40:43], v[8:23]
    v_mfma_f32_32x32x16_bf16 v[8:23], v[204:207], v[44:47], v[8:23]
    v_mfma_f32_32x32x16_bf16 v[8:23], v[208:211], v[48:51], v[8:23]
    v_mfma_f32_32x32x16_bf16 v[8:23], v[212:215], v[52:55], v[8:23]
    v_mfma_f32_32x32x16_bf16 v[8:23], v[216:219], v[56:59], v[8:23]
    v_mfma_f32_32x32x16_bf16 v[8:23], v[220:223], v[60:63], v[8:23]
    v_mfma_f32_32x32x16_bf16 v[8:23], v[224:227], v[64:67], v[8:23]
    v_mfma_f32_32x32x16_bf16 v[8:23], v[228:231], v[68:71], v[8:23]
    v_mfma_f32_32x32x16_bf16 v[8:23], v[232:235], v[72:75], v[8:23]
    v_mfma_f32_32x32x16_bf16 v[8:23], v[236:239], v[76:79], v[8:23]
    v_mfma_f32_32x32x16_bf16 v[8:23], v[240:243], v[80:83], v[8:23]
    v_mfma_f32_32x32x16_bf16 v[8:23], v[244:247], v[84:87], v[8:23]
    v_mfma_f32_32x32x16_bf16 v[8:23], v[248:251], v[88:91], v[8:23]
    v_mfma_f32_32x32x16_bf16 v[8:23], v[252:255], v[92:95], v[8:23]
    v_mfma_f32_32x32x16_bf16 v[8:23], v[112:115], v[96:99], v[8:23]
    v_mfma_f32_32x32x16_bf16 v[8:23], v[116:119], v[100:103], v[8:23]
    v_mfma_f32_32x32x16_bf16 v[8:23], v[120:123], v[104:107], v[8:23]
    v_mfma_f32_32x32x16_bf16 v[8:23], v[124:127], v[108:111], v[8:23]
    s_nop 7
    buffer_load_dwordx4 v[32:35], v129, s[52:55], s66 offen offset:640
    buffer_load_dwordx4 v[36:39], v129, s[52:55], s66 offen offset:672
    buffer_load_dwordx4 v[40:43], v129, s[52:55], s66 offen offset:704
    buffer_load_dwordx4 v[44:47], v129, s[52:55], s66 offen offset:736
    buffer_load_dwordx4 v[48:51], v129, s[52:55], s66 offen offset:768
    buffer_load_dwordx4 v[52:55], v129, s[52:55], s66 offen offset:800
    buffer_load_dwordx4 v[56:59], v129, s[52:55], s66 offen offset:832
    buffer_load_dwordx4 v[60:63], v129, s[52:55], s66 offen offset:864
    buffer_load_dwordx4 v[64:67], v129, s[52:55], s66 offen offset:896
    buffer_load_dwordx4 v[68:71], v129, s[52:55], s66 offen offset:928
    buffer_load_dwordx4 v[72:75], v129, s[52:55], s66 offen offset:960
    buffer_load_dwordx4 v[76:79], v129, s[52:55], s66 offen offset:992
    buffer_load_dwordx4 v[80:83], v129, s[52:55], s66 offen offset:1024
    buffer_load_dwordx4 v[84:87], v129, s[52:55], s66 offen offset:1056
    buffer_load_dwordx4 v[88:91], v129, s[52:55], s66 offen offset:1088
    buffer_load_dwordx4 v[92:95], v129, s[52:55], s66 offen offset:1120
    buffer_load_dwordx4 v[96:99], v129, s[52:55], s66 offen offset:1152
    buffer_load_dwordx4 v[100:103], v129, s[52:55], s66 offen offset:1184
    buffer_load_dwordx4 v[104:107], v129, s[52:55], s66 offen offset:1216
    buffer_load_dwordx4 v[108:111], v129, s[52:55], s66 offen offset:1248
    buffer_load_dwordx4 v[192:195], v131, s[56:59], 0 offen offset:640
    buffer_load_dwordx4 v[196:199], v131, s[56:59], 0 offen offset:672
    buffer_load_dwordx4 v[200:203], v131, s[56:59], 0 offen offset:704
    buffer_load_dwordx4 v[204:207], v131, s[56:59], 0 offen offset:736
    buffer_load_dwordx4 v[208:211], v131, s[56:59], 0 offen offset:768
    buffer_load_dwordx4 v[212:215], v131, s[56:59], 0 offen offset:800
    buffer_load_dwordx4 v[216:219], v131, s[56:59], 0 offen offset:832
    buffer_load_dwordx4 v[220:223], v131, s[56:59], 0 offen offset:864
    buffer_load_dwordx4 v[224:227], v131, s[56:59], 0 offen offset:896
    buffer_load_dwordx4 v[228:231], v131, s[56:59], 0 offen offset:928
    buffer_load_dwordx4 v[232:235], v131, s[56:59], 0 offen offset:960
    buffer_load_dwordx4 v[236:239], v131, s[56:59], 0 offen offset:992
    buffer_load_dwordx4 v[240:243], v131, s[56:59], 0 offen offset:1024
    buffer_load_dwordx4 v[244:247], v131, s[56:59], 0 offen offset:1056
    buffer_load_dwordx4 v[248:251], v131, s[56:59], 0 offen offset:1088
    buffer_load_dwordx4 v[252:255], v131, s[56:59], 0 offen offset:1120
    buffer_load_dwordx4 v[112:115], v131, s[56:59], 0 offen offset:1152
    buffer_load_dwordx4 v[116:119], v131, s[56:59], 0 offen offset:1184
    buffer_load_dwordx4 v[120:123], v131, s[56:59], 0 offen offset:1216
    buffer_load_dwordx4 v[124:127], v131, s[56:59], 0 offen offset:1248
    s_waitcnt vmcnt(0)
    v_mfma_f32_32x32x16_bf16 v[8:23], v[192:195], v[32:35], v[8:23]
    v_mfma_f32_32x32x16_bf16 v[8:23], v[196:199], v[36:39], v[8:23]
    v_mfma_f32_32x32x16_bf16 v[8:23], v[200:203], v[40:43], v[8:23]
    v_mfma_f32_32x32x16_bf16 v[8:23], v[204:207], v[44:47], v[8:23]
    v_mfma_f32_32x32x16_bf16 v[8:23], v[208:211], v[48:51], v[8:23]
    v_mfma_f32_32x32x16_bf16 v[8:23], v[212:215], v[52:55], v[8:23]
    v_mfma_f32_32x32x16_bf16 v[8:23], v[216:219], v[56:59], v[8:23]
    v_mfma_f32_32x32x16_bf16 v[8:23], v[220:223], v[60:63], v[8:23]
    v_mfma_f32_32x32x16_bf16 v[8:23], v[224:227], v[64:67], v[8:23]
    v_mfma_f32_32x32x16_bf16 v[8:23], v[228:231], v[68:71], v[8:23]
    v_mfma_f32_32x32x16_bf16 v[8:23], v[232:235], v[72:75], v[8:23]
    v_mfma_f32_32x32x16_bf16 v[8:23], v[236:239], v[76:79], v[8:23]
    v_mfma_f32_32x32x16_bf16 v[8:23], v[240:243], v[80:83], v[8:23]
    v_mfma_f32_32x32x16_bf16 v[8:23], v[244:247], v[84:87], v[8:23]
    v_mfma_f32_32x32x16_bf16 v[8:23], v[248:251], v[88:91], v[8:23]
    v_mfma_f32_32x32x16_bf16 v[8:23], v[252:255], v[92:95], v[8:23]
    v_mfma_f32_32x32x16_bf16 v[8:23], v[112:115], v[96:99], v[8:23]
    v_mfma_f32_32x32x16_bf16 v[8:23], v[116:119], v[100:103], v[8:23]
    v_mfma_f32_32x32x16_bf16 v[8:23], v[120:123], v[104:107], v[8:23]
    v_mfma_f32_32x32x16_bf16 v[8:23], v[124:127], v[108:111], v[8:23]
    s_nop 7
    s_nop 3
    v_mul_f32 v8, 0xbfb8aa3b, v8
    v_exp_f32 v8, v8
    s_nop 0
    v_add_f32 v8, 1.0, v8
    v_rcp_f32 v8, v8
    v_lshlrev_b32 v133, 2, v128
    v_mov_b32 v132, 0x80000000
    v_cmp_gt_u32 vcc, 32, v0
    s_nop 1
    v_cndmask_b32 v133, v132, v133, vcc
    s_lshl_b32 s65, s65, 7
    s_add_u32 s65, s65, 138412032
    buffer_store_dword v8, v133, s[8:11], s65 offen sc1
    s_waitcnt vmcnt(0)
L_gate_done:
    s_barrier
    s_mov_b32 s79, 72327552
    s_cmp_lg_u32 s4, 0
    s_cbranch_scc1 L_ai_gate
    v_mov_b32 v128, 0
    v_mov_b32 v129, 1
    s_mov_b64 exec, 1
    buffer_atomic_add v129, v128, s[8:11], s79 offen sc1
    s_mov_b64 exec, -1
L_ai_gate:
    s_cmp_ge_u32 s101, 30
    s_cbranch_scc1 L_a1_skip
    s_cmp_ge_u32 s101, 15
    s_cselect_b32 s7, 1, 0
    s_mul_i32 s65, s7, 15
    s_sub_u32 s6, s101, s65
    s_mov_b32 s12, s18
    s_and_b32 s13, s19, 0xffff
    s_mov_b32 s14, 0x258000
    s_mov_b32 s15, 0x20000
    s_lshl_b32 s78, s6, 8
    s_mov_b32 s48, s16
    s_and_b32 s49, s17, 0xffff
    s_mov_b32 s50, 0x280000
    s_mov_b32 s51, 0x20000
    v_lshrrev_b32 v128, 4, v0
    v_mul_u32_u24 v128, 3840, v128
    v_and_b32 v129, 15, v0
    v_lshl_add_u32 v128, v129, 4, v128
    v_add_u32 v131, s78, v128
    s_mul_i32 s76, s4, 61440
    s_lshl_b32 s77, s4, 12
    s_add_u32 s65, s76, 0
    s_add_u32 s66, s77, 0
    s_mov_b32 m0, s66
    s_nop 0
    buffer_load_dwordx4 v131, s[12:15], s65 offen lds
    s_add_u32 s65, s76, 15360
    s_add_u32 s66, s77, 1024
    s_mov_b32 m0, s66
    s_nop 0
    buffer_load_dwordx4 v131, s[12:15], s65 offen lds
    s_add_u32 s65, s76, 30720
    s_add_u32 s66, s77, 2048
    s_mov_b32 m0, s66
    s_nop 0
    buffer_load_dwordx4 v131, s[12:15], s65 offen lds
    s_add_u32 s65, s76, 46080
    s_add_u32 s66, s77, 3072
    s_mov_b32 m0, s66
    s_nop 0
    buffer_load_dwordx4 v131, s[12:15], s65 offen lds
    s_add_u32 s65, s76, 245760
    s_add_u32 s66, s77, 16384
    s_mov_b32 m0, s66
    s_nop 0
    buffer_load_dwordx4 v131, s[12:15], s65 offen lds
    s_add_u32 s65, s76, 261120
    s_add_u32 s66, s77, 17408
    s_mov_b32 m0, s66
    s_nop 0
    buffer_load_dwordx4 v131, s[12:15], s65 offen lds
    s_add_u32 s65, s76, 276480
    s_add_u32 s66, s77, 18432
    s_mov_b32 m0, s66
    s_nop 0
    buffer_load_dwordx4 v131, s[12:15], s65 offen lds
    s_add_u32 s65, s76, 291840
    s_add_u32 s66, s77, 19456
    s_mov_b32 m0, s66
    s_nop 0
    buffer_load_dwordx4 v131, s[12:15], s65 offen lds
    s_add_u32 s65, s76, 491520
    s_add_u32 s66, s77, 32768
    s_mov_b32 m0, s66
    s_nop 0
    buffer_load_dwordx4 v131, s[12:15], s65 offen lds
    s_add_u32 s65, s76, 506880
    s_add_u32 s66, s77, 33792
    s_mov_b32 m0, s66
    s_nop 0
    buffer_load_dwordx4 v131, s[12:15], s65 offen lds
    s_add_u32 s65, s76, 522240
    s_add_u32 s66, s77, 34816
    s_mov_b32 m0, s66
    s_nop 0
    buffer_load_dwordx4 v131, s[12:15], s65 offen lds
    s_add_u32 s65, s76, 537600
    s_add_u32 s66, s77, 35840
    s_mov_b32 m0, s66
    s_nop 0
    buffer_load_dwordx4 v131, s[12:15], s65 offen lds
    s_add_u32 s65, s76, 737280
    s_add_u32 s66, s77, 49152
    s_mov_b32 m0, s66
    s_nop 0
    buffer_load_dwordx4 v131, s[12:15], s65 offen lds
    s_add_u32 s65, s76, 752640
    s_add_u32 s66, s77, 50176
    s_mov_b32 m0, s66
    s_nop 0
    buffer_load_dwordx4 v131, s[12:15], s65 offen lds
    s_add_u32 s65, s76, 768000
    s_add_u32 s66, s77, 51200
    s_mov_b32 m0, s66
    s_nop 0
    buffer_load_dwordx4 v131, s[12:15], s65 offen lds
    s_add_u32 s65, s76, 783360
    s_add_u32 s66, s77, 52224
    s_mov_b32 m0, s66
    s_nop 0
    buffer_load_dwordx4 v131, s[12:15], s65 offen lds
    s_add_u32 s65, s76, 983040
    s_add_u32 s66, s77, 65536
    s_mov_b32 m0, s66
    s_nop 0
    buffer_load_dwordx4 v131, s[12:15], s65 offen lds
    s_add_u32 s65, s76, 998400
    s_add_u32 s66, s77, 66560
    s_mov_b32 m0, s66
    s_nop 0
    buffer_load_dwordx4 v131, s[12:15], s65 offen lds
    s_add_u32 s65, s76, 1013760
    s_add_u32 s66, s77, 67584
    s_mov_b32 m0, s66
    s_nop 0
    buffer_load_dwordx4 v131, s[12:15], s65 offen lds
    s_add_u32 s65, s76, 1029120
    s_add_u32 s66, s77, 68608
    s_mov_b32 m0, s66
    s_nop 0
    buffer_load_dwordx4 v131, s[12:15], s65 offen lds
    s_add_u32 s65, s76, 1228800
    s_add_u32 s66, s77, 81920
    s_mov_b32 m0, s66
    s_nop 0
    buffer_load_dwordx4 v131, s[12:15], s65 offen lds
    s_add_u32 s65, s76, 1244160
    s_add_u32 s66, s77, 82944
    s_mov_b32 m0, s66
    s_nop 0
    buffer_load_dwordx4 v131, s[12:15], s65 offen lds
    s_add_u32 s65, s76, 1259520
    s_add_u32 s66, s77, 83968
    s_mov_b32 m0, s66
    s_nop 0
    buffer_load_dwordx4 v131, s[12:15], s65 offen lds
    s_add_u32 s65, s76, 1274880
    s_add_u32 s66, s77, 84992
    s_mov_b32 m0, s66
    s_nop 0
    buffer_load_dwordx4 v131, s[12:15], s65 offen lds
    s_add_u32 s65, s76, 1474560
    s_add_u32 s66, s77, 98304
    s_mov_b32 m0, s66
    s_nop 0
    buffer_load_dwordx4 v131, s[12:15], s65 offen lds
    s_add_u32 s65, s76, 1489920
    s_add_u32 s66, s77, 99328
    s_mov_b32 m0, s66
    s_nop 0
    buffer_load_dwordx4 v131, s[12:15], s65 offen lds
    s_add_u32 s65, s76, 1505280
    s_add_u32 s66, s77, 100352
    s_mov_b32 m0, s66
    s_nop 0
    buffer_load_dwordx4 v131, s[12:15], s65 offen lds
    s_add_u32 s65, s76, 1520640
    s_add_u32 s66, s77, 101376
    s_mov_b32 m0, s66
    s_nop 0
    buffer_load_dwordx4 v131, s[12:15], s65 offen lds
    s_add_u32 s65, s76, 1720320
    s_add_u32 s66, s77, 114688
    s_mov_b32 m0, s66
    s_nop 0
    buffer_load_dwordx4 v131, s[12:15], s65 offen lds
    s_add_u32 s65, s76, 1735680
    s_add_u32 s66, s77, 115712
    s_mov_b32 m0, s66
    s_nop 0
    buffer_load_dwordx4 v131, s[12:15], s65 offen lds
    s_add_u32 s65, s76, 1751040
    s_add_u32 s66, s77, 116736
    s_mov_b32 m0, s66
    s_nop 0
    buffer_load_dwordx4 v131, s[12:15], s65 offen lds
    s_add_u32 s65, s76, 1766400
    s_add_u32 s66, s77, 117760
    s_mov_b32 m0, s66
    s_nop 0
    buffer_load_dwordx4 v131, s[12:15], s65 offen lds
    s_add_u32 s65, s76, 1966080
    s_add_u32 s66, s77, 131072
    s_mov_b32 m0, s66
    s_nop 0
    buffer_load_dwordx4 v131, s[12:15], s65 offen lds
    s_add_u32 s65, s76, 1981440
    s_add_u32 s66, s77, 132096
    s_mov_b32 m0, s66
    s_nop 0
    buffer_load_dwordx4 v131, s[12:15], s65 offen lds
    s_add_u32 s65, s76, 1996800
    s_add_u32 s66, s77, 133120
    s_mov_b32 m0, s66
    s_nop 0
    buffer_load_dwordx4 v131, s[12:15], s65 offen lds
    s_add_u32 s65, s76, 2012160
    s_add_u32 s66, s77, 134144
    s_mov_b32 m0, s66
    s_nop 0
    buffer_load_dwordx4 v131, s[12:15], s65 offen lds
    s_add_u32 s65, s76, 2211840
    s_add_u32 s66, s77, 147456
    s_mov_b32 m0, s66
    s_nop 0
    buffer_load_dwordx4 v131, s[12:15], s65 offen lds
    s_add_u32 s65, s76, 2227200
    s_add_u32 s66, s77, 148480
    s_mov_b32 m0, s66
    s_nop 0
    buffer_load_dwordx4 v131, s[12:15], s65 offen lds
    s_add_u32 s65, s76, 2242560
    s_add_u32 s66, s77, 149504
    s_mov_b32 m0, s66
    s_nop 0
    buffer_load_dwordx4 v131, s[12:15], s65 offen lds
    s_add_u32 s65, s76, 2257920
    s_add_u32 s66, s77, 150528
    s_mov_b32 m0, s66
    s_nop 0
    buffer_load_dwordx4 v131, s[12:15], s65 offen lds
    v_lshrrev_b32 v128, 5, v0
    v_lshlrev_b32 v128, 3, v128
    v_bfe_u32 v129, v0, 2, 2
    v_add_u32 v128, v128, v129
    v_lshlrev_b32 v128, 8, v128
    v_bfe_u32 v129, v0, 4, 1
    v_lshl_add_u32 v128, v129, 5, v128
    v_and_b32 v129, 1, v0
    v_lshl_add_u32 v128, v129, 4, v128
    v_bfe_u32 v129, v0, 1, 1
    v_lshl_add_u32 v128, v129, 3, v128
    s_and_b32 s65, s4, 1
    s_lshl_b32 s65, s65, 7
    v_add_u32 v132, s65, v128
    v_add_u32 v133, 0x10000, v132
    v_add_u32 v134, 0x20000, v132
    s_waitcnt vmcnt(36)
    s_barrier
    ds_read_b64_tr_b16 v[192:193], v132 offset:0
    ds_read_b64_tr_b16 v[194:195], v132 offset:1024
    ds_read_b64_tr_b16 a[96:97], v132 offset:64
    ds_read_b64_tr_b16 a[98:99], v132 offset:1088
    ds_read_b64_tr_b16 v[196:197], v132 offset:4096
    ds_read_b64_tr_b16 v[198:199], v132 offset:5120
    ds_read_b64_tr_b16 a[100:101], v132 offset:4160
    ds_read_b64_tr_b16 a[102:103], v132 offset:5184
    ds_read_b64_tr_b16 v[200:201], v132 offset:8192
    ds_read_b64_tr_b16 v[202:203], v132 offset:9216
    ds_read_b64_tr_b16 a[104:105], v132 offset:8256
    ds_read_b64_tr_b16 a[106:107], v132 offset:9280
    ds_read_b64_tr_b16 v[204:205], v132 offset:12288
    ds_read_b64_tr_b16 v[206:207], v132 offset:13312
    ds_read_b64_tr_b16 a[108:109], v132 offset:12352
    ds_read_b64_tr_b16 a[110:111], v132 offset:13376
    s_waitcnt vmcnt(32)
    s_barrier
    ds_read_b64_tr_b16 v[208:209], v132 offset:16384
    ds_read_b64_tr_b16 v[210:211], v132 offset:17408
    ds_read_b64_tr_b16 a[112:113], v132 offset:16448
    ds_read_b64_tr_b16 a[114:115], v132 offset:17472
    ds_read_b64_tr_b16 v[212:213], v132 offset:20480
    ds_read_b64_tr_b16 v[214:215], v132 offset:21504
    ds_read_b64_tr_b16 a[116:117], v132 offset:20544
    ds_read_b64_tr_b16 a[118:119], v132 offset:21568
    ds_read_b64_tr_b16 v[216:217], v132 offset:24576
    ds_read_b64_tr_b16 v[218:219], v132 offset:25600
    ds_read_b64_tr_b16 a[120:121], v132 offset:24640
    ds_read_b64_tr_b16 a[122:123], v132 offset:25664
    ds_read_b64_tr_b16 v[220:221], v132 offset:28672
    ds_read_b64_tr_b16 v[222:223], v132 offset:29696
    ds_read_b64_tr_b16 a[124:125], v132 offset:28736
    ds_read_b64_tr_b16 a[126:127], v132 offset:29760
    s_waitcnt lgkmcnt(0)
    s_waitcnt vmcnt(28)
    s_barrier
    ds_read_b64_tr_b16 v[224:225], v132 offset:32768
    ds_read_b64_tr_b16 v[226:227], v132 offset:33792
    ds_read_b64_tr_b16 a[128:129], v132 offset:32832
    ds_read_b64_tr_b16 a[130:131], v132 offset:33856
    ds_read_b64_tr_b16 v[228:229], v132 offset:36864
    ds_read_b64_tr_b16 v[230:231], v132 offset:37888
    ds_read_b64_tr_b16 a[132:133], v132 offset:36928
    ds_read_b64_tr_b16 a[134:135], v132 offset:37952
    ds_read_b64_tr_b16 v[232:233], v132 offset:40960
    ds_read_b64_tr_b16 v[234:235], v132 offset:41984
    ds_read_b64_tr_b16 a[136:137], v132 offset:41024
    ds_read_b64_tr_b16 a[138:139], v132 offset:42048
    ds_read_b64_tr_b16 v[236:237], v132 offset:45056
    ds_read_b64_tr_b16 v[238:239], v132 offset:46080
    ds_read_b64_tr_b16 a[140:141], v132 offset:45120
    ds_read_b64_tr_b16 a[142:143], v132 offset:46144
    s_waitcnt vmcnt(24)
    s_barrier
    ds_read_b64_tr_b16 v[240:241], v132 offset:49152
    ds_read_b64_tr_b16 v[242:243], v132 offset:50176
    ds_read_b64_tr_b16 a[144:145], v132 offset:49216
    ds_read_b64_tr_b16 a[146:147], v132 offset:50240
    ds_read_b64_tr_b16 v[244:245], v132 offset:53248
    ds_read_b64_tr_b16 v[246:247], v132 offset:54272
    ds_read_b64_tr_b16 a[148:149], v132 offset:53312
    ds_read_b64_tr_b16 a[150:151], v132 offset:54336
    ds_read_b64_tr_b16 v[248:249], v132 offset:57344
    ds_read_b64_tr_b16 v[250:251], v132 offset:58368
    ds_read_b64_tr_b16 a[152:153], v132 offset:57408
    ds_read_b64_tr_b16 a[154:155], v132 offset:58432
    ds_read_b64_tr_b16 v[252:253], v132 offset:61440
    ds_read_b64_tr_b16 v[254:255], v132 offset:62464
    ds_read_b64_tr_b16 a[156:157], v132 offset:61504
    ds_read_b64_tr_b16 a[158:159], v132 offset:62528
    s_waitcnt lgkmcnt(0)
    s_waitcnt vmcnt(20)
    s_barrier
    ds_read_b64_tr_b16 a[0:1], v133 offset:0
    ds_read_b64_tr_b16 a[2:3], v133 offset:1024
    ds_read_b64_tr_b16 a[160:161], v133 offset:64
    ds_read_b64_tr_b16 a[162:163], v133 offset:1088
    ds_read_b64_tr_b16 a[4:5], v133 offset:4096
    ds_read_b64_tr_b16 a[6:7], v133 offset:5120
    ds_read_b64_tr_b16 a[164:165], v133 offset:4160
    ds_read_b64_tr_b16 a[166:167], v133 offset:5184
    ds_read_b64_tr_b16 a[8:9], v133 offset:8192
    ds_read_b64_tr_b16 a[10:11], v133 offset:9216
    ds_read_b64_tr_b16 a[168:169], v133 offset:8256
    ds_read_b64_tr_b16 a[170:171], v133 offset:9280
    ds_read_b64_tr_b16 a[12:13], v133 offset:12288
    ds_read_b64_tr_b16 a[14:15], v133 offset:13312
    ds_read_b64_tr_b16 a[172:173], v133 offset:12352
    ds_read_b64_tr_b16 a[174:175], v133 offset:13376
    s_waitcnt vmcnt(16)
    s_barrier
    ds_read_b64_tr_b16 a[16:17], v133 offset:16384
    ds_read_b64_tr_b16 a[18:19], v133 offset:17408
    ds_read_b64_tr_b16 a[176:177], v133 offset:16448
    ds_read_b64_tr_b16 a[178:179], v133 offset:17472
    ds_read_b64_tr_b16 a[20:21], v133 offset:20480
    ds_read_b64_tr_b16 a[22:23], v133 offset:21504
    ds_read_b64_tr_b16 a[180:181], v133 offset:20544
    ds_read_b64_tr_b16 a[182:183], v133 offset:21568
    ds_read_b64_tr_b16 a[24:25], v133 offset:24576
    ds_read_b64_tr_b16 a[26:27], v133 offset:25600
    ds_read_b64_tr_b16 a[184:185], v133 offset:24640
    ds_read_b64_tr_b16 a[186:187], v133 offset:25664
    ds_read_b64_tr_b16 a[28:29], v133 offset:28672
    ds_read_b64_tr_b16 a[30:31], v133 offset:29696
    ds_read_b64_tr_b16 a[188:189], v133 offset:28736
    ds_read_b64_tr_b16 a[190:191], v133 offset:29760
    s_waitcnt lgkmcnt(0)
    s_waitcnt vmcnt(12)
    s_barrier
    ds_read_b64_tr_b16 a[32:33], v133 offset:32768
    ds_read_b64_tr_b16 a[34:35], v133 offset:33792
    ds_read_b64_tr_b16 a[192:193], v133 offset:32832
    ds_read_b64_tr_b16 a[194:195], v133 offset:33856
    ds_read_b64_tr_b16 a[36:37], v133 offset:36864
    ds_read_b64_tr_b16 a[38:39], v133 offset:37888
    ds_read_b64_tr_b16 a[196:197], v133 offset:36928
    ds_read_b64_tr_b16 a[198:199], v133 offset:37952
    ds_read_b64_tr_b16 a[40:41], v133 offset:40960
    ds_read_b64_tr_b16 a[42:43], v133 offset:41984
    ds_read_b64_tr_b16 a[200:201], v133 offset:41024
    ds_read_b64_tr_b16 a[202:203], v133 offset:42048
    ds_read_b64_tr_b16 a[44:45], v133 offset:45056
    ds_read_b64_tr_b16 a[46:47], v133 offset:46080
    ds_read_b64_tr_b16 a[204:205], v133 offset:45120
    ds_read_b64_tr_b16 a[206:207], v133 offset:46144
    s_waitcnt vmcnt(8)
    s_barrier
    ds_read_b64_tr_b16 a[48:49], v133 offset:49152
    ds_read_b64_tr_b16 a[50:51], v133 offset:50176
    ds_read_b64_tr_b16 a[208:209], v133 offset:49216
    ds_read_b64_tr_b16 a[210:211], v133 offset:50240
    ds_read_b64_tr_b16 a[52:53], v133 offset:53248
    ds_read_b64_tr_b16 a[54:55], v133 offset:54272
    ds_read_b64_tr_b16 a[212:213], v133 offset:53312
    ds_read_b64_tr_b16 a[214:215], v133 offset:54336
    ds_read_b64_tr_b16 a[56:57], v133 offset:57344
    ds_read_b64_tr_b16 a[58:59], v133 offset:58368
    ds_read_b64_tr_b16 a[216:217], v133 offset:57408
    ds_read_b64_tr_b16 a[218:219], v133 offset:58432
    ds_read_b64_tr_b16 a[60:61], v133 offset:61440
    ds_read_b64_tr_b16 a[62:63], v133 offset:62464
    ds_read_b64_tr_b16 a[220:221], v133 offset:61504
    ds_read_b64_tr_b16 a[222:223], v133 offset:62528
    s_waitcnt lgkmcnt(0)
    s_waitcnt vmcnt(4)
    s_barrier
    ds_read_b64_tr_b16 a[64:65], v134 offset:0
    ds_read_b64_tr_b16 a[66:67], v134 offset:1024
    ds_read_b64_tr_b16 a[224:225], v134 offset:64
    ds_read_b64_tr_b16 a[226:227], v134 offset:1088
    ds_read_b64_tr_b16 a[68:69], v134 offset:4096
    ds_read_b64_tr_b16 a[70:71], v134 offset:5120
    ds_read_b64_tr_b16 a[228:229], v134 offset:4160
    ds_read_b64_tr_b16 a[230:231], v134 offset:5184
    ds_read_b64_tr_b16 a[72:73], v134 offset:8192
    ds_read_b64_tr_b16 a[74:75], v134 offset:9216
    ds_read_b64_tr_b16 a[232:233], v134 offset:8256
    ds_read_b64_tr_b16 a[234:235], v134 offset:9280
    ds_read_b64_tr_b16 a[76:77], v134 offset:12288
    ds_read_b64_tr_b16 a[78:79], v134 offset:13312
    ds_read_b64_tr_b16 a[236:237], v134 offset:12352
    ds_read_b64_tr_b16 a[238:239], v134 offset:13376
    s_waitcnt vmcnt(0)
    s_barrier
    ds_read_b64_tr_b16 a[80:81], v134 offset:16384
    ds_read_b64_tr_b16 a[82:83], v134 offset:17408
    ds_read_b64_tr_b16 a[240:241], v134 offset:16448
    ds_read_b64_tr_b16 a[242:243], v134 offset:17472
    ds_read_b64_tr_b16 a[84:85], v134 offset:20480
    ds_read_b64_tr_b16 a[86:87], v134 offset:21504
    ds_read_b64_tr_b16 a[244:245], v134 offset:20544
    ds_read_b64_tr_b16 a[246:247], v134 offset:21568
    ds_read_b64_tr_b16 a[88:89], v134 offset:24576
    ds_read_b64_tr_b16 a[90:91], v134 offset:25600
    ds_read_b64_tr_b16 a[248:249], v134 offset:24640
    ds_read_b64_tr_b16 a[250:251], v134 offset:25664
    ds_read_b64_tr_b16 a[92:93], v134 offset:28672
    ds_read_b64_tr_b16 a[94:95], v134 offset:29696
    ds_read_b64_tr_b16 a[252:253], v134 offset:28736
    ds_read_b64_tr_b16 a[254:255], v134 offset:29760
    s_waitcnt lgkmcnt(0)
    s_waitcnt lgkmcnt(0)
    s_barrier
    v_lshrrev_b32 v128, 4, v0
    v_add_u32 v128, 0, v128
    v_and_b32 v129, 15, v0
    v_xor_b32 v129, v129, v128
    v_mul_u32_u24 v128, 1280, v128
    v_lshl_add_u32 v26, v129, 4, v128
    v_lshrrev_b32 v128, 4, v0
    v_add_u32 v128, 4, v128
    v_and_b32 v129, 15, v0
    v_xor_b32 v129, v129, v128
    v_mul_u32_u24 v128, 1280, v128
    v_lshl_add_u32 v27, v129, 4, v128
    v_lshrrev_b32 v128, 4, v0
    v_add_u32 v128, 8, v128
    v_and_b32 v129, 15, v0
    v_xor_b32 v129, v129, v128
    v_mul_u32_u24 v128, 1280, v128
    v_lshl_add_u32 v28, v129, 4, v128
    v_lshrrev_b32 v128, 4, v0
    v_add_u32 v128, 12, v128
    v_and_b32 v129, 15, v0
    v_xor_b32 v129, v129, v128
    v_mul_u32_u24 v128, 1280, v128
    v_lshl_add_u32 v29, v129, 4, v128
    v_and_b32 v128, 31, v0
    v_and_b32 v129, 15, v128
    v_lshrrev_b32 v130, 5, v0
    v_xor_b32 v129, v129, v130
    s_lshr_b32 s65, s4, 1
    s_lshl_b32 s65, s65, 13
    v_lshlrev_b32 v128, 8, v128
    v_add_u32 v128, s65, v128
    v_xor_b32 v130, 0, v129
    v_lshl_add_u32 v2, v130, 4, v128
    v_add_u32 v10, 0x10000, v2
    v_add_u32 v18, 0x20000, v2
    v_xor_b32 v130, 2, v129
    v_lshl_add_u32 v3, v130, 4, v128
    v_add_u32 v11, 0x10000, v3
    v_add_u32 v19, 0x20000, v3
    v_xor_b32 v130, 4, v129
    v_lshl_add_u32 v4, v130, 4, v128
    v_add_u32 v12, 0x10000, v4
    v_add_u32 v20, 0x20000, v4
    v_xor_b32 v130, 6, v129
    v_lshl_add_u32 v5, v130, 4, v128
    v_add_u32 v13, 0x10000, v5
    v_add_u32 v21, 0x20000, v5
    v_xor_b32 v130, 8, v129
    v_lshl_add_u32 v6, v130, 4, v128
    v_add_u32 v14, 0x10000, v6
    v_add_u32 v22, 0x20000, v6
    v_xor_b32 v130, 10, v129
    v_lshl_add_u32 v7, v130, 4, v128
    v_add_u32 v15, 0x10000, v7
    v_add_u32 v23, 0x20000, v7
    v_xor_b32 v130, 12, v129
    v_lshl_add_u32 v8, v130, 4, v128
    v_add_u32 v16, 0x10000, v8
    v_add_u32 v24, 0x20000, v8
    v_xor_b32 v130, 14, v129
    v_lshl_add_u32 v9, v130, 4, v128
    v_add_u32 v17, 0x10000, v9
    v_add_u32 v25, 0x20000, v9
    s_mul_i32 s53, s4, 20480
    s_mul_i32 s65, s7, 1310720
    s_add_u32 s53, s53, s65
    s_lshr_b32 s65, s4, 1
    s_lshl_b32 s66, s7, 5
    s_add_u32 s65, s65, s66
    s_mul_i32 s65, s65, 122880
    s_lshl_b32 s66, s6, 13
    s_add_u32 s65, s65, s66
    s_and_b32 s66, s4, 1
    s_lshl_b32 s66, s66, 12
    s_add_u32 s65, s65, s66
    s_add_u32 s54, s65, 139460608
    v_mov_b32 v136, 0x80000000
    s_lshl_b32 s79, s4, 12
    s_waitcnt vmcnt(0)
    s_mov_b32 s52, 0
    s_mov_b32 s57, 0
    s_add_u32 s65, s53, 0
    s_add_u32 s66, s79, 0
    s_mov_b32 m0, s66
    s_nop 0
    buffer_load_dwordx4 v26, s[48:51], s65 offen lds
    s_add_u32 s66, s79, 1024
    s_mov_b32 m0, s66
    s_nop 0
    buffer_load_dwordx4 v27, s[48:51], s65 offen lds
    s_add_u32 s66, s79, 2048
    s_mov_b32 m0, s66
    s_nop 0
    buffer_load_dwordx4 v28, s[48:51], s65 offen lds
    s_add_u32 s66, s79, 3072
    s_mov_b32 m0, s66
    s_nop 0
    buffer_load_dwordx4 v29, s[48:51], s65 offen lds
    s_add_u32 s65, s53, 256
    s_add_u32 s66, s79, 16384
    s_mov_b32 m0, s66
    s_nop 0
    buffer_load_dwordx4 v26, s[48:51], s65 offen lds
    s_add_u32 s66, s79, 17408
    s_mov_b32 m0, s66
    s_nop 0
    buffer_load_dwordx4 v27, s[48:51], s65 offen lds
    s_add_u32 s66, s79, 18432
    s_mov_b32 m0, s66
    s_nop 0
    buffer_load_dwordx4 v28, s[48:51], s65 offen lds
    s_add_u32 s66, s79, 19456
    s_mov_b32 m0, s66
    s_nop 0
    buffer_load_dwordx4 v29, s[48:51], s65 offen lds
    s_add_u32 s65, s53, 512
    s_add_u32 s66, s79, 32768
    s_mov_b32 m0, s66
    s_nop 0
    buffer_load_dwordx4 v26, s[48:51], s65 offen lds
    s_add_u32 s66, s79, 33792
    s_mov_b32 m0, s66
    s_nop 0
    buffer_load_dwordx4 v27, s[48:51], s65 offen lds
    s_add_u32 s66, s79, 34816
    s_mov_b32 m0, s66
    s_nop 0
    buffer_load_dwordx4 v28, s[48:51], s65 offen lds
    s_add_u32 s66, s79, 35840
    s_mov_b32 m0, s66
    s_nop 0
    buffer_load_dwordx4 v29, s[48:51], s65 offen lds
    s_add_u32 s65, s53, 768
    s_add_u32 s66, s79, 49152
    s_mov_b32 m0, s66
    s_nop 0
    buffer_load_dwordx4 v26, s[48:51], s65 offen lds
    s_add_u32 s66, s79, 50176
    s_mov_b32 m0, s66
    s_nop 0
    buffer_load_dwordx4 v27, s[48:51], s65 offen lds
    s_add_u32 s66, s79, 51200
    s_mov_b32 m0, s66
    s_nop 0
    buffer_load_dwordx4 v28, s[48:51], s65 offen lds
    s_add_u32 s66, s79, 52224
    s_mov_b32 m0, s66
    s_nop 0
    buffer_load_dwordx4 v29, s[48:51], s65 offen lds
    s_add_u32 s65, s53, 1024
    s_add_u32 s66, s79, 65536
    s_mov_b32 m0, s66
    s_nop 0
    buffer_load_dwordx4 v26, s[48:51], s65 offen lds
    s_add_u32 s66, s79, 66560
    s_mov_b32 m0, s66
    s_nop 0
    buffer_load_dwordx4 v27, s[48:51], s65 offen lds
    s_add_u32 s66, s79, 67584
    s_mov_b32 m0, s66
    s_nop 0
    buffer_load_dwordx4 v28, s[48:51], s65 offen lds
    s_add_u32 s66, s79, 68608
    s_mov_b32 m0, s66
    s_nop 0
    buffer_load_dwordx4 v29, s[48:51], s65 offen lds
    s_add_u32 s65, s53, 81920
    s_add_u32 s66, s79, 81920
    s_mov_b32 m0, s66
    s_nop 0
    buffer_load_dwordx4 v26, s[48:51], s65 offen lds
    s_add_u32 s66, s79, 82944
    s_mov_b32 m0, s66
    s_nop 0
    buffer_load_dwordx4 v27, s[48:51], s65 offen lds
    s_add_u32 s66, s79, 83968
    s_mov_b32 m0, s66
    s_nop 0
    buffer_load_dwordx4 v28, s[48:51], s65 offen lds
    s_add_u32 s66, s79, 84992
    s_mov_b32 m0, s66
    s_nop 0
    buffer_load_dwordx4 v29, s[48:51], s65 offen lds
    s_add_u32 s65, s53, 82176
    s_add_u32 s66, s79, 98304
    s_mov_b32 m0, s66
    s_nop 0
    buffer_load_dwordx4 v26, s[48:51], s65 offen lds
    s_add_u32 s66, s79, 99328
    s_mov_b32 m0, s66
    s_nop 0
    buffer_load_dwordx4 v27, s[48:51], s65 offen lds
    s_add_u32 s66, s79, 100352
    s_mov_b32 m0, s66
    s_nop 0
    buffer_load_dwordx4 v28, s[48:51], s65 offen lds
    s_add_u32 s66, s79, 101376
    s_mov_b32 m0, s66
    s_nop 0
    buffer_load_dwordx4 v29, s[48:51], s65 offen lds
    s_add_u32 s65, s53, 82432
    s_add_u32 s66, s79, 114688
    s_mov_b32 m0, s66
    s_nop 0
    buffer_load_dwordx4 v26, s[48:51], s65 offen lds
    s_add_u32 s66, s79, 115712
    s_mov_b32 m0, s66
    s_nop 0
    buffer_load_dwordx4 v27, s[48:51], s65 offen lds
    s_add_u32 s66, s79, 116736
    s_mov_b32 m0, s66
    s_nop 0
    buffer_load_dwordx4 v28, s[48:51], s65 offen lds
    s_add_u32 s66, s79, 117760
    s_mov_b32 m0, s66
    s_nop 0
    buffer_load_dwordx4 v29, s[48:51], s65 offen lds
    s_waitcnt vmcnt(28)
    s_barrier
    ds_read_b128 v[32:35], v2 offset:0
    ds_read_b128 v[36:39], v3 offset:0
    ds_read_b128 v[40:43], v4 offset:0
L_g1_a1:
    s_add_u32 s65, s53, 82688
    s_waitcnt lgkmcnt(2)
    v_mfma_f32_32x32x16_bf16 v[64:79], v[192:195], v[32:35], 0
    ds_read_b128 v[44:47], v5 offset:0
    v_mfma_f32_32x32x16_bf16 v[80:95], a[96:99], v[32:35], 0
    s_add_u32 s66, s79, 131072
    s_mov_b32 m0, s66
    s_nop 0
    buffer_load_dwordx4 v26, s[48:51], s65 offen lds
    s_waitcnt lgkmcnt(2)
    v_mfma_f32_32x32x16_bf16 v[64:79], v[196:199], v[36:39], v[64:79]
    ds_read_b128 v[32:35], v6 offset:0
    v_cvt_pk_bf16_f32 v48, v96, v97
    v_cvt_pk_bf16_f32 v49, v98, v99
    v_mfma_f32_32x32x16_bf16 v[80:95], a[100:103], v[36:39], v[80:95]
    s_add_u32 s66, s79, 132096
    s_mov_b32 m0, s66
    s_nop 0
    buffer_load_dwordx4 v27, s[48:51], s65 offen lds
    v_cvt_pk_bf16_f32 v50, v100, v101
    v_cvt_pk_bf16_f32 v51, v102, v103
    s_waitcnt lgkmcnt(2)
    v_mfma_f32_32x32x16_bf16 v[64:79], v[200:203], v[40:43], v[64:79]
    ds_read_b128 v[36:39], v7 offset:0
    buffer_store_dwordx4 v[48:51], v136, s[8:11], s54 offen offset:0 sc1
    v_cvt_pk_bf16_f32 v52, v104, v105
    v_mfma_f32_32x32x16_bf16 v[80:95], a[104:107], v[40:43], v[80:95]
    s_add_u32 s66, s79, 133120
    s_mov_b32 m0, s66
    s_nop 0
    buffer_load_dwordx4 v28, s[48:51], s65 offen lds
    v_cvt_pk_bf16_f32 v53, v106, v107
    v_cvt_pk_bf16_f32 v54, v108, v109
    s_waitcnt lgkmcnt(2)
    v_mfma_f32_32x32x16_bf16 v[64:79], v[204:207], v[44:47], v[64:79]
    ds_read_b128 v[40:43], v8 offset:0
    v_cvt_pk_bf16_f32 v55, v110, v111
    buffer_store_dwordx4 v[52:55], v136, s[8:11], s54 offen offset:1024 sc1
    v_mfma_f32_32x32x16_bf16 v[80:95], a[108:111], v[44:47], v[80:95]
    s_add_u32 s66, s79, 134144
    s_mov_b32 m0, s66
    s_nop 0
    buffer_load_dwordx4 v29, s[48:51], s65 offen lds
    v_cvt_pk_bf16_f32 v56, v112, v113
    v_cvt_pk_bf16_f32 v57, v114, v115
    s_waitcnt lgkmcnt(2)
    v_mfma_f32_32x32x16_bf16 v[64:79], v[208:211], v[32:35], v[64:79]
    ds_read_b128 v[44:47], v9 offset:0
    v_cvt_pk_bf16_f32 v58, v116, v117
    v_cvt_pk_bf16_f32 v59, v118, v119
    v_mfma_f32_32x32x16_bf16 v[80:95], a[112:115], v[32:35], v[80:95]
    buffer_store_dwordx4 v[56:59], v136, s[8:11], s54 offen offset:2048 sc1
    v_cvt_pk_bf16_f32 v60, v120, v121
    s_waitcnt vmcnt(28)
    s_barrier
    s_waitcnt lgkmcnt(2)
    v_mfma_f32_32x32x16_bf16 v[64:79], v[212:215], v[36:39], v[64:79]
    ds_read_b128 v[32:35], v2 offset:16384
    v_cvt_pk_bf16_f32 v61, v122, v123
    v_cvt_pk_bf16_f32 v62, v124, v125
    v_mfma_f32_32x32x16_bf16 v[80:95], a[116:119], v[36:39], v[80:95]
    v_cvt_pk_bf16_f32 v63, v126, v127
    buffer_store_dwordx4 v[60:63], v136, s[8:11], s54 offen offset:3072 sc1
    s_waitcnt lgkmcnt(2)
    v_mfma_f32_32x32x16_bf16 v[64:79], v[216:219], v[40:43], v[64:79]
    ds_read_b128 v[36:39], v3 offset:16384
    v_mfma_f32_32x32x16_bf16 v[80:95], a[120:123], v[40:43], v[80:95]
    s_waitcnt lgkmcnt(2)
    v_mfma_f32_32x32x16_bf16 v[64:79], v[220:223], v[44:47], v[64:79]
    ds_read_b128 v[40:43], v4 offset:16384
    v_mfma_f32_32x32x16_bf16 v[80:95], a[124:127], v[44:47], v[80:95]
    s_add_u32 s54, s54, s57
    s_mov_b32 s57, 245760
    v_mov_b32 v136, v1
    s_add_u32 s65, s53, 82944
    s_waitcnt lgkmcnt(2)
    v_mfma_f32_32x32x16_bf16 v[64:79], v[224:227], v[32:35], v[64:79]
    ds_read_b128 v[44:47], v5 offset:16384
    v_mfma_f32_32x32x16_bf16 v[80:95], a[128:131], v[32:35], v[80:95]
    s_add_u32 s66, s79, 147456
    s_mov_b32 m0, s66
    s_nop 0
    buffer_load_dwordx4 v26, s[48:51], s65 offen lds
    s_waitcnt lgkmcnt(2)
    v_mfma_f32_32x32x16_bf16 v[64:79], v[228:231], v[36:39], v[64:79]
    ds_read_b128 v[32:35], v6 offset:16384
    v_mfma_f32_32x32x16_bf16 v[80:95], a[132:135], v[36:39], v[80:95]
    s_add_u32 s66, s79, 148480
    s_mov_b32 m0, s66
    s_nop 0
    buffer_load_dwordx4 v27, s[48:51], s65 offen lds
    s_waitcnt lgkmcnt(2)
    v_mfma_f32_32x32x16_bf16 v[64:79], v[232:235], v[40:43], v[64:79]
    ds_read_b128 v[36:39], v7 offset:16384
    v_mfma_f32_32x32x16_bf16 v[80:95], a[136:139], v[40:43], v[80:95]
    s_add_u32 s66, s79, 149504
    s_mov_b32 m0, s66
    s_nop 0
    buffer_load_dwordx4 v28, s[48:51], s65 offen lds
    s_waitcnt lgkmcnt(2)
    v_mfma_f32_32x32x16_bf16 v[64:79], v[236:239], v[44:47], v[64:79]
    ds_read_b128 v[40:43], v8 offset:16384
    v_mfma_f32_32x32x16_bf16 v[80:95], a[140:143], v[44:47], v[80:95]
    s_add_u32 s66, s79, 150528
    s_mov_b32 m0, s66
    s_nop 0
    buffer_load_dwordx4 v29, s[48:51], s65 offen lds
    s_waitcnt lgkmcnt(2)
    v_mfma_f32_32x32x16_bf16 v[64:79], v[240:243], v[32:35], v[64:79]
    ds_read_b128 v[44:47], v9 offset:16384
    v_mfma_f32_32x32x16_bf16 v[80:95], a[144:147], v[32:35], v[80:95]
    s_waitcnt vmcnt(28)
    s_barrier
    s_waitcnt lgkmcnt(2)
    v_mfma_f32_32x32x16_bf16 v[64:79], v[244:247], v[36:39], v[64:79]
    ds_read_b128 v[32:35], v2 offset:32768
    v_mfma_f32_32x32x16_bf16 v[80:95], a[148:151], v[36:39], v[80:95]
    s_waitcnt lgkmcnt(2)
    v_mfma_f32_32x32x16_bf16 v[64:79], v[248:251], v[40:43], v[64:79]
    ds_read_b128 v[36:39], v3 offset:32768
    v_mfma_f32_32x32x16_bf16 v[80:95], a[152:155], v[40:43], v[80:95]
    s_waitcnt lgkmcnt(2)
    v_mfma_f32_32x32x16_bf16 v[64:79], v[252:255], v[44:47], v[64:79]
    ds_read_b128 v[40:43], v4 offset:32768
    v_mfma_f32_32x32x16_bf16 v[80:95], a[156:159], v[44:47], v[80:95]
    s_add_u32 s65, s53, 163840
    s_waitcnt lgkmcnt(2)
    v_mfma_f32_32x32x16_bf16 v[64:79], a[0:3], v[32:35], v[64:79]
    ds_read_b128 v[44:47], v5 offset:32768
    v_mfma_f32_32x32x16_bf16 v[80:95], a[160:163], v[32:35], v[80:95]
    s_add_u32 s66, s79, 0
    s_mov_b32 m0, s66
    s_nop 0
    buffer_load_dwordx4 v26, s[48:51], s65 offen lds
    s_waitcnt lgkmcnt(2)
    v_mfma_f32_32x32x16_bf16 v[64:79], a[4:7], v[36:39], v[64:79]
    ds_read_b128 v[32:35], v6 offset:32768
    v_mfma_f32_32x32x16_bf16 v[80:95], a[164:167], v[36:39], v[80:95]
    s_add_u32 s66, s79, 1024
    s_mov_b32 m0, s66
    s_nop 0
    buffer_load_dwordx4 v27, s[48:51], s65 offen lds
    s_waitcnt lgkmcnt(2)
    v_mfma_f32_32x32x16_bf16 v[64:79], a[8:11], v[40:43], v[64:79]
    ds_read_b128 v[36:39], v7 offset:32768
    v_mfma_f32_32x32x16_bf16 v[80:95], a[168:171], v[40:43], v[80:95]
    s_add_u32 s66, s79, 2048
    s_mov_b32 m0, s66
    s_nop 0
    buffer_load_dwordx4 v28, s[48:51], s65 offen lds
    s_waitcnt lgkmcnt(2)
    v_mfma_f32_32x32x16_bf16 v[64:79], a[12:15], v[44:47], v[64:79]
    ds_read_b128 v[40:43], v8 offset:32768
    v_mfma_f32_32x32x16_bf16 v[80:95], a[172:175], v[44:47], v[80:95]
    s_add_u32 s66, s79, 3072
    s_mov_b32 m0, s66
    s_nop 0
    buffer_load_dwordx4 v29, s[48:51], s65 offen lds
    s_waitcnt lgkmcnt(2)
    v_mfma_f32_32x32x16_bf16 v[64:79], a[16:19], v[32:35], v[64:79]
    ds_read_b128 v[44:47], v9 offset:32768
    v_mfma_f32_32x32x16_bf16 v[80:95], a[176:179], v[32:35], v[80:95]
    s_waitcnt vmcnt(28)
    s_barrier
    s_waitcnt lgkmcnt(2)
    v_mfma_f32_32x32x16_bf16 v[64:79], a[20:23], v[36:39], v[64:79]
    ds_read_b128 v[32:35], v2 offset:49152
    v_mfma_f32_32x32x16_bf16 v[80:95], a[180:183], v[36:39], v[80:95]
    s_waitcnt lgkmcnt(2)
    v_mfma_f32_32x32x16_bf16 v[64:79], a[24:27], v[40:43], v[64:79]
    ds_read_b128 v[36:39], v3 offset:49152
    v_mfma_f32_32x32x16_bf16 v[80:95], a[184:187], v[40:43], v[80:95]
    s_waitcnt lgkmcnt(2)
    v_mfma_f32_32x32x16_bf16 v[64:79], a[28:31], v[44:47], v[64:79]
    ds_read_b128 v[40:43], v4 offset:49152
    v_mfma_f32_32x32x16_bf16 v[80:95], a[188:191], v[44:47], v[80:95]
    s_add_u32 s65, s53, 164096
    s_waitcnt lgkmcnt(2)
    v_mfma_f32_32x32x16_bf16 v[64:79], a[32:35], v[32:35], v[64:79]
    ds_read_b128 v[44:47], v5 offset:49152
    v_mfma_f32_32x32x16_bf16 v[80:95], a[192:195], v[32:35], v[80:95]
    s_add_u32 s66, s79, 16384
    s_mov_b32 m0, s66
    s_nop 0
    buffer_load_dwordx4 v26, s[48:51], s65 offen lds
    s_waitcnt lgkmcnt(2)
    v_mfma_f32_32x32x16_bf16 v[64:79], a[36:39], v[36:39], v[64:79]
    ds_read_b128 v[32:35], v6 offset:49152
    v_mfma_f32_32x32x16_bf16 v[80:95], a[196:199], v[36:39], v[80:95]
    s_add_u32 s66, s79, 17408
    s_mov_b32 m0, s66
    s_nop 0
    buffer_load_dwordx4 v27, s[48:51], s65 offen lds
    s_waitcnt lgkmcnt(2)
    v_mfma_f32_32x32x16_bf16 v[64:79], a[40:43], v[40:43], v[64:79]
    ds_read_b128 v[36:39], v7 offset:49152
    v_mfma_f32_32x32x16_bf16 v[80:95], a[200:203], v[40:43], v[80:95]
    s_add_u32 s66, s79, 18432
    s_mov_b32 m0, s66
    s_nop 0
    buffer_load_dwordx4 v28, s[48:51], s65 offen lds
    s_waitcnt lgkmcnt(2)
    v_mfma_f32_32x32x16_bf16 v[64:79], a[44:47], v[44:47], v[64:79]
    ds_read_b128 v[40:43], v8 offset:49152
    v_mfma_f32_32x32x16_bf16 v[80:95], a[204:207], v[44:47], v[80:95]
    s_add_u32 s66, s79, 19456
    s_mov_b32 m0, s66
    s_nop 0
    buffer_load_dwordx4 v29, s[48:51], s65 offen lds
    s_waitcnt lgkmcnt(2)
    v_mfma_f32_32x32x16_bf16 v[64:79], a[48:51], v[32:35], v[64:79]
    ds_read_b128 v[44:47], v9 offset:49152
    v_mfma_f32_32x32x16_bf16 v[80:95], a[208:211], v[32:35], v[80:95]
    s_waitcnt vmcnt(28)
    s_barrier
    s_waitcnt lgkmcnt(2)
    v_mfma_f32_32x32x16_bf16 v[64:79], a[52:55], v[36:39], v[64:79]
    ds_read_b128 v[32:35], v10 offset:0
    v_mfma_f32_32x32x16_bf16 v[80:95], a[212:215], v[36:39], v[80:95]
    s_waitcnt lgkmcnt(2)
    v_mfma_f32_32x32x16_bf16 v[64:79], a[56:59], v[40:43], v[64:79]
    ds_read_b128 v[36:39], v11 offset:0
    v_mfma_f32_32x32x16_bf16 v[80:95], a[216:219], v[40:43], v[80:95]
    s_waitcnt lgkmcnt(2)
    v_mfma_f32_32x32x16_bf16 v[64:79], a[60:63], v[44:47], v[64:79]
    ds_read_b128 v[40:43], v12 offset:0
    v_mfma_f32_32x32x16_bf16 v[80:95], a[220:223], v[44:47], v[80:95]
    s_add_u32 s65, s53, 164352
    s_waitcnt lgkmcnt(2)
    v_mfma_f32_32x32x16_bf16 v[64:79], a[64:67], v[32:35], v[64:79]
    ds_read_b128 v[44:47], v13 offset:0
    v_mfma_f32_32x32x16_bf16 v[80:95], a[224:227], v[32:35], v[80:95]
    s_add_u32 s66, s79, 32768
    s_mov_b32 m0, s66
    s_nop 0
    buffer_load_dwordx4 v26, s[48:51], s65 offen lds
    s_waitcnt lgkmcnt(2)
    v_mfma_f32_32x32x16_bf16 v[64:79], a[68:71], v[36:39], v[64:79]
    ds_read_b128 v[32:35], v14 offset:0
    v_mfma_f32_32x32x16_bf16 v[80:95], a[228:231], v[36:39], v[80:95]
    s_add_u32 s66, s79, 33792
    s_mov_b32 m0, s66
    s_nop 0
    buffer_load_dwordx4 v27, s[48:51], s65 offen lds
    s_waitcnt lgkmcnt(2)
    v_mfma_f32_32x32x16_bf16 v[64:79], a[72:75], v[40:43], v[64:79]
    ds_read_b128 v[36:39], v15 offset:0
    v_mfma_f32_32x32x16_bf16 v[80:95], a[232:235], v[40:43], v[80:95]
    s_add_u32 s66, s79, 34816
    s_mov_b32 m0, s66
    s_nop 0
    buffer_load_dwordx4 v28, s[48:51], s65 offen lds
    s_waitcnt lgkmcnt(2)
    v_mfma_f32_32x32x16_bf16 v[64:79], a[76:79], v[44:47], v[64:79]
    ds_read_b128 v[40:43], v16 offset:0
    v_mfma_f32_32x32x16_bf16 v[80:95], a[236:239], v[44:47], v[80:95]
    s_add_u32 s66, s79, 35840
    s_mov_b32 m0, s66
    s_nop 0
    buffer_load_dwordx4 v29, s[48:51], s65 offen lds
    s_waitcnt lgkmcnt(2)
    v_mfma_f32_32x32x16_bf16 v[64:79], a[80:83], v[32:35], v[64:79]
    ds_read_b128 v[44:47], v17 offset:0
    v_mfma_f32_32x32x16_bf16 v[80:95], a[240:243], v[32:35], v[80:95]
    s_waitcnt vmcnt(28)
    s_barrier
    s_waitcnt lgkmcnt(2)
    v_mfma_f32_32x32x16_bf16 v[64:79], a[84:87], v[36:39], v[64:79]
    ds_read_b128 v[32:35], v10 offset:16384
    v_mfma_f32_32x32x16_bf16 v[80:95], a[244:247], v[36:39], v[80:95]
    s_waitcnt lgkmcnt(2)
    v_mfma_f32_32x32x16_bf16 v[64:79], a[88:91], v[40:43], v[64:79]
    ds_read_b128 v[36:39], v11 offset:16384
    v_mfma_f32_32x32x16_bf16 v[80:95], a[248:251], v[40:43], v[80:95]
    s_waitcnt lgkmcnt(2)
    v_mfma_f32_32x32x16_bf16 v[64:79], a[92:95], v[44:47], v[64:79]
    ds_read_b128 v[40:43], v12 offset:16384
    v_mfma_f32_32x32x16_bf16 v[80:95], a[252:255], v[44:47], v[80:95]
    s_add_u32 s65, s53, 164608
    s_waitcnt lgkmcnt(2)
    v_mfma_f32_32x32x16_bf16 v[96:111], v[192:195], v[32:35], 0
    ds_read_b128 v[44:47], v13 offset:16384
    v_mfma_f32_32x32x16_bf16 v[112:127], a[96:99], v[32:35], 0
    s_add_u32 s66, s79, 49152
    s_mov_b32 m0, s66
    s_nop 0
    buffer_load_dwordx4 v26, s[48:51], s65 offen lds
    s_waitcnt lgkmcnt(2)
    v_mfma_f32_32x32x16_bf16 v[96:111], v[196:199], v[36:39], v[96:111]
    ds_read_b128 v[32:35], v14 offset:16384
    v_cvt_pk_bf16_f32 v48, v64, v65
    v_cvt_pk_bf16_f32 v49, v66, v67
    v_mfma_f32_32x32x16_bf16 v[112:127], a[100:103], v[36:39], v[112:127]
    s_add_u32 s66, s79, 50176
    s_mov_b32 m0, s66
    s_nop 0
    buffer_load_dwordx4 v27, s[48:51], s65 offen lds
    v_cvt_pk_bf16_f32 v50, v68, v69
    v_cvt_pk_bf16_f32 v51, v70, v71
    s_waitcnt lgkmcnt(2)
    v_mfma_f32_32x32x16_bf16 v[96:111], v[200:203], v[40:43], v[96:111]
    ds_read_b128 v[36:39], v15 offset:16384
    buffer_store_dwordx4 v[48:51], v136, s[8:11], s54 offen offset:0 sc1
    v_cvt_pk_bf16_f32 v52, v72, v73
    v_mfma_f32_32x32x16_bf16 v[112:127], a[104:107], v[40:43], v[112:127]
    s_add_u32 s66, s79, 51200
    s_mov_b32 m0, s66
    s_nop 0
    buffer_load_dwordx4 v28, s[48:51], s65 offen lds
    v_cvt_pk_bf16_f32 v53, v74, v75
    v_cvt_pk_bf16_f32 v54, v76, v77
    s_waitcnt lgkmcnt(2)
    v_mfma_f32_32x32x16_bf16 v[96:111], v[204:207], v[44:47], v[96:111]
    ds_read_b128 v[40:43], v16 offset:16384
    v_cvt_pk_bf16_f32 v55, v78, v79
    buffer_store_dwordx4 v[52:55], v136, s[8:11], s54 offen offset:1024 sc1
    v_mfma_f32_32x32x16_bf16 v[112:127], a[108:111], v[44:47], v[112:127]
    s_add_u32 s66, s79, 52224
    s_mov_b32 m0, s66
    s_nop 0
    buffer_load_dwordx4 v29, s[48:51], s65 offen lds
    v_cvt_pk_bf16_f32 v56, v80, v81
    v_cvt_pk_bf16_f32 v57, v82, v83
    s_waitcnt lgkmcnt(2)
    v_mfma_f32_32x32x16_bf16 v[96:111], v[208:211], v[32:35], v[96:111]
    ds_read_b128 v[44:47], v17 offset:16384
    v_cvt_pk_bf16_f32 v58, v84, v85
    v_cvt_pk_bf16_f32 v59, v86, v87
    v_mfma_f32_32x32x16_bf16 v[112:127], a[112:115], v[32:35], v[112:127]
    buffer_store_dwordx4 v[56:59], v136, s[8:11], s54 offen offset:2048 sc1
    v_cvt_pk_bf16_f32 v60, v88, v89
    s_waitcnt vmcnt(28)
    s_barrier
    s_waitcnt lgkmcnt(2)
    v_mfma_f32_32x32x16_bf16 v[96:111], v[212:215], v[36:39], v[96:111]
    ds_read_b128 v[32:35], v10 offset:32768
    v_cvt_pk_bf16_f32 v61, v90, v91
    v_cvt_pk_bf16_f32 v62, v92, v93
    v_mfma_f32_32x32x16_bf16 v[112:127], a[116:119], v[36:39], v[112:127]
    v_cvt_pk_bf16_f32 v63, v94, v95
    buffer_store_dwordx4 v[60:63], v136, s[8:11], s54 offen offset:3072 sc1
    s_waitcnt lgkmcnt(2)
    v_mfma_f32_32x32x16_bf16 v[96:111], v[216:219], v[40:43], v[96:111]
    ds_read_b128 v[36:39], v11 offset:32768
    v_mfma_f32_32x32x16_bf16 v[112:127], a[120:123], v[40:43], v[112:127]
    s_waitcnt lgkmcnt(2)
    v_mfma_f32_32x32x16_bf16 v[96:111], v[220:223], v[44:47], v[96:111]
    ds_read_b128 v[40:43], v12 offset:32768
    v_mfma_f32_32x32x16_bf16 v[112:127], a[124:127], v[44:47], v[112:127]
    s_add_u32 s54, s54, s57
    s_mov_b32 s57, 245760
    v_mov_b32 v136, v1
    s_add_u32 s65, s53, 164864
    s_waitcnt lgkmcnt(2)
    v_mfma_f32_32x32x16_bf16 v[96:111], v[224:227], v[32:35], v[96:111]
    ds_read_b128 v[44:47], v13 offset:32768
    v_mfma_f32_32x32x16_bf16 v[112:127], a[128:131], v[32:35], v[112:127]
    s_add_u32 s66, s79, 65536
    s_mov_b32 m0, s66
    s_nop 0
    buffer_load_dwordx4 v26, s[48:51], s65 offen lds
    s_waitcnt lgkmcnt(2)
    v_mfma_f32_32x32x16_bf16 v[96:111], v[228:231], v[36:39], v[96:111]
    ds_read_b128 v[32:35], v14 offset:32768
    v_mfma_f32_32x32x16_bf16 v[112:127], a[132:135], v[36:39], v[112:127]
    s_add_u32 s66, s79, 66560
    s_mov_b32 m0, s66
    s_nop 0
    buffer_load_dwordx4 v27, s[48:51], s65 offen lds
    s_waitcnt lgkmcnt(2)
    v_mfma_f32_32x32x16_bf16 v[96:111], v[232:235], v[40:43], v[96:111]
    ds_read_b128 v[36:39], v15 offset:32768
    v_mfma_f32_32x32x16_bf16 v[112:127], a[136:139], v[40:43], v[112:127]
    s_add_u32 s66, s79, 67584
    s_mov_b32 m0, s66
    s_nop 0
    buffer_load_dwordx4 v28, s[48:51], s65 offen lds
    s_waitcnt lgkmcnt(2)
    v_mfma_f32_32x32x16_bf16 v[96:111], v[236:239], v[44:47], v[96:111]
    ds_read_b128 v[40:43], v16 offset:32768
    v_mfma_f32_32x32x16_bf16 v[112:127], a[140:143], v[44:47], v[112:127]
    s_add_u32 s66, s79, 68608
    s_mov_b32 m0, s66
    s_nop 0
    buffer_load_dwordx4 v29, s[48:51], s65 offen lds
    s_waitcnt lgkmcnt(2)
    v_mfma_f32_32x32x16_bf16 v[96:111], v[240:243], v[32:35], v[96:111]
    ds_read_b128 v[44:47], v17 offset:32768
    v_mfma_f32_32x32x16_bf16 v[112:127], a[144:147], v[32:35], v[112:127]
    s_waitcnt vmcnt(28)
    s_barrier
    s_waitcnt lgkmcnt(2)
    v_mfma_f32_32x32x16_bf16 v[96:111], v[244:247], v[36:39], v[96:111]
    ds_read_b128 v[32:35], v10 offset:49152
    v_mfma_f32_32x32x16_bf16 v[112:127], a[148:151], v[36:39], v[112:127]
    s_waitcnt lgkmcnt(2)
    v_mfma_f32_32x32x16_bf16 v[96:111], v[248:251], v[40:43], v[96:111]
    ds_read_b128 v[36:39], v11 offset:49152
    v_mfma_f32_32x32x16_bf16 v[112:127], a[152:155], v[40:43], v[112:127]
    s_waitcnt lgkmcnt(2)
    v_mfma_f32_32x32x16_bf16 v[96:111], v[252:255], v[44:47], v[96:111]
    ds_read_b128 v[40:43], v12 offset:49152
    v_mfma_f32_32x32x16_bf16 v[112:127], a[156:159], v[44:47], v[112:127]
    s_add_u32 s65, s53, 245760
    s_waitcnt lgkmcnt(2)
    v_mfma_f32_32x32x16_bf16 v[96:111], a[0:3], v[32:35], v[96:111]
    ds_read_b128 v[44:47], v13 offset:49152
    v_mfma_f32_32x32x16_bf16 v[112:127], a[160:163], v[32:35], v[112:127]
    s_add_u32 s66, s79, 81920
    s_mov_b32 m0, s66
    s_nop 0
    buffer_load_dwordx4 v26, s[48:51], s65 offen lds
    s_waitcnt lgkmcnt(2)
    v_mfma_f32_32x32x16_bf16 v[96:111], a[4:7], v[36:39], v[96:111]
    ds_read_b128 v[32:35], v14 offset:49152
    v_mfma_f32_32x32x16_bf16 v[112:127], a[164:167], v[36:39], v[112:127]
    s_add_u32 s66, s79, 82944
    s_mov_b32 m0, s66
    s_nop 0
    buffer_load_dwordx4 v27, s[48:51], s65 offen lds
    s_waitcnt lgkmcnt(2)
    v_mfma_f32_32x32x16_bf16 v[96:111], a[8:11], v[40:43], v[96:111]
    ds_read_b128 v[36:39], v15 offset:49152
    v_mfma_f32_32x32x16_bf16 v[112:127], a[168:171], v[40:43], v[112:127]
    s_add_u32 s66, s79, 83968
    s_mov_b32 m0, s66
    s_nop 0
    buffer_load_dwordx4 v28, s[48:51], s65 offen lds
    s_waitcnt lgkmcnt(2)
    v_mfma_f32_32x32x16_bf16 v[96:111], a[12:15], v[44:47], v[96:111]
    ds_read_b128 v[40:43], v16 offset:49152
    v_mfma_f32_32x32x16_bf16 v[112:127], a[172:175], v[44:47], v[112:127]
    s_add_u32 s66, s79, 84992
    s_mov_b32 m0, s66
    s_nop 0
    buffer_load_dwordx4 v29, s[48:51], s65 offen lds
    s_waitcnt lgkmcnt(2)
    v_mfma_f32_32x32x16_bf16 v[96:111], a[16:19], v[32:35], v[96:111]
    ds_read_b128 v[44:47], v17 offset:49152
    v_mfma_f32_32x32x16_bf16 v[112:127], a[176:179], v[32:35], v[112:127]
    s_waitcnt vmcnt(28)
    s_barrier
    s_waitcnt lgkmcnt(2)
    v_mfma_f32_32x32x16_bf16 v[96:111], a[20:23], v[36:39], v[96:111]
    ds_read_b128 v[32:35], v18 offset:0
    v_mfma_f32_32x32x16_bf16 v[112:127], a[180:183], v[36:39], v[112:127]
    s_waitcnt lgkmcnt(2)
    v_mfma_f32_32x32x16_bf16 v[96:111], a[24:27], v[40:43], v[96:111]
    ds_read_b128 v[36:39], v19 offset:0
    v_mfma_f32_32x32x16_bf16 v[112:127], a[184:187], v[40:43], v[112:127]
    s_waitcnt lgkmcnt(2)
    v_mfma_f32_32x32x16_bf16 v[96:111], a[28:31], v[44:47], v[96:111]
    ds_read_b128 v[40:43], v20 offset:0
    v_mfma_f32_32x32x16_bf16 v[112:127], a[188:191], v[44:47], v[112:127]
    s_add_u32 s65, s53, 246016
    s_waitcnt lgkmcnt(2)
    v_mfma_f32_32x32x16_bf16 v[96:111], a[32:35], v[32:35], v[96:111]
    ds_read_b128 v[44:47], v21 offset:0
    v_mfma_f32_32x32x16_bf16 v[112:127], a[192:195], v[32:35], v[112:127]
    s_add_u32 s66, s79, 98304
    s_mov_b32 m0, s66
    s_nop 0
    buffer_load_dwordx4 v26, s[48:51], s65 offen lds
    s_waitcnt lgkmcnt(2)
    v_mfma_f32_32x32x16_bf16 v[96:111], a[36:39], v[36:39], v[96:111]
    ds_read_b128 v[32:35], v22 offset:0
    v_mfma_f32_32x32x16_bf16 v[112:127], a[196:199], v[36:39], v[112:127]
    s_add_u32 s66, s79, 99328
    s_mov_b32 m0, s66
    s_nop 0
    buffer_load_dwordx4 v27, s[48:51], s65 offen lds
    s_waitcnt lgkmcnt(2)
    v_mfma_f32_32x32x16_bf16 v[96:111], a[40:43], v[40:43], v[96:111]
    ds_read_b128 v[36:39], v23 offset:0
    v_mfma_f32_32x32x16_bf16 v[112:127], a[200:203], v[40:43], v[112:127]
    s_add_u32 s66, s79, 100352
    s_mov_b32 m0, s66
    s_nop 0
    buffer_load_dwordx4 v28, s[48:51], s65 offen lds
    s_waitcnt lgkmcnt(2)
    v_mfma_f32_32x32x16_bf16 v[96:111], a[44:47], v[44:47], v[96:111]
    ds_read_b128 v[40:43], v24 offset:0
    v_mfma_f32_32x32x16_bf16 v[112:127], a[204:207], v[44:47], v[112:127]
    s_add_u32 s66, s79, 101376
    s_mov_b32 m0, s66
    s_nop 0
    buffer_load_dwordx4 v29, s[48:51], s65 offen lds
    s_waitcnt lgkmcnt(2)
    v_mfma_f32_32x32x16_bf16 v[96:111], a[48:51], v[32:35], v[96:111]
    ds_read_b128 v[44:47], v25 offset:0
    v_mfma_f32_32x32x16_bf16 v[112:127], a[208:211], v[32:35], v[112:127]
    s_waitcnt vmcnt(28)
    s_barrier
    s_waitcnt lgkmcnt(2)
    v_mfma_f32_32x32x16_bf16 v[96:111], a[52:55], v[36:39], v[96:111]
    ds_read_b128 v[32:35], v18 offset:16384
    v_mfma_f32_32x32x16_bf16 v[112:127], a[212:215], v[36:39], v[112:127]
    s_waitcnt lgkmcnt(2)
    v_mfma_f32_32x32x16_bf16 v[96:111], a[56:59], v[40:43], v[96:111]
    ds_read_b128 v[36:39], v19 offset:16384
    v_mfma_f32_32x32x16_bf16 v[112:127], a[216:219], v[40:43], v[112:127]
    s_waitcnt lgkmcnt(2)
    v_mfma_f32_32x32x16_bf16 v[96:111], a[60:63], v[44:47], v[96:111]
    ds_read_b128 v[40:43], v20 offset:16384
    v_mfma_f32_32x32x16_bf16 v[112:127], a[220:223], v[44:47], v[112:127]
    s_add_u32 s65, s53, 246272
    s_waitcnt lgkmcnt(2)
    v_mfma_f32_32x32x16_bf16 v[96:111], a[64:67], v[32:35], v[96:111]
    ds_read_b128 v[44:47], v21 offset:16384
    v_mfma_f32_32x32x16_bf16 v[112:127], a[224:227], v[32:35], v[112:127]
    s_add_u32 s66, s79, 114688
    s_mov_b32 m0, s66
    s_nop 0
    buffer_load_dwordx4 v26, s[48:51], s65 offen lds
    s_waitcnt lgkmcnt(2)
    v_mfma_f32_32x32x16_bf16 v[96:111], a[68:71], v[36:39], v[96:111]
    ds_read_b128 v[32:35], v22 offset:16384
    v_mfma_f32_32x32x16_bf16 v[112:127], a[228:231], v[36:39], v[112:127]
    s_add_u32 s66, s79, 115712
    s_mov_b32 m0, s66
    s_nop 0
    buffer_load_dwordx4 v27, s[48:51], s65 offen lds
    s_waitcnt lgkmcnt(2)
    v_mfma_f32_32x32x16_bf16 v[96:111], a[72:75], v[40:43], v[96:111]
    ds_read_b128 v[36:39], v23 offset:16384
    v_mfma_f32_32x32x16_bf16 v[112:127], a[232:235], v[40:43], v[112:127]
    s_add_u32 s66, s79, 116736
    s_mov_b32 m0, s66
    s_nop 0
    buffer_load_dwordx4 v28, s[48:51], s65 offen lds
    s_waitcnt lgkmcnt(2)
    v_mfma_f32_32x32x16_bf16 v[96:111], a[76:79], v[44:47], v[96:111]
    ds_read_b128 v[40:43], v24 offset:16384
    v_mfma_f32_32x32x16_bf16 v[112:127], a[236:239], v[44:47], v[112:127]
    s_add_u32 s66, s79, 117760
    s_mov_b32 m0, s66
    s_nop 0
    buffer_load_dwordx4 v29, s[48:51], s65 offen lds
    s_waitcnt lgkmcnt(2)
    v_mfma_f32_32x32x16_bf16 v[96:111], a[80:83], v[32:35], v[96:111]
    ds_read_b128 v[44:47], v25 offset:16384
    v_mfma_f32_32x32x16_bf16 v[112:127], a[240:243], v[32:35], v[112:127]
    s_waitcnt vmcnt(28)
    s_barrier
    s_waitcnt lgkmcnt(2)
    v_mfma_f32_32x32x16_bf16 v[96:111], a[84:87], v[36:39], v[96:111]
    ds_read_b128 v[32:35], v2 offset:0
    v_mfma_f32_32x32x16_bf16 v[112:127], a[244:247], v[36:39], v[112:127]
    s_waitcnt lgkmcnt(2)
    v_mfma_f32_32x32x16_bf16 v[96:111], a[88:91], v[40:43], v[96:111]
    ds_read_b128 v[36:39], v3 offset:0
    v_mfma_f32_32x32x16_bf16 v[112:127], a[248:251], v[40:43], v[112:127]
    s_waitcnt lgkmcnt(2)
    v_mfma_f32_32x32x16_bf16 v[96:111], a[92:95], v[44:47], v[96:111]
    ds_read_b128 v[40:43], v4 offset:0
    v_mfma_f32_32x32x16_bf16 v[112:127], a[252:255], v[44:47], v[112:127]
    s_add_u32 s52, s52, 2
    s_add_u32 s53, s53, 163840
    s_cmp_lt_u32 s52, 16
    s_cbranch_scc1 L_g1_a1
    s_waitcnt lgkmcnt(0)
    s_nop 4
    v_cvt_pk_bf16_f32 v48, v96, v97
    v_cvt_pk_bf16_f32 v49, v98, v99
    v_cvt_pk_bf16_f32 v50, v100, v101
    v_cvt_pk_bf16_f32 v51, v102, v103
    buffer_store_dwordx4 v[48:51], v136, s[8:11], s54 offen offset:0 sc1
    v_cvt_pk_bf16_f32 v52, v104, v105
    v_cvt_pk_bf16_f32 v53, v106, v107
    v_cvt_pk_bf16_f32 v54, v108, v109
    v_cvt_pk_bf16_f32 v55, v110, v111
    buffer_store_dwordx4 v[52:55], v136, s[8:11], s54 offen offset:1024 sc1
    v_cvt_pk_bf16_f32 v56, v112, v113
    v_cvt_pk_bf16_f32 v57, v114, v115
    v_cvt_pk_bf16_f32 v58, v116, v117
    v_cvt_pk_bf16_f32 v59, v118, v119
    buffer_store_dwordx4 v[56:59], v136, s[8:11], s54 offen offset:2048 sc1
    v_cvt_pk_bf16_f32 v60, v120, v121
    v_cvt_pk_bf16_f32 v61, v122, v123
    v_cvt_pk_bf16_f32 v62, v124, v125
    v_cvt_pk_bf16_f32 v63, v126, v127
    buffer_store_dwordx4 v[60:63], v136, s[8:11], s54 offen offset:3072 sc1
    s_waitcnt vmcnt(0)
    s_barrier
    s_mov_b32 s79, 72327296
    s_cmp_lg_u32 s4, 0
    s_cbranch_scc1 L_ai_a1
    v_mov_b32 v128, 0
    v_mov_b32 v129, 1
    s_mov_b64 exec, 1
    buffer_atomic_add v129, v128, s[8:11], s79 offen sc1
    s_mov_b64 exec, -1
L_ai_a1:
L_a1_skip:
    s_mov_b32 s79, 72327296
    s_mov_b32 s12, s20
    s_and_b32 s13, s21, 0xffff
    s_mov_b32 s14, 0x6400
    s_mov_b32 s15, 0x20000
    v_lshrrev_b32 v8, 5, v0
    v_mul_u32_u24 v9, 20, v8
    s_mul_i32 s65, s101, 800
    buffer_load_ushort v136, v9, s[12:15], s65 offen offset:0
    buffer_load_ushort v137, v9, s[12:15], s65 offen offset:80
    buffer_load_ushort v138, v9, s[12:15], s65 offen offset:160
    buffer_load_ushort v139, v9, s[12:15], s65 offen offset:240
    buffer_load_ushort v140, v9, s[12:15], s65 offen offset:320
    buffer_load_ushort v141, v9, s[12:15], s65 offen offset:400
    buffer_load_ushort v142, v9, s[12:15], s65 offen offset:480
    buffer_load_ushort v143, v9, s[12:15], s65 offen offset:560
    buffer_load_ushort v144, v9, s[12:15], s65 offen offset:640
    buffer_load_ushort v145, v9, s[12:15], s65 offen offset:720
    buffer_load_ushort v146, v9, s[12:15], s65 offen offset:2
    buffer_load_ushort v147, v9, s[12:15], s65 offen offset:82
    buffer_load_ushort v148, v9, s[12:15], s65 offen offset:162
    buffer_load_ushort v149, v9, s[12:15], s65 offen offset:242
    buffer_load_ushort v150, v9, s[12:15], s65 offen offset:322
    buffer_load_ushort v151, v9, s[12:15], s65 offen offset:402
    buffer_load_ushort v152, v9, s[12:15], s65 offen offset:482
    buffer_load_ushort v153, v9, s[12:15], s65 offen offset:562
    buffer_load_ushort v154, v9, s[12:15], s65 offen offset:642
    buffer_load_ushort v155, v9, s[12:15], s65 offen offset:722
    buffer_load_ushort v156, v9, s[12:15], s65 offen offset:4
    buffer_load_ushort v157, v9, s[12:15], s65 offen offset:84
    buffer_load_ushort v158, v9, s[12:15], s65 offen offset:164
    buffer_load_ushort v159, v9, s[12:15], s65 offen offset:244
    buffer_load_ushort v160, v9, s[12:15], s65 offen offset:324
    buffer_load_ushort v161, v9, s[12:15], s65 offen offset:404
    buffer_load_ushort v162, v9, s[12:15], s65 offen offset:484
    buffer_load_ushort v163, v9, s[12:15], s65 offen offset:564
    buffer_load_ushort v164, v9, s[12:15], s65 offen offset:644
    buffer_load_ushort v165, v9, s[12:15], s65 offen offset:724
    s_waitcnt vmcnt(30)
    buffer_load_ushort v166, v9, s[12:15], s65 offen offset:6
    buffer_load_ushort v167, v9, s[12:15], s65 offen offset:86
    buffer_load_ushort v168, v9, s[12:15], s65 offen offset:166
    buffer_load_ushort v169, v9, s[12:15], s65 offen offset:246
    buffer_load_ushort v170, v9, s[12:15], s65 offen offset:326
    buffer_load_ushort v171, v9, s[12:15], s65 offen offset:406
    buffer_load_ushort v172, v9, s[12:15], s65 offen offset:486
    buffer_load_ushort v173, v9, s[12:15], s65 offen offset:566
    buffer_load_ushort v174, v9, s[12:15], s65 offen offset:646
    buffer_load_ushort v175, v9, s[12:15], s65 offen offset:726
    buffer_load_ushort v176, v9, s[12:15], s65 offen offset:8
    buffer_load_ushort v177, v9, s[12:15], s65 offen offset:88
    buffer_load_ushort v178, v9, s[12:15], s65 offen offset:168
    buffer_load_ushort v179, v9, s[12:15], s65 offen offset:248
    buffer_load_ushort v180, v9, s[12:15], s65 offen offset:328
    buffer_load_ushort v181, v9, s[12:15], s65 offen offset:408
    buffer_load_ushort v182, v9, s[12:15], s65 offen offset:488
    buffer_load_ushort v183, v9, s[12:15], s65 offen offset:568
    buffer_load_ushort v184, v9, s[12:15], s65 offen offset:648
    buffer_load_ushort v185, v9, s[12:15], s65 offen offset:728
    s_waitcnt vmcnt(0)
    buffer_load_ushort v20, v9, s[12:15], s65 offen offset:40
    buffer_load_ushort v21, v9, s[12:15], s65 offen offset:120
    buffer_load_ushort v22, v9, s[12:15], s65 offen offset:200
    buffer_load_ushort v23, v9, s[12:15], s65 offen offset:280
    buffer_load_ushort v24, v9, s[12:15], s65 offen offset:360
    buffer_load_ushort v25, v9, s[12:15], s65 offen offset:440
    buffer_load_ushort v26, v9, s[12:15], s65 offen offset:520
    buffer_load_ushort v27, v9, s[12:15], s65 offen offset:600
    buffer_load_ushort v28, v9, s[12:15], s65 offen offset:680
    buffer_load_ushort v29, v9, s[12:15], s65 offen offset:760
    buffer_load_ushort v30, v9, s[12:15], s65 offen offset:42
    buffer_load_ushort v31, v9, s[12:15], s65 offen offset:122
    buffer_load_ushort v32, v9, s[12:15], s65 offen offset:202
    buffer_load_ushort v33, v9, s[12:15], s65 offen offset:282
    buffer_load_ushort v34, v9, s[12:15], s65 offen offset:362
    buffer_load_ushort v35, v9, s[12:15], s65 offen offset:442
    buffer_load_ushort v36, v9, s[12:15], s65 offen offset:522
    buffer_load_ushort v37, v9, s[12:15], s65 offen offset:602
    buffer_load_ushort v38, v9, s[12:15], s65 offen offset:682
    buffer_load_ushort v39, v9, s[12:15], s65 offen offset:762
    buffer_load_ushort v40, v9, s[12:15], s65 offen offset:44
    buffer_load_ushort v41, v9, s[12:15], s65 offen offset:124
    buffer_load_ushort v42, v9, s[12:15], s65 offen offset:204
    buffer_load_ushort v43, v9, s[12:15], s65 offen offset:284
    buffer_load_ushort v44, v9, s[12:15], s65 offen offset:364
    buffer_load_ushort v45, v9, s[12:15], s65 offen offset:444
    buffer_load_ushort v46, v9, s[12:15], s65 offen offset:524
    buffer_load_ushort v47, v9, s[12:15], s65 offen offset:604
    buffer_load_ushort v48, v9, s[12:15], s65 offen offset:684
    buffer_load_ushort v49, v9, s[12:15], s65 offen offset:764
    buffer_load_ushort v50, v9, s[12:15], s65 offen offset:46
    buffer_load_ushort v51, v9, s[12:15], s65 offen offset:126
    buffer_load_ushort v52, v9, s[12:15], s65 offen offset:206
    buffer_load_ushort v53, v9, s[12:15], s65 offen offset:286
    buffer_load_ushort v54, v9, s[12:15], s65 offen offset:366
    buffer_load_ushort v55, v9, s[12:15], s65 offen offset:446
    buffer_load_ushort v56, v9, s[12:15], s65 offen offset:526
    buffer_load_ushort v57, v9, s[12:15], s65 offen offset:606
    buffer_load_ushort v58, v9, s[12:15], s65 offen offset:686
    buffer_load_ushort v59, v9, s[12:15], s65 offen offset:766
    buffer_load_ushort v60, v9, s[12:15], s65 offen offset:48
    buffer_load_ushort v61, v9, s[12:15], s65 offen offset:128
    buffer_load_ushort v62, v9, s[12:15], s65 offen offset:208
    buffer_load_ushort v63, v9, s[12:15], s65 offen offset:288
    buffer_load_ushort v64, v9, s[12:15], s65 offen offset:368
    buffer_load_ushort v65, v9, s[12:15], s65 offen offset:448
    buffer_load_ushort v66, v9, s[12:15], s65 offen offset:528
    buffer_load_ushort v67, v9, s[12:15], s65 offen offset:608
    buffer_load_ushort v68, v9, s[12:15], s65 offen offset:688
    buffer_load_ushort v69, v9, s[12:15], s65 offen offset:768
    s_waitcnt vmcnt(0)
    v_lshl_or_b32 v136, v20, 16, v136
    v_lshl_or_b32 v137, v21, 16, v137
    v_lshl_or_b32 v138, v22, 16, v138
    v_lshl_or_b32 v139, v23, 16, v139
    v_lshl_or_b32 v140, v24, 16, v140
    v_lshl_or_b32 v141, v25, 16, v141
    v_lshl_or_b32 v142, v26, 16, v142
    v_lshl_or_b32 v143, v27, 16, v143
    v_lshl_or_b32 v144, v28, 16, v144
    v_lshl_or_b32 v145, v29, 16, v145
    v_lshl_or_b32 v146, v30, 16, v146
    v_lshl_or_b32 v147, v31, 16, v147
    v_lshl_or_b32 v148, v32, 16, v148
    v_lshl_or_b32 v149, v33, 16, v149
    v_lshl_or_b32 v150, v34, 16, v150
    v_lshl_or_b32 v151, v35, 16, v151
    v_lshl_or_b32 v152, v36, 16, v152
    v_lshl_or_b32 v153, v37, 16, v153
    v_lshl_or_b32 v154, v38, 16, v154
    v_lshl_or_b32 v155, v39, 16, v155
    v_lshl_or_b32 v156, v40, 16, v156
    v_lshl_or_b32 v157, v41, 16, v157
    v_lshl_or_b32 v158, v42, 16, v158
    v_lshl_or_b32 v159, v43, 16, v159
    v_lshl_or_b32 v160, v44, 16, v160
    v_lshl_or_b32 v161, v45, 16, v161
    v_lshl_or_b32 v162, v46, 16, v162
    v_lshl_or_b32 v163, v47, 16, v163
    v_lshl_or_b32 v164, v48, 16, v164
    v_lshl_or_b32 v165, v49, 16, v165
    v_lshl_or_b32 v166, v50, 16, v166
    v_lshl_or_b32 v167, v51, 16, v167
    v_lshl_or_b32 v168, v52, 16, v168
    v_lshl_or_b32 v169, v53, 16, v169
    v_lshl_or_b32 v170, v54, 16, v170
    v_lshl_or_b32 v171, v55, 16, v171
    v_lshl_or_b32 v172, v56, 16, v172
    v_lshl_or_b32 v173, v57, 16, v173
    v_lshl_or_b32 v174, v58, 16, v174
    v_lshl_or_b32 v175, v59, 16, v175
    v_lshl_or_b32 v176, v60, 16, v176
    v_lshl_or_b32 v177, v61, 16, v177
    v_lshl_or_b32 v178, v62, 16, v178
    v_lshl_or_b32 v179, v63, 16, v179
    v_lshl_or_b32 v180, v64, 16, v180
    v_lshl_or_b32 v181, v65, 16, v181
    v_lshl_or_b32 v182, v66, 16, v182
    v_lshl_or_b32 v183, v67, 16, v183
    v_lshl_or_b32 v184, v68, 16, v184
    v_lshl_or_b32 v185, v69, 16, v185
    buffer_load_ushort v186, v9, s[12:15], s65 offen offset:10
    buffer_load_ushort v187, v9, s[12:15], s65 offen offset:90
    buffer_load_ushort v188, v9, s[12:15], s65 offen offset:170
    buffer_load_ushort v189, v9, s[12:15], s65 offen offset:250
    buffer_load_ushort v190, v9, s[12:15], s65 offen offset:330
    buffer_load_ushort v191, v9, s[12:15], s65 offen offset:410
    buffer_load_ushort v192, v9, s[12:15], s65 offen offset:490
    buffer_load_ushort v193, v9, s[12:15], s65 offen offset:570
    buffer_load_ushort v194, v9, s[12:15], s65 offen offset:650
    buffer_load_ushort v195, v9, s[12:15], s65 offen offset:730
    buffer_load_ushort v196, v9, s[12:15], s65 offen offset:12
    buffer_load_ushort v197, v9, s[12:15], s65 offen offset:92
    buffer_load_ushort v198, v9, s[12:15], s65 offen offset:172
    buffer_load_ushort v199, v9, s[12:15], s65 offen offset:252
    buffer_load_ushort v200, v9, s[12:15], s65 offen offset:332
    buffer_load_ushort v201, v9, s[12:15], s65 offen offset:412
    buffer_load_ushort v202, v9, s[12:15], s65 offen offset:492
    buffer_load_ushort v203, v9, s[12:15], s65 offen offset:572
    buffer_load_ushort v204, v9, s[12:15], s65 offen offset:652
    buffer_load_ushort v205, v9, s[12:15], s65 offen offset:732
    buffer_load_ushort v206, v9, s[12:15], s65 offen offset:14
    buffer_load_ushort v207, v9, s[12:15], s65 offen offset:94
    buffer_load_ushort v208, v9, s[12:15], s65 offen offset:174
    buffer_load_ushort v209, v9, s[12:15], s65 offen offset:254
    buffer_load_ushort v210, v9, s[12:15], s65 offen offset:334
    buffer_load_ushort v211, v9, s[12:15], s65 offen offset:414
    buffer_load_ushort v212, v9, s[12:15], s65 offen offset:494
    buffer_load_ushort v213, v9, s[12:15], s65 offen offset:574
    buffer_load_ushort v214, v9, s[12:15], s65 offen offset:654
    buffer_load_ushort v215, v9, s[12:15], s65 offen offset:734
    s_waitcnt vmcnt(30)
    buffer_load_ushort v216, v9, s[12:15], s65 offen offset:16
    buffer_load_ushort v217, v9, s[12:15], s65 offen offset:96
    buffer_load_ushort v218, v9, s[12:15], s65 offen offset:176
    buffer_load_ushort v219, v9, s[12:15], s65 offen offset:256
    buffer_load_ushort v220, v9, s[12:15], s65 offen offset:336
    buffer_load_ushort v221, v9, s[12:15], s65 offen offset:416
    buffer_load_ushort v222, v9, s[12:15], s65 offen offset:496
    buffer_load_ushort v223, v9, s[12:15], s65 offen offset:576
    buffer_load_ushort v224, v9, s[12:15], s65 offen offset:656
    buffer_load_ushort v225, v9, s[12:15], s65 offen offset:736
    buffer_load_ushort v226, v9, s[12:15], s65 offen offset:18
    buffer_load_ushort v227, v9, s[12:15], s65 offen offset:98
    buffer_load_ushort v228, v9, s[12:15], s65 offen offset:178
    buffer_load_ushort v229, v9, s[12:15], s65 offen offset:258
    buffer_load_ushort v230, v9, s[12:15], s65 offen offset:338
    buffer_load_ushort v231, v9, s[12:15], s65 offen offset:418
    buffer_load_ushort v232, v9, s[12:15], s65 offen offset:498
    buffer_load_ushort v233, v9, s[12:15], s65 offen offset:578
    buffer_load_ushort v234, v9, s[12:15], s65 offen offset:658
    buffer_load_ushort v235, v9, s[12:15], s65 offen offset:738
    s_waitcnt vmcnt(0)
    buffer_load_ushort v20, v9, s[12:15], s65 offen offset:50
    buffer_load_ushort v21, v9, s[12:15], s65 offen offset:130
    buffer_load_ushort v22, v9, s[12:15], s65 offen offset:210
    buffer_load_ushort v23, v9, s[12:15], s65 offen offset:290
    buffer_load_ushort v24, v9, s[12:15], s65 offen offset:370
    buffer_load_ushort v25, v9, s[12:15], s65 offen offset:450
    buffer_load_ushort v26, v9, s[12:15], s65 offen offset:530
    buffer_load_ushort v27, v9, s[12:15], s65 offen offset:610
    buffer_load_ushort v28, v9, s[12:15], s65 offen offset:690
    buffer_load_ushort v29, v9, s[12:15], s65 offen offset:770
    buffer_load_ushort v30, v9, s[12:15], s65 offen offset:52
    buffer_load_ushort v31, v9, s[12:15], s65 offen offset:132
    buffer_load_ushort v32, v9, s[12:15], s65 offen offset:212
    buffer_load_ushort v33, v9, s[12:15], s65 offen offset:292
    buffer_load_ushort v34, v9, s[12:15], s65 offen offset:372
    buffer_load_ushort v35, v9, s[12:15], s65 offen offset:452
    buffer_load_ushort v36, v9, s[12:15], s65 offen offset:532
    buffer_load_ushort v37, v9, s[12:15], s65 offen offset:612
    buffer_load_ushort v38, v9, s[12:15], s65 offen offset:692
    buffer_load_ushort v39, v9, s[12:15], s65 offen offset:772
    buffer_load_ushort v40, v9, s[12:15], s65 offen offset:54
    buffer_load_ushort v41, v9, s[12:15], s65 offen offset:134
    buffer_load_ushort v42, v9, s[12:15], s65 offen offset:214
    buffer_load_ushort v43, v9, s[12:15], s65 offen offset:294
    buffer_load_ushort v44, v9, s[12:15], s65 offen offset:374
    buffer_load_ushort v45, v9, s[12:15], s65 offen offset:454
    buffer_load_ushort v46, v9, s[12:15], s65 offen offset:534
    buffer_load_ushort v47, v9, s[12:15], s65 offen offset:614
    buffer_load_ushort v48, v9, s[12:15], s65 offen offset:694
    buffer_load_ushort v49, v9, s[12:15], s65 offen offset:774
    buffer_load_ushort v50, v9, s[12:15], s65 offen offset:56
    buffer_load_ushort v51, v9, s[12:15], s65 offen offset:136
    buffer_load_ushort v52, v9, s[12:15], s65 offen offset:216
    buffer_load_ushort v53, v9, s[12:15], s65 offen offset:296
    buffer_load_ushort v54, v9, s[12:15], s65 offen offset:376
    buffer_load_ushort v55, v9, s[12:15], s65 offen offset:456
    buffer_load_ushort v56, v9, s[12:15], s65 offen offset:536
    buffer_load_ushort v57, v9, s[12:15], s65 offen offset:616
    buffer_load_ushort v58, v9, s[12:15], s65 offen offset:696
    buffer_load_ushort v59, v9, s[12:15], s65 offen offset:776
    buffer_load_ushort v60, v9, s[12:15], s65 offen offset:58
    buffer_load_ushort v61, v9, s[12:15], s65 offen offset:138
    buffer_load_ushort v62, v9, s[12:15], s65 offen offset:218
    buffer_load_ushort v63, v9, s[12:15], s65 offen offset:298
    buffer_load_ushort v64, v9, s[12:15], s65 offen offset:378
    buffer_load_ushort v65, v9, s[12:15], s65 offen offset:458
    buffer_load_ushort v66, v9, s[12:15], s65 offen offset:538
    buffer_load_ushort v67, v9, s[12:15], s65 offen offset:618
    buffer_load_ushort v68, v9, s[12:15], s65 offen offset:698
    buffer_load_ushort v69, v9, s[12:15], s65 offen offset:778
    s_waitcnt vmcnt(0)
    v_lshl_or_b32 v186, v20, 16, v186
    v_lshl_or_b32 v187, v21, 16, v187
    v_lshl_or_b32 v188, v22, 16, v188
    v_lshl_or_b32 v189, v23, 16, v189
    v_lshl_or_b32 v190, v24, 16, v190
    v_lshl_or_b32 v191, v25, 16, v191
    v_lshl_or_b32 v192, v26, 16, v192
    v_lshl_or_b32 v193, v27, 16, v193
    v_lshl_or_b32 v194, v28, 16, v194
    v_lshl_or_b32 v195, v29, 16, v195
    v_lshl_or_b32 v196, v30, 16, v196
    v_lshl_or_b32 v197, v31, 16, v197
    v_lshl_or_b32 v198, v32, 16, v198
    v_lshl_or_b32 v199, v33, 16, v199
    v_lshl_or_b32 v200, v34, 16, v200
    v_lshl_or_b32 v201, v35, 16, v201
    v_lshl_or_b32 v202, v36, 16, v202
    v_lshl_or_b32 v203, v37, 16, v203
    v_lshl_or_b32 v204, v38, 16, v204
    v_lshl_or_b32 v205, v39, 16, v205
    v_lshl_or_b32 v206, v40, 16, v206
    v_lshl_or_b32 v207, v41, 16, v207
    v_lshl_or_b32 v208, v42, 16, v208
    v_lshl_or_b32 v209, v43, 16, v209
    v_lshl_or_b32 v210, v44, 16, v210
    v_lshl_or_b32 v211, v45, 16, v211
    v_lshl_or_b32 v212, v46, 16, v212
    v_lshl_or_b32 v213, v47, 16, v213
    v_lshl_or_b32 v214, v48, 16, v214
    v_lshl_or_b32 v215, v49, 16, v215
    v_lshl_or_b32 v216, v50, 16, v216
    v_lshl_or_b32 v217, v51, 16, v217
    v_lshl_or_b32 v218, v52, 16, v218
    v_lshl_or_b32 v219, v53, 16, v219
    v_lshl_or_b32 v220, v54, 16, v220
    v_lshl_or_b32 v221, v55, 16, v221
    v_lshl_or_b32 v222, v56, 16, v222
    v_lshl_or_b32 v223, v57, 16, v223
    v_lshl_or_b32 v224, v58, 16, v224
    v_lshl_or_b32 v225, v59, 16, v225
    v_lshl_or_b32 v226, v60, 16, v226
    v_lshl_or_b32 v227, v61, 16, v227
    v_lshl_or_b32 v228, v62, 16, v228
    v_lshl_or_b32 v229, v63, 16, v229
    v_lshl_or_b32 v230, v64, 16, v230
    v_lshl_or_b32 v231, v65, 16, v231
    v_lshl_or_b32 v232, v66, 16, v232
    v_lshl_or_b32 v233, v67, 16, v233
    v_lshl_or_b32 v234, v68, 16, v234
    v_lshl_or_b32 v235, v69, 16, v235
    v_mov_b32 v120, 0x3fb8aa3b
    v_mov_b32 v10, 0xbfb8aa3b
    v_cmp_eq_u32 vcc, 1, v8
    s_nop 1
    v_cndmask_b32 v120, v120, v10, vcc
    v_and_b32 v10, 31, v0
    v_lshlrev_b32 v124, 4, v10
    s_mul_i32 s66, s4, 5120
    v_mul_u32_u24 v121, 80, v10
    v_mul_u32_u24 v11, 40, v8
    v_add3_u32 v121, v121, v11, s66
    v_lshlrev_b32 v122, 6, v10
    v_add_u32 v122, s66, v122
    v_mov_b32 v18, 0x3f80
    v_mov_b32 v19, 0
    ds_write_b64 v122, v[18:19] offset:2600
    ds_write_b64 v122, v[18:19] offset:2608
    v_mov_b32 v18, 0
    ds_write_b64 v122, v[18:19] offset:2616
    v_bfe_u32 v10, v0, 2, 2
    v_lshl_add_u32 v10, v8, 3, v10
    v_bfe_u32 v11, v0, 4, 1
    v_add_u32 v11, 0, v11
    v_lshlrev_b32 v11, 3, v11
    v_bfe_u32 v12, v0, 1, 1
    v_lshl_add_u32 v11, v12, 2, v11
    v_cmp_gt_u32 vcc, 20, v11
    v_and_b32 v12, 1, v0
    v_mul_u32_u24 v12, 20, v12
    v_add_u32 v11, v11, v12
    v_cndmask_b32 v11, 0, v11, vcc
    v_lshlrev_b32 v11, 1, v11
    v_mul_u32_u24 v123, 80, v10
    v_add3_u32 v123, v123, v11, s66
    v_bfe_u32 v11, v0, 4, 1
    v_add_u32 v11, 2, v11
    v_lshlrev_b32 v11, 3, v11
    v_bfe_u32 v12, v0, 1, 1
    v_lshl_add_u32 v11, v12, 2, v11
    v_cmp_gt_u32 vcc, 20, v11
    v_and_b32 v12, 1, v0
    v_mul_u32_u24 v12, 20, v12
    v_add_u32 v11, v11, v12
    v_cndmask_b32 v11, 0, v11, vcc
    v_lshlrev_b32 v11, 1, v11
    v_mul_u32_u24 v236, 80, v10
    v_add3_u32 v236, v236, v11, s66
    v_lshlrev_b32 v237, 6, v10
    v_bfe_u32 v11, v0, 4, 1
    v_lshl_add_u32 v237, v11, 5, v237
    v_and_b32 v11, 3, v0
    v_lshl_add_u32 v237, v11, 3, v237
    v_add_u32 v237, s66, v237
    v_mov_b32 v76, 0
    v_mov_b32 v77, 0
    v_mov_b32 v78, 0
    v_mov_b32 v79, 0
    v_mov_b32 v80, 0
    v_mov_b32 v81, 0
    v_mov_b32 v82, 0
    v_mov_b32 v83, 0
    v_mov_b32 v84, 0
    v_mov_b32 v85, 0
    v_mov_b32 v86, 0
    v_mov_b32 v87, 0
    v_mov_b32 v88, 0
    v_mov_b32 v89, 0
    v_mov_b32 v90, 0
    v_mov_b32 v91, 0
    v_mov_b32 v92, 0
    v_mov_b32 v93, 0
    v_mov_b32 v94, 0
    v_mov_b32 v95, 0
    v_mov_b32 v96, 0
    v_mov_b32 v97, 0
    v_mov_b32 v98, 0
    v_mov_b32 v99, 0
    v_mov_b32 v100, 0
    v_mov_b32 v101, 0
    v_mov_b32 v102, 0
    v_mov_b32 v103, 0
    v_mov_b32 v104, 0
    v_mov_b32 v105, 0
    v_mov_b32 v106, 0
    v_mov_b32 v107, 0
    v_mov_b32 v58, 0
    v_mov_b32 v59, 0
    s_waitcnt vmcnt(0)
    s_cmp_lg_u32 s4, 0
    s_cbranch_scc1 L_wcok_a2
    v_min_u32 v128, 0, v0
    v_lshlrev_b32 v128, 2, v128
L_wc_a2:
    buffer_load_dword v129, v128, s[8:11], s79 offen sc1
    s_waitcnt vmcnt(0)
    v_cmp_gt_u32 vcc, 30, v129
    s_cbranch_vccz L_wcok_a2
    s_sleep 8
    s_cmp_eq_u32 s46, 0
    s_cbranch_scc1 L_wcok_a2
    s_sub_u32 s46, s46, 1
    s_branch L_wc_a2
L_wcok_a2:
    s_barrier
    s_mov_b32 s49, s4
    s_mul_i32 s48, s101, 20
    s_lshr_b32 s48, s48, 3
    s_lshl_b32 s48, s48, 9
    s_add_u32 s48, s48, 139460608
    s_mul_i32 s65, s49, 122880
    s_add_u32 s65, s65, s48
    s_add_u32 s66, s65, 40960
    s_add_u32 s67, s65, 81920
    buffer_load_dwordx4 a[0:3], v124, s[8:11], s66 offen offset:0 sc1
    buffer_load_dwordx4 a[4:7], v124, s[8:11], s66 offen offset:512 sc1
    buffer_load_dwordx4 a[8:11], v124, s[8:11], s66 offen offset:1024 sc1
    buffer_load_dwordx4 a[12:15], v124, s[8:11], s67 offen offset:0 sc1
    buffer_load_dwordx4 a[16:19], v124, s[8:11], s67 offen offset:512 sc1
    buffer_load_dwordx4 a[20:23], v124, s[8:11], s67 offen offset:1024 sc1
L_a2:
    s_waitcnt vmcnt(0)
    s_bitcmp1_b32 s101, 0
    s_cbranch_scc1 L_oddk
    v_accvgpr_read_b32 v8, a0
    v_accvgpr_read_b32 v9, a1
    v_accvgpr_read_b32 v10, a2
    v_accvgpr_read_b32 v11, a3
    v_accvgpr_read_b32 v12, a4
    v_accvgpr_read_b32 v13, a5
    v_accvgpr_read_b32 v14, a6
    v_accvgpr_read_b32 v15, a7
    v_accvgpr_read_b32 v16, a8
    v_accvgpr_read_b32 v17, a9
    s_branch L_tkk
L_oddk:
    v_accvgpr_read_b32 v8, a2
    v_accvgpr_read_b32 v9, a3
    v_accvgpr_read_b32 v10, a4
    v_accvgpr_read_b32 v11, a5
    v_accvgpr_read_b32 v12, a6
    v_accvgpr_read_b32 v13, a7
    v_accvgpr_read_b32 v14, a8
    v_accvgpr_read_b32 v15, a9
    v_accvgpr_read_b32 v16, a10
    v_accvgpr_read_b32 v17, a11
L_tkk:
    s_bitcmp1_b32 s101, 0
    s_cbranch_scc1 L_oddv
    v_accvgpr_read_b32 v18, a12
    v_accvgpr_read_b32 v19, a13
    v_accvgpr_read_b32 v20, a14
    v_accvgpr_read_b32 v21, a15
    v_accvgpr_read_b32 v22, a16
    v_accvgpr_read_b32 v23, a17
    v_accvgpr_read_b32 v24, a18
    v_accvgpr_read_b32 v25, a19
    v_accvgpr_read_b32 v26, a20
    v_accvgpr_read_b32 v27, a21
    s_branch L_tkv
L_oddv:
    v_accvgpr_read_b32 v18, a14
    v_accvgpr_read_b32 v19, a15
    v_accvgpr_read_b32 v20, a16
    v_accvgpr_read_b32 v21, a17
    v_accvgpr_read_b32 v22, a18
    v_accvgpr_read_b32 v23, a19
    v_accvgpr_read_b32 v24, a20
    v_accvgpr_read_b32 v25, a21
    v_accvgpr_read_b32 v26, a22
    v_accvgpr_read_b32 v27, a23
L_tkv:
    s_add_u32 s49, s49, 4
    s_mul_i32 s65, s49, 122880
    s_add_u32 s65, s65, s48
    s_add_u32 s66, s65, 40960
    s_add_u32 s67, s65, 81920
    buffer_load_dwordx4 a[0:3], v124, s[8:11], s66 offen offset:0 sc1
    buffer_load_dwordx4 a[4:7], v124, s[8:11], s66 offen offset:512 sc1
    buffer_load_dwordx4 a[8:11], v124, s[8:11], s66 offen offset:1024 sc1
    buffer_load_dwordx4 a[12:15], v124, s[8:11], s67 offen offset:0 sc1
    buffer_load_dwordx4 a[16:19], v124, s[8:11], s67 offen offset:512 sc1
    buffer_load_dwordx4 a[20:23], v124, s[8:11], s67 offen offset:1024 sc1
    ds_write_b64 v122, v[18:19] offset:2560
    ds_write_b64 v122, v[20:21] offset:2568
    ds_write_b64 v122, v[22:23] offset:2576
    ds_write_b64 v122, v[24:25] offset:2584
    ds_write_b64 v122, v[26:27] offset:2592
    v_dot2_f32_bf16 v28, v8, v136, 0
    v_dot2_f32_bf16 v28, v9, v137, v28
    v_dot2_f32_bf16 v28, v10, v138, v28
    v_dot2_f32_bf16 v28, v11, v139, v28
    v_dot2_f32_bf16 v28, v12, v140, v28
    v_dot2_f32_bf16 v28, v13, v141, v28
    v_dot2_f32_bf16 v28, v14, v142, v28
    v_dot2_f32_bf16 v28, v15, v143, v28
    v_dot2_f32_bf16 v28, v16, v144, v28
    v_dot2_f32_bf16 v28, v17, v145, v28
    v_dot2_f32_bf16 v29, v8, v146, 0
    v_dot2_f32_bf16 v29, v9, v147, v29
    v_dot2_f32_bf16 v29, v10, v148, v29
    v_dot2_f32_bf16 v29, v11, v149, v29
    v_dot2_f32_bf16 v29, v12, v150, v29
    v_dot2_f32_bf16 v29, v13, v151, v29
    v_dot2_f32_bf16 v29, v14, v152, v29
    v_dot2_f32_bf16 v29, v15, v153, v29
    v_dot2_f32_bf16 v29, v16, v154, v29
    v_dot2_f32_bf16 v29, v17, v155, v29
    v_dot2_f32_bf16 v30, v8, v156, 0
    v_dot2_f32_bf16 v30, v9, v157, v30
    v_dot2_f32_bf16 v30, v10, v158, v30
    v_dot2_f32_bf16 v30, v11, v159, v30
    v_dot2_f32_bf16 v30, v12, v160, v30
    v_dot2_f32_bf16 v30, v13, v161, v30
    v_dot2_f32_bf16 v30, v14, v162, v30
    v_dot2_f32_bf16 v30, v15, v163, v30
    v_dot2_f32_bf16 v30, v16, v164, v30
    v_dot2_f32_bf16 v30, v17, v165, v30
    v_dot2_f32_bf16 v31, v8, v166, 0
    v_dot2_f32_bf16 v31, v9, v167, v31
    v_dot2_f32_bf16 v31, v10, v168, v31
    v_dot2_f32_bf16 v31, v11, v169, v31
    v_dot2_f32_bf16 v31, v12, v170, v31
    v_dot2_f32_bf16 v31, v13, v171, v31
    v_dot2_f32_bf16 v31, v14, v172, v31
    v_dot2_f32_bf16 v31, v15, v173, v31
    v_dot2_f32_bf16 v31, v16, v174, v31
    v_dot2_f32_bf16 v31, v17, v175, v31
    v_dot2_f32_bf16 v32, v8, v176, 0
    v_dot2_f32_bf16 v32, v9, v177, v32
    v_dot2_f32_bf16 v32, v10, v178, v32
    v_dot2_f32_bf16 v32, v11, v179, v32
    v_dot2_f32_bf16 v32, v12, v180, v32
    v_dot2_f32_bf16 v32, v13, v181, v32
    v_dot2_f32_bf16 v32, v14, v182, v32
    v_dot2_f32_bf16 v32, v15, v183, v32
    v_dot2_f32_bf16 v32, v16, v184, v32
    v_dot2_f32_bf16 v32, v17, v185, v32
    v_dot2_f32_bf16 v33, v8, v186, 0
    v_dot2_f32_bf16 v33, v9, v187, v33
    v_dot2_f32_bf16 v33, v10, v188, v33
    v_dot2_f32_bf16 v33, v11, v189, v33
    v_dot2_f32_bf16 v33, v12, v190, v33
    v_dot2_f32_bf16 v33, v13, v191, v33
    v_dot2_f32_bf16 v33, v14, v192, v33
    v_dot2_f32_bf16 v33, v15, v193, v33
    v_dot2_f32_bf16 v33, v16, v194, v33
    v_dot2_f32_bf16 v33, v17, v195, v33
    v_dot2_f32_bf16 v34, v8, v196, 0
    v_dot2_f32_bf16 v34, v9, v197, v34
    v_dot2_f32_bf16 v34, v10, v198, v34
    v_dot2_f32_bf16 v34, v11, v199, v34
    v_dot2_f32_bf16 v34, v12, v200, v34
    v_dot2_f32_bf16 v34, v13, v201, v34
    v_dot2_f32_bf16 v34, v14, v202, v34
    v_dot2_f32_bf16 v34, v15, v203, v34
    v_dot2_f32_bf16 v34, v16, v204, v34
    v_dot2_f32_bf16 v34, v17, v205, v34
    v_dot2_f32_bf16 v35, v8, v206, 0
    v_dot2_f32_bf16 v35, v9, v207, v35
    v_dot2_f32_bf16 v35, v10, v208, v35
    v_dot2_f32_bf16 v35, v11, v209, v35
    v_dot2_f32_bf16 v35, v12, v210, v35
    v_dot2_f32_bf16 v35, v13, v211, v35
    v_dot2_f32_bf16 v35, v14, v212, v35
    v_dot2_f32_bf16 v35, v15, v213, v35
    v_dot2_f32_bf16 v35, v16, v214, v35
    v_dot2_f32_bf16 v35, v17, v215, v35
    v_dot2_f32_bf16 v36, v8, v216, 0
    v_dot2_f32_bf16 v36, v9, v217, v36
    v_dot2_f32_bf16 v36, v10, v218, v36
    v_dot2_f32_bf16 v36, v11, v219, v36
    v_dot2_f32_bf16 v36, v12, v220, v36
    v_dot2_f32_bf16 v36, v13, v221, v36
    v_dot2_f32_bf16 v36, v14, v222, v36
    v_dot2_f32_bf16 v36, v15, v223, v36
    v_dot2_f32_bf16 v36, v16, v224, v36
    v_dot2_f32_bf16 v36, v17, v225, v36
    v_dot2_f32_bf16 v37, v8, v226, 0
    v_dot2_f32_bf16 v37, v9, v227, v37
    v_dot2_f32_bf16 v37, v10, v228, v37
    v_dot2_f32_bf16 v37, v11, v229, v37
    v_dot2_f32_bf16 v37, v12, v230, v37
    v_dot2_f32_bf16 v37, v13, v231, v37
    v_dot2_f32_bf16 v37, v14, v232, v37
    v_dot2_f32_bf16 v37, v15, v233, v37
    v_dot2_f32_bf16 v37, v16, v234, v37
    v_dot2_f32_bf16 v37, v17, v235, v37
    v_cvt_pk_bf16_f32 v48, v28, v29
    v_cvt_pk_bf16_f32 v49, v30, v31
    v_cvt_pk_bf16_f32 v50, v32, v33
    v_cvt_pk_bf16_f32 v51, v34, v35
    v_cvt_pk_bf16_f32 v52, v36, v37
    v_lshlrev_b32 v28, 16, v48
    v_and_b32 v29, 0xffff0000, v48
    v_lshlrev_b32 v30, 16, v49
    v_and_b32 v31, 0xffff0000, v49
    v_lshlrev_b32 v32, 16, v50
    v_and_b32 v33, 0xffff0000, v50
    v_lshlrev_b32 v34, 16, v51
    v_and_b32 v35, 0xffff0000, v51
    v_lshlrev_b32 v36, 16, v52
    v_and_b32 v37, 0xffff0000, v52
    v_mov_b32 v38, v28
    v_mov_b32 v39, v29
    v_mov_b32 v40, v30
    v_mov_b32 v41, v31
    v_mov_b32 v42, v32
    v_mov_b32 v43, v33
    v_mov_b32 v44, v34
    v_mov_b32 v45, v35
    v_mov_b32 v46, v36
    v_mov_b32 v47, v37
    v_permlane32_swap_b32 v28, v38
    v_permlane32_swap_b32 v29, v39
    v_permlane32_swap_b32 v30, v40
    v_permlane32_swap_b32 v31, v41
    v_permlane32_swap_b32 v32, v42
    v_permlane32_swap_b32 v33, v43
    v_permlane32_swap_b32 v34, v44
    v_permlane32_swap_b32 v35, v45
    v_permlane32_swap_b32 v36, v46
    v_permlane32_swap_b32 v37, v47
    v_mul_f32 v28, v28, v120
    v_mul_f32 v29, v29, v120
    v_mul_f32 v30, v30, v120
    v_mul_f32 v31, v31, v120
    v_mul_f32 v32, v32, v120
    v_mul_f32 v33, v33, v120
    v_mul_f32 v34, v34, v120
    v_mul_f32 v35, v35, v120
    v_mul_f32 v36, v36, v120
    v_mul_f32 v37, v37, v120
    v_mul_f32 v38, v38, v120
    v_mul_f32 v39, v39, v120
    v_mul_f32 v40, v40, v120
    v_mul_f32 v41, v41, v120
    v_mul_f32 v42, v42, v120
    v_mul_f32 v43, v43, v120
    v_mul_f32 v44, v44, v120
    v_mul_f32 v45, v45, v120
    v_mul_f32 v46, v46, v120
    v_mul_f32 v47, v47, v120
    v_max3_f32 v60, v28, v29, v30
    v_max3_f32 v61, v31, v32, v33
    v_max3_f32 v60, v60, v34, v35
    v_max3_f32 v61, v61, v36, v37
    v_max3_f32 v60, v60, v38, v39
    v_max3_f32 v61, v61, v40, v41
    v_max3_f32 v60, v60, v42, v43
    v_max3_f32 v61, v61, v44, v45
    v_max3_f32 v60, v60, v46, v47
    v_max_f32 v60, v60, v61
    v_sub_f32 v28, v28, v60
    v_sub_f32 v29, v29, v60
    v_sub_f32 v30, v30, v60
    v_sub_f32 v31, v31, v60
    v_sub_f32 v32, v32, v60
    v_sub_f32 v33, v33, v60
    v_sub_f32 v34, v34, v60
    v_sub_f32 v35, v35, v60
    v_sub_f32 v36, v36, v60
    v_sub_f32 v37, v37, v60
    v_sub_f32 v38, v38, v60
    v_sub_f32 v39, v39, v60
    v_sub_f32 v40, v40, v60
    v_sub_f32 v41, v41, v60
    v_sub_f32 v42, v42, v60
    v_sub_f32 v43, v43, v60
    v_sub_f32 v44, v44, v60
    v_sub_f32 v45, v45, v60
    v_sub_f32 v46, v46, v60
    v_sub_f32 v47, v47, v60
    v_exp_f32 v28, v28
    v_exp_f32 v29, v29
    v_exp_f32 v30, v30
    v_exp_f32 v31, v31
    v_exp_f32 v32, v32
    v_exp_f32 v33, v33
    v_exp_f32 v34, v34
    v_exp_f32 v35, v35
    v_exp_f32 v36, v36
    v_exp_f32 v37, v37
    v_exp_f32 v38, v38
    v_exp_f32 v39, v39
    v_exp_f32 v40, v40
    v_exp_f32 v41, v41
    v_exp_f32 v42, v42
    v_exp_f32 v43, v43
    v_exp_f32 v44, v44
    v_exp_f32 v45, v45
    v_exp_f32 v46, v46
    v_exp_f32 v47, v47
    v_add_f32 v60, v28, v29
    v_add_f32 v61, v30, v31
    v_add_f32 v60, v60, v32
    v_add_f32 v61, v61, v33
    v_add_f32 v61, v61, v34
    v_add_f32 v60, v60, v35
    v_add_f32 v60, v60, v36
    v_add_f32 v61, v61, v37
    v_add_f32 v61, v61, v38
    v_add_f32 v60, v60, v39
    v_add_f32 v60, v60, v40
    v_add_f32 v61, v61, v41
    v_add_f32 v61, v61, v42
    v_add_f32 v60, v60, v43
    v_add_f32 v60, v60, v44
    v_add_f32 v61, v61, v45
    v_add_f32 v61, v61, v46
    v_add_f32 v60, v60, v47
    v_add_f32 v60, v60, v61
    v_rcp_f32 v60, v60
    s_nop 0
    v_mul_f32 v28, v28, v60
    v_mul_f32 v29, v29, v60
    v_mul_f32 v30, v30, v60
    v_mul_f32 v31, v31, v60
    v_mul_f32 v32, v32, v60
    v_mul_f32 v33, v33, v60
    v_mul_f32 v34, v34, v60
    v_mul_f32 v35, v35, v60
    v_mul_f32 v36, v36, v60
    v_mul_f32 v37, v37, v60
    v_mul_f32 v38, v38, v60
    v_mul_f32 v39, v39, v60
    v_mul_f32 v40, v40, v60
    v_mul_f32 v41, v41, v60
    v_mul_f32 v42, v42, v60
    v_mul_f32 v43, v43, v60
    v_mul_f32 v44, v44, v60
    v_mul_f32 v45, v45, v60
    v_mul_f32 v46, v46, v60
    v_mul_f32 v47, v47, v60
    v_cvt_pk_bf16_f32 v48, v28, v29
    v_cvt_pk_bf16_f32 v49, v30, v31
    v_cvt_pk_bf16_f32 v50, v32, v33
    v_cvt_pk_bf16_f32 v51, v34, v35
    v_cvt_pk_bf16_f32 v52, v36, v37
    v_cvt_pk_bf16_f32 v53, v38, v39
    v_cvt_pk_bf16_f32 v54, v40, v41
    v_cvt_pk_bf16_f32 v55, v42, v43
    v_cvt_pk_bf16_f32 v56, v44, v45
    v_cvt_pk_bf16_f32 v57, v46, v47
    ds_write_b64 v121, v[48:49] offset:0
    ds_write_b64 v121, v[50:51] offset:8
    ds_write_b64 v121, v[52:53] offset:16
    ds_write_b64 v121, v[54:55] offset:24
    ds_write_b64 v121, v[56:57] offset:32
    s_waitcnt lgkmcnt(0)
    ds_read_b64_tr_b16 v[60:61], v123 offset:0
    ds_read_b64_tr_b16 v[64:65], v236 offset:0
    ds_read_b64_tr_b16 v[68:69], v237 offset:2560
    ds_read_b64_tr_b16 v[62:63], v123 offset:320
    ds_read_b64_tr_b16 v[66:67], v236 offset:320
    ds_read_b64_tr_b16 v[70:71], v237 offset:2816
    s_waitcnt lgkmcnt(0)
    v_mfma_f32_32x32x16_bf16 v[76:91], v[60:63], v[68:71], v[76:91]
    v_mfma_f32_32x32x16_bf16 v[92:107], v[64:67], v[68:71], v[92:107]
    s_nop 7
    ds_read_b64_tr_b16 v[60:61], v123 offset:1280
    ds_read_b64_tr_b16 v[64:65], v236 offset:1280
    ds_read_b64_tr_b16 v[68:69], v237 offset:3584
    ds_read_b64_tr_b16 v[62:63], v123 offset:1600
    ds_read_b64_tr_b16 v[66:67], v236 offset:1600
    ds_read_b64_tr_b16 v[70:71], v237 offset:3840
    s_waitcnt lgkmcnt(0)
    v_mfma_f32_32x32x16_bf16 v[76:91], v[60:63], v[68:71], v[76:91]
    v_mfma_f32_32x32x16_bf16 v[92:107], v[64:67], v[68:71], v[92:107]
    s_nop 7
    s_cmp_lt_u32 s49, 64
    s_cbranch_scc1 L_a2
    s_waitcnt vmcnt(0)
    s_nop 7
    s_nop 7
    s_lshl_b32 s65, s4, 13
    v_add_u32 v8, s65, v1
    ds_write_b128 v8, v[76:79] offset:24576
    ds_write_b128 v8, v[80:83] offset:25600
    ds_write_b128 v8, v[84:87] offset:26624
    ds_write_b128 v8, v[88:91] offset:27648
    ds_write_b128 v8, v[92:95] offset:28672
    ds_write_b128 v8, v[96:99] offset:29696
    ds_write_b128 v8, v[100:103] offset:30720
    ds_write_b128 v8, v[104:107] offset:31744
    s_waitcnt lgkmcnt(0)
    s_barrier
    ds_read_b128 v[8:11], v1 offset:24576
    ds_read_b128 v[12:15], v1 offset:25600
    ds_read_b128 v[16:19], v1 offset:26624
    ds_read_b128 v[20:23], v1 offset:27648
    ds_read_b128 v[24:27], v1 offset:28672
    ds_read_b128 v[28:31], v1 offset:29696
    ds_read_b128 v[32:35], v1 offset:30720
    ds_read_b128 v[36:39], v1 offset:31744
    s_waitcnt lgkmcnt(0)
    v_mov_b32 v76, v8
    v_mov_b32 v77, v9
    v_mov_b32 v78, v10
    v_mov_b32 v79, v11
    v_mov_b32 v80, v12
    v_mov_b32 v81, v13
    v_mov_b32 v82, v14
    v_mov_b32 v83, v15
    v_mov_b32 v84, v16
    v_mov_b32 v85, v17
    v_mov_b32 v86, v18
    v_mov_b32 v87, v19
    v_mov_b32 v88, v20
    v_mov_b32 v89, v21
    v_mov_b32 v90, v22
    v_mov_b32 v91, v23
    v_mov_b32 v92, v24
    v_mov_b32 v93, v25
    v_mov_b32 v94, v26
    v_mov_b32 v95, v27
    v_mov_b32 v96, v28
    v_mov_b32 v97, v29
    v_mov_b32 v98, v30
    v_mov_b32 v99, v31
    v_mov_b32 v100, v32
    v_mov_b32 v101, v33
    v_mov_b32 v102, v34
    v_mov_b32 v103, v35
    v_mov_b32 v104, v36
    v_mov_b32 v105, v37
    v_mov_b32 v106, v38
    v_mov_b32 v107, v39
    ds_read_b128 v[8:11], v1 offset:32768
    ds_read_b128 v[12:15], v1 offset:33792
    ds_read_b128 v[16:19], v1 offset:34816
    ds_read_b128 v[20:23], v1 offset:35840
    ds_read_b128 v[24:27], v1 offset:36864
    ds_read_b128 v[28:31], v1 offset:37888
    ds_read_b128 v[32:35], v1 offset:38912
    ds_read_b128 v[36:39], v1 offset:39936
    s_waitcnt lgkmcnt(0)
    v_add_f32 v76, v76, v8
    v_add_f32 v77, v77, v9
    v_add_f32 v78, v78, v10
    v_add_f32 v79, v79, v11
    v_add_f32 v80, v80, v12
    v_add_f32 v81, v81, v13
    v_add_f32 v82, v82, v14
    v_add_f32 v83, v83, v15
    v_add_f32 v84, v84, v16
    v_add_f32 v85, v85, v17
    v_add_f32 v86, v86, v18
    v_add_f32 v87, v87, v19
    v_add_f32 v88, v88, v20
    v_add_f32 v89, v89, v21
    v_add_f32 v90, v90, v22
    v_add_f32 v91, v91, v23
    v_add_f32 v92, v92, v24
    v_add_f32 v93, v93, v25
    v_add_f32 v94, v94, v26
    v_add_f32 v95, v95, v27
    v_add_f32 v96, v96, v28
    v_add_f32 v97, v97, v29
    v_add_f32 v98, v98, v30
    v_add_f32 v99, v99, v31
    v_add_f32 v100, v100, v32
    v_add_f32 v101, v101, v33
    v_add_f32 v102, v102, v34
    v_add_f32 v103, v103, v35
    v_add_f32 v104, v104, v36
    v_add_f32 v105, v105, v37
    v_add_f32 v106, v106, v38
    v_add_f32 v107, v107, v39
    ds_read_b128 v[8:11], v1 offset:40960
    ds_read_b128 v[12:15], v1 offset:41984
    ds_read_b128 v[16:19], v1 offset:43008
    ds_read_b128 v[20:23], v1 offset:44032
    ds_read_b128 v[24:27], v1 offset:45056
    ds_read_b128 v[28:31], v1 offset:46080
    ds_read_b128 v[32:35], v1 offset:47104
    ds_read_b128 v[36:39], v1 offset:48128
    s_waitcnt lgkmcnt(0)
    v_add_f32 v76, v76, v8
    v_add_f32 v77, v77, v9
    v_add_f32 v78, v78, v10
    v_add_f32 v79, v79, v11
    v_add_f32 v80, v80, v12
    v_add_f32 v81, v81, v13
    v_add_f32 v82, v82, v14
    v_add_f32 v83, v83, v15
    v_add_f32 v84, v84, v16
    v_add_f32 v85, v85, v17
    v_add_f32 v86, v86, v18
    v_add_f32 v87, v87, v19
    v_add_f32 v88, v88, v20
    v_add_f32 v89, v89, v21
    v_add_f32 v90, v90, v22
    v_add_f32 v91, v91, v23
    v_add_f32 v92, v92, v24
    v_add_f32 v93, v93, v25
    v_add_f32 v94, v94, v26
    v_add_f32 v95, v95, v27
    v_add_f32 v96, v96, v28
    v_add_f32 v97, v97, v29
    v_add_f32 v98, v98, v30
    v_add_f32 v99, v99, v31
    v_add_f32 v100, v100, v32
    v_add_f32 v101, v101, v33
    v_add_f32 v102, v102, v34
    v_add_f32 v103, v103, v35
    v_add_f32 v104, v104, v36
    v_add_f32 v105, v105, v37
    v_add_f32 v106, v106, v38
    v_add_f32 v107, v107, v39
    ds_read_b128 v[8:11], v1 offset:49152
    ds_read_b128 v[12:15], v1 offset:50176
    ds_read_b128 v[16:19], v1 offset:51200
    ds_read_b128 v[20:23], v1 offset:52224
    ds_read_b128 v[24:27], v1 offset:53248
    ds_read_b128 v[28:31], v1 offset:54272
    ds_read_b128 v[32:35], v1 offset:55296
    ds_read_b128 v[36:39], v1 offset:56320
    s_waitcnt lgkmcnt(0)
    v_add_f32 v76, v76, v8
    v_add_f32 v77, v77, v9
    v_add_f32 v78, v78, v10
    v_add_f32 v79, v79, v11
    v_add_f32 v80, v80, v12
    v_add_f32 v81, v81, v13
    v_add_f32 v82, v82, v14
    v_add_f32 v83, v83, v15
    v_add_f32 v84, v84, v16
    v_add_f32 v85, v85, v17
    v_add_f32 v86, v86, v18
    v_add_f32 v87, v87, v19
    v_add_f32 v88, v88, v20
    v_add_f32 v89, v89, v21
    v_add_f32 v90, v90, v22
    v_add_f32 v91, v91, v23
    v_add_f32 v92, v92, v24
    v_add_f32 v93, v93, v25
    v_add_f32 v94, v94, v26
    v_add_f32 v95, v95, v27
    v_add_f32 v96, v96, v28
    v_add_f32 v97, v97, v29
    v_add_f32 v98, v98, v30
    v_add_f32 v99, v99, v31
    v_add_f32 v100, v100, v32
    v_add_f32 v101, v101, v33
    v_add_f32 v102, v102, v34
    v_add_f32 v103, v103, v35
    v_add_f32 v104, v104, v36
    v_add_f32 v105, v105, v37
    v_add_f32 v106, v106, v38
    v_add_f32 v107, v107, v39
    v_cvt_pk_bf16_f32 v108, v76, v77
    v_cvt_pk_bf16_f32 v109, v78, v79
    v_cvt_pk_bf16_f32 v110, v80, v81
    v_cvt_pk_bf16_f32 v111, v82, v83
    v_cvt_pk_bf16_f32 v112, v84, v85
    v_cvt_pk_bf16_f32 v113, v86, v87
    v_cvt_pk_bf16_f32 v114, v88, v89
    v_cvt_pk_bf16_f32 v115, v90, v91
    v_cvt_pk_bf16_f32 v116, v92, v93
    v_cvt_pk_bf16_f32 v117, v94, v95
    v_cvt_pk_bf16_f32 v118, v96, v97
    v_cvt_pk_bf16_f32 v119, v98, v99
    v_lshrrev_b32 v8, 5, v0
    v_lshlrev_b32 v8, 2, v8
    s_mul_i32 s65, s101, 20
    v_add_u32 v8, s65, v8
    v_and_b32 v9, 31, v0
    v_lshlrev_b32 v9, 4, v9
    v_add_u32 v10, 0, v8
    v_lshrrev_b32 v11, 3, v10
    v_lshlrev_b32 v11, 9, v11
    v_and_b32 v10, 7, v10
    v_lshl_add_u32 v11, v10, 1, v11
    v_add_u32 v125, v11, v9
    v_add_u32 v10, 8, v8
    v_lshrrev_b32 v11, 3, v10
    v_lshlrev_b32 v11, 9, v11
    v_and_b32 v10, 7, v10
    v_lshl_add_u32 v11, v10, 1, v11
    v_add_u32 v126, v11, v9
    v_add_u32 v10, 16, v8
    v_lshrrev_b32 v11, 3, v10
    v_lshlrev_b32 v11, 9, v11
    v_and_b32 v10, 7, v10
    v_lshl_add_u32 v11, v10, 1, v11
    v_add_u32 v127, v11, v9
    v_mov_b32 v10, 0x80000000
    v_cmp_gt_u32 vcc, 32, v0
    s_nop 1
    v_cndmask_b32 v127, v10, v127, vcc
    s_mov_b32 s49, s4
    s_mul_i32 s66, s49, 122880
    s_add_u32 s66, s66, s48
    buffer_load_dwordx4 a[0:3], v124, s[8:11], s66 offen offset:0 sc1
    buffer_load_dwordx4 a[4:7], v124, s[8:11], s66 offen offset:512 sc1
    buffer_load_dwordx4 a[8:11], v124, s[8:11], s66 offen offset:1024 sc1
    s_waitcnt vmcnt(0)
L_a3:
    s_waitcnt vmcnt(3)
    s_bitcmp1_b32 s101, 0
    s_cbranch_scc1 L_oddq
    v_accvgpr_read_b32 v8, a0
    v_accvgpr_read_b32 v9, a1
    v_accvgpr_read_b32 v10, a2
    v_accvgpr_read_b32 v11, a3
    v_accvgpr_read_b32 v12, a4
    v_accvgpr_read_b32 v13, a5
    v_accvgpr_read_b32 v14, a6
    v_accvgpr_read_b32 v15, a7
    v_accvgpr_read_b32 v16, a8
    v_accvgpr_read_b32 v17, a9
    s_branch L_tkq
L_oddq:
    v_accvgpr_read_b32 v8, a2
    v_accvgpr_read_b32 v9, a3
    v_accvgpr_read_b32 v10, a4
    v_accvgpr_read_b32 v11, a5
    v_accvgpr_read_b32 v12, a6
    v_accvgpr_read_b32 v13, a7
    v_accvgpr_read_b32 v14, a8
    v_accvgpr_read_b32 v15, a9
    v_accvgpr_read_b32 v16, a10
    v_accvgpr_read_b32 v17, a11
L_tkq:
    s_mov_b32 s50, s49
    s_add_u32 s49, s49, 4
    s_mul_i32 s66, s49, 122880
    s_add_u32 s66, s66, s48
    buffer_load_dwordx4 a[0:3], v124, s[8:11], s66 offen offset:0 sc1
    buffer_load_dwordx4 a[4:7], v124, s[8:11], s66 offen offset:512 sc1
    buffer_load_dwordx4 a[8:11], v124, s[8:11], s66 offen offset:1024 sc1
    v_dot2_f32_bf16 v28, v8, v136, 0
    v_dot2_f32_bf16 v28, v9, v137, v28
    v_dot2_f32_bf16 v28, v10, v138, v28
    v_dot2_f32_bf16 v28, v11, v139, v28
    v_dot2_f32_bf16 v28, v12, v140, v28
    v_dot2_f32_bf16 v28, v13, v141, v28
    v_dot2_f32_bf16 v28, v14, v142, v28
    v_dot2_f32_bf16 v28, v15, v143, v28
    v_dot2_f32_bf16 v28, v16, v144, v28
    v_dot2_f32_bf16 v28, v17, v145, v28
    v_dot2_f32_bf16 v29, v8, v146, 0
    v_dot2_f32_bf16 v29, v9, v147, v29
    v_dot2_f32_bf16 v29, v10, v148, v29
    v_dot2_f32_bf16 v29, v11, v149, v29
    v_dot2_f32_bf16 v29, v12, v150, v29
    v_dot2_f32_bf16 v29, v13, v151, v29
    v_dot2_f32_bf16 v29, v14, v152, v29
    v_dot2_f32_bf16 v29, v15, v153, v29
    v_dot2_f32_bf16 v29, v16, v154, v29
    v_dot2_f32_bf16 v29, v17, v155, v29
    v_dot2_f32_bf16 v30, v8, v156, 0
    v_dot2_f32_bf16 v30, v9, v157, v30
    v_dot2_f32_bf16 v30, v10, v158, v30
    v_dot2_f32_bf16 v30, v11, v159, v30
    v_dot2_f32_bf16 v30, v12, v160, v30
    v_dot2_f32_bf16 v30, v13, v161, v30
    v_dot2_f32_bf16 v30, v14, v162, v30
    v_dot2_f32_bf16 v30, v15, v163, v30
    v_dot2_f32_bf16 v30, v16, v164, v30
    v_dot2_f32_bf16 v30, v17, v165, v30
    v_dot2_f32_bf16 v31, v8, v166, 0
    v_dot2_f32_bf16 v31, v9, v167, v31
    v_dot2_f32_bf16 v31, v10, v168, v31
    v_dot2_f32_bf16 v31, v11, v169, v31
    v_dot2_f32_bf16 v31, v12, v170, v31
    v_dot2_f32_bf16 v31, v13, v171, v31
    v_dot2_f32_bf16 v31, v14, v172, v31
    v_dot2_f32_bf16 v31, v15, v173, v31
    v_dot2_f32_bf16 v31, v16, v174, v31
    v_dot2_f32_bf16 v31, v17, v175, v31
    v_dot2_f32_bf16 v32, v8, v176, 0
    v_dot2_f32_bf16 v32, v9, v177, v32
    v_dot2_f32_bf16 v32, v10, v178, v32
    v_dot2_f32_bf16 v32, v11, v179, v32
    v_dot2_f32_bf16 v32, v12, v180, v32
    v_dot2_f32_bf16 v32, v13, v181, v32
    v_dot2_f32_bf16 v32, v14, v182, v32
    v_dot2_f32_bf16 v32, v15, v183, v32
    v_dot2_f32_bf16 v32, v16, v184, v32
    v_dot2_f32_bf16 v32, v17, v185, v32
    v_dot2_f32_bf16 v33, v8, v186, 0
    v_dot2_f32_bf16 v33, v9, v187, v33
    v_dot2_f32_bf16 v33, v10, v188, v33
    v_dot2_f32_bf16 v33, v11, v189, v33
    v_dot2_f32_bf16 v33, v12, v190, v33
    v_dot2_f32_bf16 v33, v13, v191, v33
    v_dot2_f32_bf16 v33, v14, v192, v33
    v_dot2_f32_bf16 v33, v15, v193, v33
    v_dot2_f32_bf16 v33, v16, v194, v33
    v_dot2_f32_bf16 v33, v17, v195, v33
    v_dot2_f32_bf16 v34, v8, v196, 0
    v_dot2_f32_bf16 v34, v9, v197, v34
    v_dot2_f32_bf16 v34, v10, v198, v34
    v_dot2_f32_bf16 v34, v11, v199, v34
    v_dot2_f32_bf16 v34, v12, v200, v34
    v_dot2_f32_bf16 v34, v13, v201, v34
    v_dot2_f32_bf16 v34, v14, v202, v34
    v_dot2_f32_bf16 v34, v15, v203, v34
    v_dot2_f32_bf16 v34, v16, v204, v34
    v_dot2_f32_bf16 v34, v17, v205, v34
    v_dot2_f32_bf16 v35, v8, v206, 0
    v_dot2_f32_bf16 v35, v9, v207, v35
    v_dot2_f32_bf16 v35, v10, v208, v35
    v_dot2_f32_bf16 v35, v11, v209, v35
    v_dot2_f32_bf16 v35, v12, v210, v35
    v_dot2_f32_bf16 v35, v13, v211, v35
    v_dot2_f32_bf16 v35, v14, v212, v35
    v_dot2_f32_bf16 v35, v15, v213, v35
    v_dot2_f32_bf16 v35, v16, v214, v35
    v_dot2_f32_bf16 v35, v17, v215, v35
    v_dot2_f32_bf16 v36, v8, v216, 0
    v_dot2_f32_bf16 v36, v9, v217, v36
    v_dot2_f32_bf16 v36, v10, v218, v36
    v_dot2_f32_bf16 v36, v11, v219, v36
    v_dot2_f32_bf16 v36, v12, v220, v36
    v_dot2_f32_bf16 v36, v13, v221, v36
    v_dot2_f32_bf16 v36, v14, v222, v36
    v_dot2_f32_bf16 v36, v15, v223, v36
    v_dot2_f32_bf16 v36, v16, v224, v36
    v_dot2_f32_bf16 v36, v17, v225, v36
    v_dot2_f32_bf16 v37, v8, v226, 0
    v_dot2_f32_bf16 v37, v9, v227, v37
    v_dot2_f32_bf16 v37, v10, v228, v37
    v_dot2_f32_bf16 v37, v11, v229, v37
    v_dot2_f32_bf16 v37, v12, v230, v37
    v_dot2_f32_bf16 v37, v13, v231, v37
    v_dot2_f32_bf16 v37, v14, v232, v37
    v_dot2_f32_bf16 v37, v15, v233, v37
    v_dot2_f32_bf16 v37, v16, v234, v37
    v_dot2_f32_bf16 v37, v17, v235, v37
    v_cvt_pk_bf16_f32 v48, v28, v29
    v_cvt_pk_bf16_f32 v49, v30, v31
    v_cvt_pk_bf16_f32 v50, v32, v33
    v_cvt_pk_bf16_f32 v51, v34, v35
    v_cvt_pk_bf16_f32 v52, v36, v37
    v_lshlrev_b32 v28, 16, v48
    v_and_b32 v29, 0xffff0000, v48
    v_lshlrev_b32 v30, 16, v49
    v_and_b32 v31, 0xffff0000, v49
    v_lshlrev_b32 v32, 16, v50
    v_and_b32 v33, 0xffff0000, v50
    v_lshlrev_b32 v34, 16, v51
    v_and_b32 v35, 0xffff0000, v51
    v_lshlrev_b32 v36, 16, v52
    v_and_b32 v37, 0xffff0000, v52
    v_mov_b32 v38, v28
    v_mov_b32 v39, v29
    v_mov_b32 v40, v30
    v_mov_b32 v41, v31
    v_mov_b32 v42, v32
    v_mov_b32 v43, v33
    v_mov_b32 v44, v34
    v_mov_b32 v45, v35
    v_mov_b32 v46, v36
    v_mov_b32 v47, v37
    v_permlane32_swap_b32 v28, v38
    v_permlane32_swap_b32 v29, v39
    v_permlane32_swap_b32 v30, v40
    v_permlane32_swap_b32 v31, v41
    v_permlane32_swap_b32 v32, v42
    v_permlane32_swap_b32 v33, v43
    v_permlane32_swap_b32 v34, v44
    v_permlane32_swap_b32 v35, v45
    v_permlane32_swap_b32 v36, v46
    v_permlane32_swap_b32 v37, v47
    v_mul_f32 v28, v28, v120
    v_mul_f32 v29, v29, v120
    v_mul_f32 v30, v30, v120
    v_mul_f32 v31, v31, v120
    v_mul_f32 v32, v32, v120
    v_mul_f32 v33, v33, v120
    v_mul_f32 v34, v34, v120
    v_mul_f32 v35, v35, v120
    v_mul_f32 v36, v36, v120
    v_mul_f32 v37, v37, v120
    v_mul_f32 v38, v38, v120
    v_mul_f32 v39, v39, v120
    v_mul_f32 v40, v40, v120
    v_mul_f32 v41, v41, v120
    v_mul_f32 v42, v42, v120
    v_mul_f32 v43, v43, v120
    v_mul_f32 v44, v44, v120
    v_mul_f32 v45, v45, v120
    v_mul_f32 v46, v46, v120
    v_mul_f32 v47, v47, v120
    v_max3_f32 v60, v28, v29, v30
    v_max3_f32 v61, v31, v32, v33
    v_max3_f32 v60, v60, v34, v35
    v_max3_f32 v61, v61, v36, v37
    v_max3_f32 v60, v60, v38, v39
    v_max3_f32 v61, v61, v40, v41
    v_max3_f32 v60, v60, v42, v43
    v_max3_f32 v61, v61, v44, v45
    v_max3_f32 v60, v60, v46, v47
    v_max_f32 v60, v60, v61
    v_sub_f32 v28, v28, v60
    v_sub_f32 v29, v29, v60
    v_sub_f32 v30, v30, v60
    v_sub_f32 v31, v31, v60
    v_sub_f32 v32, v32, v60
    v_sub_f32 v33, v33, v60
    v_sub_f32 v34, v34, v60
    v_sub_f32 v35, v35, v60
    v_sub_f32 v36, v36, v60
    v_sub_f32 v37, v37, v60
    v_sub_f32 v38, v38, v60
    v_sub_f32 v39, v39, v60
    v_sub_f32 v40, v40, v60
    v_sub_f32 v41, v41, v60
    v_sub_f32 v42, v42, v60
    v_sub_f32 v43, v43, v60
    v_sub_f32 v44, v44, v60
    v_sub_f32 v45, v45, v60
    v_sub_f32 v46, v46, v60
    v_sub_f32 v47, v47, v60
    v_exp_f32 v28, v28
    v_exp_f32 v29, v29
    v_exp_f32 v30, v30
    v_exp_f32 v31, v31
    v_exp_f32 v32, v32
    v_exp_f32 v33, v33
    v_exp_f32 v34, v34
    v_exp_f32 v35, v35
    v_exp_f32 v36, v36
    v_exp_f32 v37, v37
    v_exp_f32 v38, v38
    v_exp_f32 v39, v39
    v_exp_f32 v40, v40
    v_exp_f32 v41, v41
    v_exp_f32 v42, v42
    v_exp_f32 v43, v43
    v_exp_f32 v44, v44
    v_exp_f32 v45, v45
    v_exp_f32 v46, v46
    v_exp_f32 v47, v47
    v_add_f32 v60, v28, v29
    v_add_f32 v61, v30, v31
    v_add_f32 v60, v60, v32
    v_add_f32 v61, v61, v33
    v_add_f32 v61, v61, v34
    v_add_f32 v60, v60, v35
    v_add_f32 v60, v60, v36
    v_add_f32 v61, v61, v37
    v_add_f32 v61, v61, v38
    v_add_f32 v60, v60, v39
    v_add_f32 v60, v60, v40
    v_add_f32 v61, v61, v41
    v_add_f32 v61, v61, v42
    v_add_f32 v60, v60, v43
    v_add_f32 v60, v60, v44
    v_add_f32 v61, v61, v45
    v_add_f32 v61, v61, v46
    v_add_f32 v60, v60, v47
    v_add_f32 v60, v60, v61
    v_rcp_f32 v60, v60
    s_nop 0
    v_mul_f32 v28, v28, v60
    v_mul_f32 v29, v29, v60
    v_mul_f32 v30, v30, v60
    v_mul_f32 v31, v31, v60
    v_mul_f32 v32, v32, v60
    v_mul_f32 v33, v33, v60
    v_mul_f32 v34, v34, v60
    v_mul_f32 v35, v35, v60
    v_mul_f32 v36, v36, v60
    v_mul_f32 v37, v37, v60
    v_mul_f32 v38, v38, v60
    v_mul_f32 v39, v39, v60
    v_mul_f32 v40, v40, v60
    v_mul_f32 v41, v41, v60
    v_mul_f32 v42, v42, v60
    v_mul_f32 v43, v43, v60
    v_mul_f32 v44, v44, v60
    v_mul_f32 v45, v45, v60
    v_mul_f32 v46, v46, v60
    v_mul_f32 v47, v47, v60
    v_cvt_pk_bf16_f32 v48, v28, v29
    v_cvt_pk_bf16_f32 v49, v30, v31
    v_cvt_pk_bf16_f32 v50, v32, v33
    v_cvt_pk_bf16_f32 v51, v34, v35
    v_cvt_pk_bf16_f32 v52, v36, v37
    v_cvt_pk_bf16_f32 v53, v38, v39
    v_cvt_pk_bf16_f32 v54, v40, v41
    v_cvt_pk_bf16_f32 v55, v42, v43
    v_cvt_pk_bf16_f32 v56, v44, v45
    v_cvt_pk_bf16_f32 v57, v46, v47
    v_mfma_f32_32x32x16_bf16 v[76:91], v[108:111], v[48:51], 0
    v_mfma_f32_32x32x16_bf16 v[76:91], v[112:115], v[52:55], v[76:91]
    v_mfma_f32_32x32x16_bf16 v[76:91], v[116:119], v[56:59], v[76:91]
    v_cmp_gt_u32 vcc, 32, v0
    s_nop 10
    v_cndmask_b32 v60, v84, v88, vcc
    v_add_f32 v60, 0x358637bd, v60
    v_rcp_f32 v60, v60
    s_nop 0
    v_mul_f32 v76, v76, v60
    v_mul_f32 v77, v77, v60
    v_mul_f32 v78, v78, v60
    v_mul_f32 v79, v79, v60
    v_mul_f32 v80, v80, v60
    v_mul_f32 v81, v81, v60
    v_mul_f32 v82, v82, v60
    v_mul_f32 v83, v83, v60
    v_mul_f32 v84, v84, v60
    v_mul_f32 v85, v85, v60
    v_mul_f32 v86, v86, v60
    v_mul_f32 v87, v87, v60
    s_mul_i32 s65, s50, 40960
    s_add_u32 s65, s65, 134217728
    v_cvt_pk_bf16_f32 v62, v76, v77
    v_cvt_pk_bf16_f32 v63, v78, v79
    buffer_store_dwordx2 v[62:63], v125, s[8:11], s65 offen
    v_cvt_pk_bf16_f32 v64, v80, v81
    v_cvt_pk_bf16_f32 v65, v82, v83
    buffer_store_dwordx2 v[64:65], v126, s[8:11], s65 offen
    v_cvt_pk_bf16_f32 v66, v84, v85
    v_cvt_pk_bf16_f32 v67, v86, v87
    buffer_store_dwordx2 v[66:67], v127, s[8:11], s65 offen
    s_cmp_lt_u32 s49, 64
    s_cbranch_scc1 L_a3
    s_waitcnt vmcnt(0)
    buffer_wbl2 sc1
    s_waitcnt vmcnt(0)
    s_barrier
    s_mov_b32 s79, 72327424
    s_cmp_lg_u32 s4, 0
    s_cbranch_scc1 L_ai_a3
    v_mov_b32 v128, 0
    v_mov_b32 v129, 1
    s_mov_b64 exec, 1
    buffer_atomic_add v129, v128, s[8:11], s79 offen sc1
    s_mov_b64 exec, -1
L_ai_a3:
    s_sub_u32 s101, s100, 90
L_reducer:
    s_mov_b32 s5, s100
    s_mov_b32 s52, s40
    s_and_b32 s53, s41, 0xffff
    s_mov_b32 s54, 0x280000
    s_mov_b32 s55, 0x20000
    s_mov_b32 s79, 72327552
    s_waitcnt vmcnt(0)
    s_cmp_lg_u32 s4, 0
    s_cbranch_scc1 L_wcok_rg
    v_min_u32 v128, 0, v0
    v_lshlrev_b32 v128, 2, v128
L_wc_rg:
    buffer_load_dword v129, v128, s[8:11], s79 offen sc1
    s_waitcnt vmcnt(0)
    v_cmp_gt_u32 vcc, 32, v129
    s_cbranch_vccz L_wcok_rg
    s_sleep 8
    s_cmp_eq_u32 s46, 0
    s_cbranch_scc1 L_wcok_rg
    s_sub_u32 s46, s46, 1
    s_branch L_wc_rg
L_wcok_rg:
    s_barrier
    v_and_b32 v130, 31, v0
    v_mul_u32_u24 v8, 1280, v130
    v_lshrrev_b32 v131, 5, v0
    v_lshl_add_u32 v8, v131, 4, v8
    v_lshlrev_b32 v10, 2, v130
    s_mov_b32 s48, s101
L_red:
    s_cmp_ge_u32 s48, 320
    s_cbranch_scc1 L_red_done
    s_mul_i32 s49, s48, 52429
    s_lshr_b32 s49, s49, 18
    s_mul_i32 s65, s49, 5
    s_sub_u32 s50, s48, s65
    s_lshl_b32 s79, s48, 7
    s_add_u32 s79, s79, 72286208
    s_waitcnt vmcnt(0)
    s_cmp_lg_u32 s4, 0
    s_cbranch_scc1 L_wcok_rj
    v_min_u32 v128, 0, v0
    v_lshlrev_b32 v128, 2, v128
L_wc_rj:
    buffer_load_dword v129, v128, s[8:11], s79 offen sc1
    s_waitcnt vmcnt(0)
    v_cmp_gt_u32 vcc, 9, v129
    s_cbranch_vccz L_wcok_rj
    s_sleep 4
    s_cmp_eq_u32 s46, 0
    s_cbranch_scc1 L_wcok_rj
    s_sub_u32 s46, s46, 1
    s_branch L_wc_rj
L_wcok_rj:
    s_barrier
    s_mul_i32 s65, s48, 147456
    s_lshl_b32 s66, s4, 12
    s_add_u32 s65, s65, s66
    s_add_u32 s65, s65, 83886080
    s_lshl_b32 s66, s49, 7
    s_add_u32 s66, s66, 138412032
    buffer_load_dword v9, v10, s[8:11], s66 offen sc1
    buffer_load_dwordx4 v[48:51], v1, s[8:11], s65 offen offset:0 sc1
    buffer_load_dwordx4 v[52:55], v1, s[8:11], s65 offen offset:1024 sc1
    buffer_load_dwordx4 v[56:59], v1, s[8:11], s65 offen offset:2048 sc1
    buffer_load_dwordx4 v[60:63], v1, s[8:11], s65 offen offset:3072 sc1
    s_add_u32 s65, s65, 16384
    buffer_load_dwordx4 v[64:67], v1, s[8:11], s65 offen offset:0 sc1
    buffer_load_dwordx4 v[68:71], v1, s[8:11], s65 offen offset:1024 sc1
    buffer_load_dwordx4 v[72:75], v1, s[8:11], s65 offen offset:2048 sc1
    buffer_load_dwordx4 v[76:79], v1, s[8:11], s65 offen offset:3072 sc1
    s_add_u32 s65, s65, 16384
    buffer_load_dwordx4 v[80:83], v1, s[8:11], s65 offen offset:0 sc1
    buffer_load_dwordx4 v[84:87], v1, s[8:11], s65 offen offset:1024 sc1
    buffer_load_dwordx4 v[88:91], v1, s[8:11], s65 offen offset:2048 sc1
    buffer_load_dwordx4 v[92:95], v1, s[8:11], s65 offen offset:3072 sc1
    s_add_u32 s65, s65, 16384
    buffer_load_dwordx4 v[96:99], v1, s[8:11], s65 offen offset:0 sc1
    buffer_load_dwordx4 v[100:103], v1, s[8:11], s65 offen offset:1024 sc1
    buffer_load_dwordx4 v[104:107], v1, s[8:11], s65 offen offset:2048 sc1
    buffer_load_dwordx4 v[108:111], v1, s[8:11], s65 offen offset:3072 sc1
    s_add_u32 s65, s65, 16384
    buffer_load_dwordx4 v[112:115], v1, s[8:11], s65 offen offset:0 sc1
    buffer_load_dwordx4 v[116:119], v1, s[8:11], s65 offen offset:1024 sc1
    buffer_load_dwordx4 v[120:123], v1, s[8:11], s65 offen offset:2048 sc1
    buffer_load_dwordx4 v[124:127], v1, s[8:11], s65 offen offset:3072 sc1
    s_add_u32 s65, s65, 16384
    buffer_load_dwordx4 v[128:131], v1, s[8:11], s65 offen offset:0 sc1
    buffer_load_dwordx4 v[132:135], v1, s[8:11], s65 offen offset:1024 sc1
    buffer_load_dwordx4 v[136:139], v1, s[8:11], s65 offen offset:2048 sc1
    buffer_load_dwordx4 v[140:143], v1, s[8:11], s65 offen offset:3072 sc1
    s_add_u32 s65, s65, 16384
    buffer_load_dwordx4 v[144:147], v1, s[8:11], s65 offen offset:0 sc1
    buffer_load_dwordx4 v[148:151], v1, s[8:11], s65 offen offset:1024 sc1
    buffer_load_dwordx4 v[152:155], v1, s[8:11], s65 offen offset:2048 sc1
    buffer_load_dwordx4 v[156:159], v1, s[8:11], s65 offen offset:3072 sc1
    s_add_u32 s65, s65, 16384
    buffer_load_dwordx4 v[160:163], v1, s[8:11], s65 offen offset:0 sc1
    buffer_load_dwordx4 v[164:167], v1, s[8:11], s65 offen offset:1024 sc1
    buffer_load_dwordx4 v[168:171], v1, s[8:11], s65 offen offset:2048 sc1
    buffer_load_dwordx4 v[172:175], v1, s[8:11], s65 offen offset:3072 sc1
    s_add_u32 s65, s65, 16384
    buffer_load_dwordx4 v[176:179], v1, s[8:11], s65 offen offset:0 sc1
    buffer_load_dwordx4 v[180:183], v1, s[8:11], s65 offen offset:1024 sc1
    buffer_load_dwordx4 v[184:187], v1, s[8:11], s65 offen offset:2048 sc1
    buffer_load_dwordx4 v[188:191], v1, s[8:11], s65 offen offset:3072 sc1
    s_waitcnt vmcnt(28)
    v_pk_add_f32 v[48:49], v[48:49], v[64:65]
    v_pk_add_f32 v[50:51], v[50:51], v[66:67]
    v_pk_add_f32 v[52:53], v[52:53], v[68:69]
    v_pk_add_f32 v[54:55], v[54:55], v[70:71]
    v_pk_add_f32 v[56:57], v[56:57], v[72:73]
    v_pk_add_f32 v[58:59], v[58:59], v[74:75]
    v_pk_add_f32 v[60:61], v[60:61], v[76:77]
    v_pk_add_f32 v[62:63], v[62:63], v[78:79]
    s_waitcnt vmcnt(24)
    v_pk_add_f32 v[48:49], v[48:49], v[80:81]
    v_pk_add_f32 v[50:51], v[50:51], v[82:83]
    v_pk_add_f32 v[52:53], v[52:53], v[84:85]
    v_pk_add_f32 v[54:55], v[54:55], v[86:87]
    v_pk_add_f32 v[56:57], v[56:57], v[88:89]
    v_pk_add_f32 v[58:59], v[58:59], v[90:91]
    v_pk_add_f32 v[60:61], v[60:61], v[92:93]
    v_pk_add_f32 v[62:63], v[62:63], v[94:95]
    s_waitcnt vmcnt(20)
    v_pk_add_f32 v[48:49], v[48:49], v[96:97]
    v_pk_add_f32 v[50:51], v[50:51], v[98:99]
    v_pk_add_f32 v[52:53], v[52:53], v[100:101]
    v_pk_add_f32 v[54:55], v[54:55], v[102:103]
    v_pk_add_f32 v[56:57], v[56:57], v[104:105]
    v_pk_add_f32 v[58:59], v[58:59], v[106:107]
    v_pk_add_f32 v[60:61], v[60:61], v[108:109]
    v_pk_add_f32 v[62:63], v[62:63], v[110:111]
    s_waitcnt vmcnt(16)
    v_pk_add_f32 v[48:49], v[48:49], v[112:113]
    v_pk_add_f32 v[50:51], v[50:51], v[114:115]
    v_pk_add_f32 v[52:53], v[52:53], v[116:117]
    v_pk_add_f32 v[54:55], v[54:55], v[118:119]
    v_pk_add_f32 v[56:57], v[56:57], v[120:121]
    v_pk_add_f32 v[58:59], v[58:59], v[122:123]
    v_pk_add_f32 v[60:61], v[60:61], v[124:125]
    v_pk_add_f32 v[62:63], v[62:63], v[126:127]
    s_waitcnt vmcnt(12)
    v_pk_add_f32 v[48:49], v[48:49], v[128:129]
    v_pk_add_f32 v[50:51], v[50:51], v[130:131]
    v_pk_add_f32 v[52:53], v[52:53], v[132:133]
    v_pk_add_f32 v[54:55], v[54:55], v[134:135]
    v_pk_add_f32 v[56:57], v[56:57], v[136:137]
    v_pk_add_f32 v[58:59], v[58:59], v[138:139]
    v_pk_add_f32 v[60:61], v[60:61], v[140:141]
    v_pk_add_f32 v[62:63], v[62:63], v[142:143]
    s_waitcnt vmcnt(8)
    v_pk_add_f32 v[48:49], v[48:49], v[144:145]
    v_pk_add_f32 v[50:51], v[50:51], v[146:147]
    v_pk_add_f32 v[52:53], v[52:53], v[148:149]
    v_pk_add_f32 v[54:55], v[54:55], v[150:151]
    v_pk_add_f32 v[56:57], v[56:57], v[152:153]
    v_pk_add_f32 v[58:59], v[58:59], v[154:155]
    v_pk_add_f32 v[60:61], v[60:61], v[156:157]
    v_pk_add_f32 v[62:63], v[62:63], v[158:159]
    s_waitcnt vmcnt(4)
    v_pk_add_f32 v[48:49], v[48:49], v[160:161]
    v_pk_add_f32 v[50:51], v[50:51], v[162:163]
    v_pk_add_f32 v[52:53], v[52:53], v[164:165]
    v_pk_add_f32 v[54:55], v[54:55], v[166:167]
    v_pk_add_f32 v[56:57], v[56:57], v[168:169]
    v_pk_add_f32 v[58:59], v[58:59], v[170:171]
    v_pk_add_f32 v[60:61], v[60:61], v[172:173]
    v_pk_add_f32 v[62:63], v[62:63], v[174:175]
    s_waitcnt vmcnt(0)
    v_sub_f32 v11, 1.0, v9
    v_mul_f32 v48, v48, v11
    v_fmac_f32 v48, v176, v9
    v_mul_f32 v49, v49, v11
    v_fmac_f32 v49, v177, v9
    v_mul_f32 v50, v50, v11
    v_fmac_f32 v50, v178, v9
    v_mul_f32 v51, v51, v11
    v_fmac_f32 v51, v179, v9
    v_mul_f32 v52, v52, v11
    v_fmac_f32 v52, v180, v9
    v_mul_f32 v53, v53, v11
    v_fmac_f32 v53, v181, v9
    v_mul_f32 v54, v54, v11
    v_fmac_f32 v54, v182, v9
    v_mul_f32 v55, v55, v11
    v_fmac_f32 v55, v183, v9
    v_mul_f32 v56, v56, v11
    v_fmac_f32 v56, v184, v9
    v_mul_f32 v57, v57, v11
    v_fmac_f32 v57, v185, v9
    v_mul_f32 v58, v58, v11
    v_fmac_f32 v58, v186, v9
    v_mul_f32 v59, v59, v11
    v_fmac_f32 v59, v187, v9
    v_mul_f32 v60, v60, v11
    v_fmac_f32 v60, v188, v9
    v_mul_f32 v61, v61, v11
    v_fmac_f32 v61, v189, v9
    v_mul_f32 v62, v62, v11
    v_fmac_f32 v62, v190, v9
    v_mul_f32 v63, v63, v11
    v_fmac_f32 v63, v191, v9
    v_cvt_pk_bf16_f32 v32, v48, v49
    v_cvt_pk_bf16_f32 v33, v50, v51
    v_cvt_pk_bf16_f32 v34, v52, v53
    v_cvt_pk_bf16_f32 v35, v54, v55
    v_cvt_pk_bf16_f32 v36, v56, v57
    v_cvt_pk_bf16_f32 v37, v58, v59
    v_cvt_pk_bf16_f32 v38, v60, v61
    v_cvt_pk_bf16_f32 v39, v62, v63
    v_permlane32_swap_b32 v32, v34
    v_permlane32_swap_b32 v33, v35
    v_permlane32_swap_b32 v36, v38
    v_permlane32_swap_b32 v37, v39
    s_lshl_b32 s65, s49, 5
    s_mul_i32 s65, s65, 1280
    s_lshl_b32 s66, s50, 8
    s_add_u32 s65, s65, s66
    s_lshl_b32 s66, s4, 6
    s_add_u32 s65, s65, s66
    buffer_store_dwordx4 v[32:35], v8, s[52:55], s65 offen
    buffer_store_dwordx4 v[36:39], v8, s[52:55], s65 offen offset:32
    s_add_u32 s48, s48, 38
    s_branch L_red
L_red_done:
    s_mov_b32 s5, s100
L_end:
    s_endpgm
.section .rodata,"a"
.p2align 6
.amdhsa_kernel gated_mix__linear_kernel_hedgehog__memory_aug_recurrent_mem_tr__prompt_kernel
  .amdhsa_next_free_vgpr 512
  .amdhsa_next_free_sgpr 102
  .amdhsa_accum_offset 256
  .amdhsa_group_segment_fixed_size 0
  .amdhsa_kernarg_size 120
  .amdhsa_user_sgpr_count 2
  .amdhsa_user_sgpr_kernarg_segment_ptr 1
  .amdhsa_system_sgpr_workgroup_id_x 1
.end_amdhsa_kernel
```
